```python
import torch

def _softmax(x, axis=-1):
    return torch.softmax(x, dim=axis)
def _gelu(x):
    return torch.nn.functional.gelu(x, approximate="tanh")
def _silu(x):
    return torch.nn.functional.silu(x)
def _sigmoid(x):
    return torch.sigmoid(x)
def _layernorm(x, axis=-1, eps=1e-5):
    m = x.mean(dim=axis, keepdim=True)
    v = x.var(dim=axis, keepdim=True, unbiased=False)
    return (x - m) / torch.sqrt(v + eps)
def _scatter_add(tgt, idx, src, axis=0):
    return tgt.clone().index_add_(axis, idx, src)
def _segment_sum(src, seg, n):
    out = torch.zeros((n,) + src.shape[1:], dtype=src.dtype)
    return out.index_add_(0, seg, src)
def _pad(x, pw):
    flat = tuple(v for pair in reversed(pw) for v in pair)
    return torch.nn.functional.pad(x, flat)

kernel_name = 'interleave_layers__linear_kernel_hedgehog__glu_gated_geglu__prompt'

def setup_inputs():

    _w = (lambda a: (lambda t: t.to(torch.bfloat16) if t.is_floating_point() else t)(torch.as_tensor(a)))
    def _A_setup():
        B, S, D, H = 1, 2048, 448, 16
        Dh = D // H
        return {
            "x": _w((lambda *s: torch.randn(*s, dtype=torch.bfloat16) * 0.05)(B, S, D)),
            "wqkv": _w((lambda *s: torch.randn(*s, dtype=torch.bfloat16) * 0.4)(D, 3 * D)),
            "w_phi": _w((lambda *s: torch.randn(*s, dtype=torch.bfloat16) * 0.4)(H, Dh, Dh) * (Dh ** -0.5)),
            "wo": _w((lambda *s: torch.randn(*s, dtype=torch.bfloat16) * 0.05)(D, D)),
        }
    _A_in = _A_setup()

    def _B_setup():
        B, S, Dm, Df = 1, 2048, 448, 1792
        return {
            "x": _w((lambda *s: torch.randn(*s, dtype=torch.bfloat16) * 0.05)(B, S, Dm)),
            "w_gate": _w((lambda *s: torch.randn(*s, dtype=torch.bfloat16) * 0.8)(Dm, Df) * (Dm ** -0.5)),
            "w_up": _w((lambda *s: torch.randn(*s, dtype=torch.bfloat16) * 0.8)(Dm, Df) * (Dm ** -0.5)),
            "w_down": _w((lambda *s: torch.randn(*s, dtype=torch.bfloat16) * 0.8)(Df, Dm) * (Df ** -0.5)),
        }
    _B_in = _B_setup()

    return {
        "A_x": _A_in["x"],
        "A_wqkv": _A_in["wqkv"],
        "A_w_phi": _A_in["w_phi"],
        "A_wo": _A_in["wo"],
        "B_x": _B_in["x"],
        "B_w_gate": _B_in["w_gate"],
        "B_w_up": _B_in["w_up"],
        "B_w_down": _B_in["w_down"],
    }

def reference(A_x, A_wqkv, A_w_phi, A_wo, B_x, B_w_gate, B_w_up, B_w_down):
    def _A_ref(x, wqkv, w_phi, wo):
        B, S, D = x.shape
        H = 16; Dh = D // H
        qkv = (lambda x, *d: x.permute(*d))((x @ wqkv).reshape(B, S, 3, H, Dh), 2, 0, 3, 1, 4)
        q, k, v = qkv[0], qkv[1], qkv[2]
        pq = torch.einsum("bhsd,hdf->bhsf", q, w_phi)
        pk = torch.einsum("bhsd,hdf->bhsf", k, w_phi)
        phi_q = torch.concatenate([_softmax(pq, axis=-1), _softmax(-pq, axis=-1)], axis=-1)
        phi_k = torch.concatenate([_softmax(pk, axis=-1), _softmax(-pk, axis=-1)], axis=-1)
        kv = torch.einsum("bhsf,bhsd->bhfd", phi_k, v)
        z  = torch.einsum("bhsf->bhf", phi_k)
        num = torch.einsum("bhqf,bhfd->bhqd", phi_q, kv)
        den = torch.einsum("bhqf,bhf->bhq", phi_q, z)[..., None] + 1e-6
        o = num / den
        return (lambda x, *d: x.permute(*d))(o, 0, 2, 1, 3).reshape(B, S, D) @ wo

    def _B_ref(x, w_gate, w_up, w_down):
        g = torch.einsum("bsd,df->bsf", x, w_gate)
        u = torch.einsum("bsd,df->bsf", x, w_up)
        h = _gelu(g) * u
        return torch.einsum("bsf,fd->bsd", h, w_down)

    x = A_x
    x = x + _A_ref(_layernorm(x, axis=-1), A_wqkv, A_w_phi, A_wo)
    x = x + _B_ref(_layernorm(x, axis=-1), B_w_gate, B_w_up, B_w_down)
    x = x + _A_ref(_layernorm(x, axis=-1), A_wqkv, A_w_phi, A_wo)
    x = x + _B_ref(_layernorm(x, axis=-1), B_w_gate, B_w_up, B_w_down)
    return x
```

```asm
; @launch grid=(256,1,1) block=(256,1,1) lds=163840
.amdgcn_target "amdgcn-amd-amdhsa--gfx950"
.text
.globl interleave_layers__linear_kernel_hedgehog__glu_gated_geglu__prompt_kernel
.p2align 8
.type interleave_layers__linear_kernel_hedgehog__glu_gated_geglu__prompt_kernel,@function
interleave_layers__linear_kernel_hedgehog__glu_gated_geglu__prompt_kernel:
    s_cmp_ge_u32 s2, 256
    s_cbranch_scc1 L_end
    s_load_dwordx2 s[4:5], s[0:1], 0
    s_load_dwordx2 s[8:9], s[0:1], 8
    s_getpc_b64 s[52:53]
    s_lshr_b32 s82, s2, 3
    v_lshrrev_b32 v7, 6, v0
    v_and_b32 v28, 7, v0
    v_lshl_add_u32 v28, v7, 3, v28
    v_lshl_add_u32 v28, s82, 5, v28
    v_lshlrev_b32 v28, 7, v28
    s_and_b32 s52, s52, 0xffffff00
    v_min_u32 v28, L_codeend-interleave_layers__linear_kernel_hedgehog__glu_gated_geglu__prompt_kernel-4, v28
    v_readfirstlane_b32 s56, v7
    global_load_dword a0, v28, s[52:53]
    s_load_dwordx2 s[32:33], s[0:1], 80
    s_load_dwordx2 s[12:13], s[0:1], 16
    s_load_dwordx2 s[16:17], s[0:1], 24
    s_load_dwordx2 s[20:21], s[0:1], 40
    s_load_dwordx2 s[24:25], s[0:1], 56
    s_load_dwordx2 s[28:29], s[0:1], 64
    s_load_dwordx2 s[54:55], s[0:1], 48
    v_and_b32 v1, 63, v0
    s_and_b32 s69, s2, 7
    s_and_b32 s58, s82, 15
    s_lshr_b32 s71, s82, 4
    s_lshl_b32 s57, s69, 1
    s_add_u32 s57, s57, s71
    s_lshl_b32 s62, s56, 10
    s_and_b32 s69, s58, 1
    s_mul_i32 s65, s58, 56
    s_lshl_b32 s71, s69, 3
    s_sub_u32 s65, s65, s71
    s_mul_i32 s71, s56, 7
    s_mul_i32 s64, s57, 28
    s_add_u32 s64, s64, s71
    s_mul_i32 s72, s64, 2688
    s_add_u32 s65, s65, s72
    v_lshrrev_b32 v28, 3, v1
    v_and_b32 v29, 7, v1
    v_add_u32 v30, s71, v28
    v_and_b32 v30, 2, v30
    v_lshlrev_b32 v30, 1, v30
    v_xor_b32 v7, v30, v29
    v_mul_u32_u24 v4, 2688, v28
    v_lshrrev_b32 v32, 2, v7
    v_mul_u32_u24 v32, 896, v32
    v_add_u32 v4, v4, v32
    v_and_b32 v32, 3, v7
    v_lshl_add_u32 v4, v32, 4, v4
    v_lshrrev_b32 v28, 2, v1
    v_mul_u32_u24 v5, 2688, v28
    v_and_b32 v29, 3, v1
    v_lshl_add_u32 v5, v29, 4, v5
    s_mov_b32 s6, 1835008
    s_mov_b32 s7, 0x20000
    s_mov_b32 s10, 1204224
    s_mov_b32 s11, 0x20000
    v_lshrrev_b32 v194, 3, v1
    v_mul_u32_u24 v224, 896, v194
    v_bfe_u32 v194, v1, 4, 2
    v_and_b32 v195, 7, v1
    v_xor_b32 v194, v194, v195
    v_lshlrev_b32 v194, 4, v194
    v_xor_b32 v195, 64, v194
    v_add_u32 v225, v224, v195
    v_add_u32 v224, v224, v194
    s_lshl_b32 s70, s57, 2
    s_add_u32 s70, s70, s56
    s_mul_i32 s70, s70, 28672
    s_lshl_b32 s88, s56, 12
    s_mul_i32 s83, s82, 37
    s_lshr_b32 s83, s83, 8
    s_mul_i32 s83, s83, 7
    s_sub_u32 s82, s82, s83
    s_and_b32 s82, s82, 7
    s_mov_b32 s83, s82
    s_waitcnt lgkmcnt(0)
    s_mov_b32 exec_hi, 0xffffff
    buffer_load_dwordx4 v[140:143], v4, s[8:11], s65 offen offset:896
    s_mov_b64 exec, 0xfffffff
    buffer_load_dwordx4 v[144:147], v5, s[8:11], s65 offen
    s_mov_b64 exec, -1
    s_lshl_b32 s85, s83, 7
    s_add_u32 s85, s85, s70
    s_add_u32 s83, s83, 1
    s_cmp_eq_u32 s83, 7
    s_cselect_b32 s83, 0, s83
    s_add_u32 m0, s88, 45056
    s_add_u32 s79, s85, 0
    buffer_load_dwordx4 v224, s[4:7], s79 offen lds
    s_add_u32 m0, s88, 46080
    s_add_u32 s79, s85, 7168
    buffer_load_dwordx4 v225, s[4:7], s79 offen lds
    s_add_u32 m0, s88, 47104
    s_add_u32 s79, s85, 14336
    buffer_load_dwordx4 v224, s[4:7], s79 offen lds
    s_add_u32 m0, s88, 48128
    s_add_u32 s79, s85, 21504
    buffer_load_dwordx4 v225, s[4:7], s79 offen lds
    s_lshl_b32 s85, s83, 7
    s_add_u32 s85, s85, s70
    s_add_u32 s83, s83, 1
    s_cmp_eq_u32 s83, 7
    s_cselect_b32 s83, 0, s83
    s_add_u32 m0, s88, 61440
    s_add_u32 s79, s85, 0
    buffer_load_dwordx4 v224, s[4:7], s79 offen lds
    s_add_u32 m0, s88, 62464
    s_add_u32 s79, s85, 7168
    buffer_load_dwordx4 v225, s[4:7], s79 offen lds
    s_add_u32 m0, s88, 63488
    s_add_u32 s79, s85, 14336
    buffer_load_dwordx4 v224, s[4:7], s79 offen lds
    s_add_u32 m0, s88, 64512
    s_add_u32 s79, s85, 21504
    buffer_load_dwordx4 v225, s[4:7], s79 offen lds
    v_lshlrev_b32 v2, 4, v1
    s_lshl_b32 s63, s57, 20
    s_lshr_b32 s76, s56, 1
    s_mov_b32 s14, 25088
    s_mov_b32 s15, 0x20000
    s_mov_b32 s34, 41943040
    s_mov_b32 s35, 0x20000
    s_add_u32 s50, s32, 0x2002000
    s_addc_u32 s51, s33, 0
    s_load_dwordx2 s[36:37], s[50:51], 0
    v_mov_b32 v172, 0
    v_mov_b32 v173, 0
    v_mov_b32 v174, 0
    v_mov_b32 v175, 0
    s_lshl_b32 s69, s58, 13
    s_lshl_b32 s79, s57, 9
    s_add_u32 s69, s69, s79
    s_and_b32 s79, s56, 1
    s_lshl_b32 s79, s79, 17
    s_add_u32 s69, s69, s79
    s_add_u32 s69, s69, 0x2010000
    s_lshl_b32 s79, s58, 7
    s_add_u32 s79, s79, s63
    s_cmp_ge_u32 s56, 2
    s_cselect_b32 s69, s79, s69
    s_cselect_b32 s44, 0xff, -1
    s_mov_b32 s45, 0
    s_mov_b64 exec, s[44:45]
    buffer_store_dwordx4 v[172:175], v2, s[32:35], s69 offen sc1
    s_mov_b64 exec, -1
    s_getreg_b32 s74, hwreg(HW_REG_XCC_ID, 0, 4)
    s_mov_b32 s61, 0
    s_mul_i32 s78, s58, 86016
    s_add_u32 s78, s78, 0x2080000
    v_and_b32 v194, 31, v1
    v_bfe_u32 v195, v194, 1, 3
    v_lshrrev_b32 v196, 5, v1
    v_xor_b32 v195, v195, v196
    v_lshlrev_b32 v194, 7, v194
    v_lshl_add_u32 v194, v195, 4, v194
    s_add_u32 s69, s88, 45056
    v_add_u32 v220, s69, v194
    v_xor_b32 v221, 32, v220
    v_xor_b32 v222, 64, v220
    v_xor_b32 v223, 96, v220
    s_bitcmp1_b32 s58, 0
    s_cselect_b32 s69, 0, 99
    s_cselect_b32 s71, 99, 3
    v_cmp_eq_u32 s[44:45], s69, v7
    v_cmp_eq_u32 s[46:47], s71, v7
    s_lshl_b32 s69, s64, 7
    s_add_u32 s69, s69, s78
    s_lshl_b32 s71, s64, 6
    s_add_u32 s71, s71, s78
    s_add_u32 s71, s71, 57344
    s_add_u32 s78, s78, s62
    s_mov_b32 s72, 0xffff0000
    v_mov_b32 v194, 0x3f80
    s_waitcnt vmcnt(9)
    v_and_or_b32 v195, v140, s72, v194
    v_and_or_b32 v196, v142, s72, v194
    v_cndmask_b32 v140, v140, v195, s[44:45]
    v_cndmask_b32 v142, v142, v196, s[46:47]
    s_mov_b32 exec_hi, 0xffffff
    buffer_store_dwordx4 v[140:143], v2, s[32:35], s69 offen sc1
    s_mov_b64 exec, 0xfffffff
    buffer_store_dwordx4 v[144:147], v2, s[32:35], s71 offen sc1
    s_mov_b64 exec, -1
    s_lshl_b32 s85, s83, 7
    s_add_u32 s85, s85, s70
    s_add_u32 s83, s83, 1
    s_cmp_eq_u32 s83, 7
    s_cselect_b32 s83, 0, s83
    s_add_u32 m0, s88, 77824
    s_add_u32 s79, s85, 0
    buffer_load_dwordx4 v224, s[4:7], s79 offen lds
    s_add_u32 m0, s88, 78848
    s_add_u32 s79, s85, 7168
    buffer_load_dwordx4 v225, s[4:7], s79 offen lds
    s_add_u32 m0, s88, 79872
    s_add_u32 s79, s85, 14336
    buffer_load_dwordx4 v224, s[4:7], s79 offen lds
    s_add_u32 m0, s88, 80896
    s_add_u32 s79, s85, 21504
    buffer_load_dwordx4 v225, s[4:7], s79 offen lds
    s_waitcnt lgkmcnt(0)
    s_add_u32 s36, s36, 1
    s_add_u32 s37, s37, 1
    s_lshl_b32 s69, s37, 4
    s_or_b32 s69, s69, s74
    v_mov_b32 v194, s36
    v_mov_b32 v195, s69
    s_lshl_b32 s69, s58, 3
    s_add_u32 s69, s69, s63
    s_add_u32 s69, s69, 0x800
    s_lshl_b32 s71, s58, 7
    s_lshl_b32 s72, s57, 3
    s_add_u32 s71, s71, s72
    s_add_u32 s71, s71, 0x2001000
    s_bitcmp1_b32 s56, 0
    s_cselect_b32 s69, s71, s69
    s_cmp_ge_u32 s56, 2
    s_waitcnt vmcnt(4)
    s_barrier
    s_cbranch_scc1 L_bt_1
    s_mov_b64 exec, 1
    buffer_store_dwordx2 v[194:195], off, s[32:35], s69 sc1
    s_mov_b64 exec, -1
L_bt_1:
    s_lshl_b32 s85, s83, 7
    s_add_u32 s85, s85, s70
    s_add_u32 s83, s83, 1
    s_cmp_eq_u32 s83, 7
    s_cselect_b32 s83, 0, s83
    s_add_u32 m0, s88, 94208
    s_add_u32 s79, s85, 0
    buffer_load_dwordx4 v224, s[4:7], s79 offen lds
    s_add_u32 m0, s88, 95232
    s_add_u32 s79, s85, 7168
    buffer_load_dwordx4 v225, s[4:7], s79 offen lds
    s_add_u32 m0, s88, 96256
    s_add_u32 s79, s85, 14336
    buffer_load_dwordx4 v224, s[4:7], s79 offen lds
    s_add_u32 m0, s88, 97280
    s_add_u32 s79, s85, 21504
    buffer_load_dwordx4 v225, s[4:7], s79 offen lds
    s_mul_i32 s69, s58, 1568
    s_mov_b32 m0, 161792
    s_nop 0
    buffer_load_dwordx4 v2, s[12:15], s69 offen lds
    buffer_load_dwordx4 v2, s[12:15], s69 offen offset:1024 lds
    ds_read_b128 v[28:31], v220 offset:0
    ds_read_b128 v[32:35], v221 offset:0
    ds_read_b128 v[36:39], v222 offset:0
    ds_read_b128 v[40:43], v223 offset:0
    s_waitcnt lgkmcnt(3)
    v_mfma_f32_32x32x16_bf16 a[24:39], v[28:31], v[28:31], 0
    s_waitcnt lgkmcnt(2)
    v_mfma_f32_32x32x16_bf16 a[24:39], v[32:35], v[32:35], a[24:39]
    s_waitcnt lgkmcnt(1)
    v_mfma_f32_32x32x16_bf16 a[24:39], v[36:39], v[36:39], a[24:39]
    s_waitcnt lgkmcnt(0)
    v_mfma_f32_32x32x16_bf16 a[24:39], v[40:43], v[40:43], a[24:39]
    s_lshl_b32 s85, s83, 7
    s_add_u32 s85, s85, s70
    s_add_u32 s83, s83, 1
    s_cmp_eq_u32 s83, 7
    s_cselect_b32 s83, 0, s83
    s_add_u32 m0, s88, 110592
    s_add_u32 s79, s85, 0
    buffer_load_dwordx4 v224, s[4:7], s79 offen lds
    s_add_u32 m0, s88, 111616
    s_add_u32 s79, s85, 7168
    buffer_load_dwordx4 v225, s[4:7], s79 offen lds
    s_add_u32 m0, s88, 112640
    s_add_u32 s79, s85, 14336
    buffer_load_dwordx4 v224, s[4:7], s79 offen lds
    s_add_u32 m0, s88, 113664
    s_add_u32 s79, s85, 21504
    buffer_load_dwordx4 v225, s[4:7], s79 offen lds
    ds_read_b128 v[44:47], v220 offset:16384
    ds_read_b128 v[48:51], v221 offset:16384
    ds_read_b128 v[52:55], v222 offset:16384
    ds_read_b128 v[56:59], v223 offset:16384
    s_waitcnt lgkmcnt(3)
    v_mfma_f32_32x32x16_bf16 a[24:39], v[44:47], v[44:47], a[24:39]
    s_waitcnt lgkmcnt(2)
    v_mfma_f32_32x32x16_bf16 a[24:39], v[48:51], v[48:51], a[24:39]
    s_waitcnt lgkmcnt(1)
    v_mfma_f32_32x32x16_bf16 a[24:39], v[52:55], v[52:55], a[24:39]
    s_waitcnt lgkmcnt(0)
    v_mfma_f32_32x32x16_bf16 a[24:39], v[56:59], v[56:59], a[24:39]
    s_lshl_b32 s85, s83, 7
    s_add_u32 s85, s85, s70
    s_add_u32 s83, s83, 1
    s_cmp_eq_u32 s83, 7
    s_cselect_b32 s83, 0, s83
    s_add_u32 m0, s88, 126976
    s_add_u32 s79, s85, 0
    buffer_load_dwordx4 v224, s[4:7], s79 offen lds
    s_add_u32 m0, s88, 128000
    s_add_u32 s79, s85, 7168
    buffer_load_dwordx4 v225, s[4:7], s79 offen lds
    s_add_u32 m0, s88, 129024
    s_add_u32 s79, s85, 14336
    buffer_load_dwordx4 v224, s[4:7], s79 offen lds
    s_add_u32 m0, s88, 130048
    s_add_u32 s79, s85, 21504
    buffer_load_dwordx4 v225, s[4:7], s79 offen lds
    v_lshrrev_b32 v172, 4, v1
    v_bfe_u32 v173, v1, 2, 2
    v_and_b32 v174, 3, v1
    v_and_b32 v175, 1, v172
    v_lshlrev_b32 v175, 1, v175
    v_lshrrev_b32 v213, 1, v174
    v_add_u32 v175, v175, v213
    v_and_b32 v213, 2, v173
    v_lshlrev_b32 v213, 1, v213
    v_xor_b32 v175, v175, v213
    v_lshlrev_b32 v175, 4, v175
    v_and_b32 v174, 1, v174
    v_lshl_add_u32 v175, v174, 3, v175
    v_lshrrev_b32 v172, 1, v172
    v_lshl_add_u32 v173, v172, 3, v173
    v_lshl_add_u32 v212, v173, 7, v175
    v_xor_b32 v213, 64, v212
    v_mov_b32 v192, 0
    v_mov_b32 v193, 0
    v_lshrrev_b32 v172, 4, v1
    v_bfe_u32 v173, v1, 2, 2
    v_and_b32 v174, 3, v1
    v_mov_b32 v175, 0x3f803f80
    v_accvgpr_write_b32 a248, v175
    v_accvgpr_write_b32 a249, v175
    v_accvgpr_write_b32 a250, v175
    v_accvgpr_write_b32 a251, v175
    v_lshl_add_u32 v172, v172, 3, v173
    s_and_b32 s69, s56, 1
    s_lshl_b32 s69, s69, 5
    s_lshl_b32 s71, s76, 11
    s_add_u32 s69, s69, s71
    v_lshlrev_b32 v227, 6, v172
    v_lshl_add_u32 v227, v174, 3, v227
    v_add_u32 v227, s69, v227
    v_and_b32 v173, 2, v173
    v_lshlrev_b32 v173, 1, v173
    v_lshrrev_b32 v175, 1, v174
    v_xor_b32 v173, v173, v175
    s_lshl_b32 s69, s56, 1
    v_xor_b32 v173, s69, v173
    v_lshlrev_b32 v172, 7, v172
    v_lshl_add_u32 v172, v173, 4, v172
    v_and_b32 v174, 1, v174
    v_lshl_add_u32 v226, v174, 3, v172
    s_lshl_b32 s69, s56, 6
    s_add_u32 s69, s69, 159744
    v_lshlrev_b32 v233, 2, v1
    v_add_u32 v232, s69, v233
    v_add_u32 v233, 159744, v233
    s_waitcnt vmcnt(14)
    ds_read_b128 v[60:63], v220 offset:32768
    ds_read_b128 v[64:67], v221 offset:32768
    ds_read_b128 v[68:71], v222 offset:32768
    ds_read_b128 v[72:75], v223 offset:32768
    s_waitcnt lgkmcnt(3)
    v_mfma_f32_32x32x16_bf16 a[24:39], v[60:63], v[60:63], a[24:39]
    s_waitcnt lgkmcnt(2)
    v_mfma_f32_32x32x16_bf16 a[24:39], v[64:67], v[64:67], a[24:39]
    s_waitcnt lgkmcnt(1)
    v_mfma_f32_32x32x16_bf16 a[24:39], v[68:71], v[68:71], a[24:39]
    s_waitcnt lgkmcnt(0)
    v_mfma_f32_32x32x16_bf16 a[24:39], v[72:75], v[72:75], a[24:39]
    s_lshl_b32 s85, s83, 7
    s_add_u32 s85, s85, s70
    s_add_u32 s83, s83, 1
    s_cmp_eq_u32 s83, 7
    s_cselect_b32 s83, 0, s83
    s_add_u32 m0, s88, 143360
    s_add_u32 s79, s85, 0
    buffer_load_dwordx4 v224, s[4:7], s79 offen lds
    s_add_u32 m0, s88, 144384
    s_add_u32 s79, s85, 7168
    buffer_load_dwordx4 v225, s[4:7], s79 offen lds
    s_add_u32 m0, s88, 145408
    s_add_u32 s79, s85, 14336
    buffer_load_dwordx4 v224, s[4:7], s79 offen lds
    s_add_u32 m0, s88, 146432
    s_add_u32 s79, s85, 21504
    buffer_load_dwordx4 v225, s[4:7], s79 offen lds
    s_cmp_lg_u32 s76, 0
    s_cselect_b32 s20, s54, s20
    s_cselect_b32 s21, s55, s21
    s_mov_b32 s18, 401408
    s_mov_b32 s19, 0x20000
    s_mov_b32 s22, 1605632
    s_mov_b32 s23, 0x20000
    s_mov_b32 s26, 1605632
    s_mov_b32 s27, 0x20000
    s_min_u32 s73, s58, 13
    s_cmp_ge_u32 s73, 7
    s_cselect_b32 s59, 1, 0
    s_mul_i32 s50, s59, 7
    s_sub_u32 s60, s73, s50
    s_and_b32 s50, s56, 1
    s_lshl_b32 s75, s59, 1
    s_add_u32 s75, s75, s50
    s_mul_i32 s67, s50, 28672
    s_lshl_b32 s51, s73, 8
    s_add_u32 s67, s67, s51
    s_lshl_b32 s51, s60, 7
    s_mul_i32 s66, s56, 7168
    s_add_u32 s66, s66, s51
    v_lshrrev_b32 v228, 3, v1
    v_and_b32 v229, 7, v1
    v_and_b32 v230, 2, v228
    v_lshlrev_b32 v231, 1, v230
    v_xor_b32 v231, v231, v229
    v_mul_u32_u24 v3, 896, v228
    v_lshl_add_u32 v3, v231, 4, v3
    s_lshl_b32 s50, s76, 2
    v_or_b32 v230, s50, v230
    v_xor_b32 v230, v230, v229
    v_mul_u32_u24 v6, 3584, v228
    v_lshl_add_u32 v6, v230, 4, v6
    s_mov_b32 s38, 0
    s_mov_b32 s39, -1
    s_mov_b32 s41, 0
    s_mov_b32 s42, 0
    s_bitcmp1_b32 s58, 0
    s_cselect_b32 s40, -1, 0
    s_cselect_b32 s43, 0, -1
    s_mov_b32 s48, 0x40004000
    s_mov_b32 s54, 0x80008000
    s_mov_b32 s49, 0x40004000
    s_mov_b32 s55, 0x80008000
    v_accvgpr_write_b32 a11, 0
    v_accvgpr_write_b32 a13, 0
    v_accvgpr_write_b32 a14, 0
    v_accvgpr_write_b32 a15, 0
    v_accvgpr_write_b32 a16, 0
    v_accvgpr_write_b32 a17, 0
    v_mov_b32 v25, 0
    v_mov_b32 v26, 0
    v_mov_b32 v27, 0
    v_lshrrev_b32 v228, 4, v1
    v_bfe_u32 v229, v1, 2, 2
    v_and_b32 v230, 3, v1
    v_lshrrev_b32 v231, 1, v228
    v_lshl_add_u32 v214, v231, 3, v229
    v_lshlrev_b32 v214, 6, v214
    v_lshl_add_u32 v214, v230, 3, v214
    v_lshlrev_b32 v215, 10, v231
    v_and_b32 v231, 1, v228
    v_lshl_add_u32 v214, v231, 5, v214
    v_lshl_add_u32 v215, v231, 7, v215
    v_and_b32 v231, 15, v1
    v_lshl_add_u32 v215, v231, 2, v215
    v_lshl_add_u32 v228, v228, 3, v229
    v_bfe_u32 v229, v228, 1, 3
    v_xor_b32 v229, v229, v230
    v_lshlrev_b32 v228, 6, v228
    v_lshl_add_u32 v228, v229, 3, v228
    s_and_b32 s89, s56, 1
    s_lshl_b32 s89, s89, 5
    v_xor_b32 v248, s89, v228
    s_lshl_b32 s89, s76, 13
    s_add_u32 s89, s89, 32768
    v_add_u32 v248, s89, v248
    v_xor_b32 v249, 16, v248
    v_add_u32 v250, 49152, v228
    v_xor_b32 v251, 16, v250
    v_and_b32 v228, 31, v1
    v_lshrrev_b32 v229, 5, v1
    v_bfe_u32 v230, v228, 1, 3
    s_lshl_b32 s89, s56, 11
    s_add_u32 s89, s89, 32768
    v_lshlrev_b32 v228, 6, v228
    v_add_u32 v228, s89, v228
    v_xor_b32 v231, v229, v230
    v_lshl_add_u32 v236, v231, 3, v228
    v_xor_b32 v237, 16, v236
    v_xor_b32 v238, 32, v236
    v_xor_b32 v239, 48, v236
    s_and_b32 s89, s58, 1
    s_cmp_lg_u32 s89, 0
    s_mov_b32 s50, 0xeda95410
    s_cselect_b32 s89, 0xcb8632f7, s50
    s_cselect_b32 s50, s50, 0xf7cb8632
    s_waitcnt vmcnt(14)
    ds_read_b128 v[76:79], v220 offset:49152
    ds_read_b128 v[80:83], v221 offset:49152
    ds_read_b128 v[84:87], v222 offset:49152
    ds_read_b128 v[88:91], v223 offset:49152
    s_waitcnt lgkmcnt(3)
    v_mfma_f32_32x32x16_bf16 a[24:39], v[76:79], v[76:79], a[24:39]
    s_waitcnt lgkmcnt(2)
    v_mfma_f32_32x32x16_bf16 a[24:39], v[80:83], v[80:83], a[24:39]
    s_waitcnt lgkmcnt(1)
    v_mfma_f32_32x32x16_bf16 a[24:39], v[84:87], v[84:87], a[24:39]
    s_waitcnt lgkmcnt(0)
    v_mfma_f32_32x32x16_bf16 a[24:39], v[88:91], v[88:91], a[24:39]
    v_and_b32 v194, 15, v1
    v_lshlrev_b32 v194, 3, v194
    s_add_u32 s69, s63, 0x800
    s_lshl_b32 s71, s58, 7
    s_add_u32 s71, s71, 0x2001000
    v_mov_b32 v195, s69
    v_mov_b32 v196, s71
    v_cmp_gt_u32 vcc, 16, v1
    s_nop 1
    v_cndmask_b32 v195, v196, v195, vcc
    v_add_u32 v252, v194, v195
    buffer_load_dwordx2 v[218:219], v252, s[32:35], 0 offen sc1
    s_waitcnt vmcnt(9)
    v_add_u32 v220, 65536, v220
    ds_read_b128 v[92:95], v220 offset:0
    v_add_u32 v221, 65536, v221
    ds_read_b128 v[96:99], v221 offset:0
    v_add_u32 v222, 65536, v222
    ds_read_b128 v[100:103], v222 offset:0
    v_add_u32 v223, 65536, v223
    ds_read_b128 v[104:107], v223 offset:0
    s_waitcnt lgkmcnt(3)
    v_mfma_f32_32x32x16_bf16 a[24:39], v[92:95], v[92:95], a[24:39]
    s_waitcnt lgkmcnt(2)
    v_mfma_f32_32x32x16_bf16 a[24:39], v[96:99], v[96:99], a[24:39]
    s_waitcnt lgkmcnt(1)
    v_mfma_f32_32x32x16_bf16 a[24:39], v[100:103], v[100:103], a[24:39]
    s_waitcnt lgkmcnt(0)
    v_mfma_f32_32x32x16_bf16 a[24:39], v[104:107], v[104:107], a[24:39]
    v_mov_b32 v231, s89
    v_mov_b32 v240, s50
    v_cmp_ne_u32 vcc, 0, v229
    s_nop 1
    v_cndmask_b32 v229, v231, v240, vcc
    v_lshlrev_b32 v230, 1, v230
    v_bfe_u32 v240, v229, 0, 4
    v_xor_b32 v240, v240, v230
    v_lshl_add_u32 v240, v240, 2, v228
    v_bfe_u32 v241, v229, 4, 4
    v_xor_b32 v241, v241, v230
    v_lshl_add_u32 v241, v241, 2, v228
    v_bfe_u32 v242, v229, 8, 4
    v_xor_b32 v242, v242, v230
    v_lshl_add_u32 v242, v242, 2, v228
    v_bfe_u32 v243, v229, 12, 4
    v_xor_b32 v243, v243, v230
    v_lshl_add_u32 v243, v243, 2, v228
    v_bfe_u32 v244, v229, 16, 4
    v_xor_b32 v244, v244, v230
    v_lshl_add_u32 v244, v244, 2, v228
    v_bfe_u32 v245, v229, 20, 4
    v_xor_b32 v245, v245, v230
    v_lshl_add_u32 v245, v245, 2, v228
    v_bfe_u32 v246, v229, 24, 4
    v_xor_b32 v246, v246, v230
    v_lshl_add_u32 v246, v246, 2, v228
    v_bfe_u32 v247, v229, 28, 4
    v_xor_b32 v247, v247, v230
    v_lshl_add_u32 v247, v247, 2, v228
    s_lshl_b32 s89, s58, 13
    s_add_u32 s89, s89, 0x2010000
    v_lshrrev_b32 v228, 5, v1
    v_and_b32 v229, 31, v1
    s_and_b32 s69, s58, 1
    v_subrev_u32 v228, s69, v228
    v_mul_i32_i24 v230, 224, v228
    v_lshl_add_u32 v230, v229, 1, v230
    v_add_u32 v230, 161792, v230
    v_add_u32 v228, -4, v230
    v_cmp_le_u32 vcc, 28, v229
    s_nop 1
    v_cndmask_b32 v230, v230, v228, vcc
    ds_read_u16 v8, v230 offset:0
    ds_read_u16 v9, v230 offset:56
    ds_read_u16 v10, v230 offset:112
    ds_read_u16 v11, v230 offset:168
    ds_read_u16 v12, v230 offset:448
    ds_read_u16 v13, v230 offset:504
    ds_read_u16 v14, v230 offset:560
    ds_read_u16 v15, v230 offset:616
    ds_read_u16 v16, v230 offset:896
    ds_read_u16 v17, v230 offset:952
    ds_read_u16 v18, v230 offset:1008
    ds_read_u16 v19, v230 offset:1064
    ds_read_u16 v20, v230 offset:1344
    ds_read_u16 v21, v230 offset:1400
    ds_read_u16 v22, v230 offset:1456
    ds_read_u16 v23, v230 offset:1512
    s_mov_b32 s50, 0xcc000000
    s_mov_b32 s51, 0xcc000000
    s_waitcnt vmcnt(0)
    s_mov_b32 s73, 0
    s_and_b32 s72, s37, 0x0fffffff
L_boot_2:
    v_lshrrev_b32 v200, 4, v219
    v_cmp_eq_u32 s[44:45], s36, v218
    v_cmp_eq_u32 s[46:47], s72, v200
    s_add_u32 s73, s73, 1
    s_and_b64 s[44:45], s[44:45], s[46:47]
    s_cmp_eq_u64 s[44:45], -1
    s_cbranch_scc1 L_boot_2_ok
    s_cmp_ge_u32 s73, 262144
    s_cbranch_scc1 L_boot_2_ok
    s_sleep 2
    buffer_load_dwordx2 v[218:219], v252, s[32:35], 0 offen sc1
    s_waitcnt vmcnt(0)
    s_branch L_boot_2
L_boot_2_ok:
    v_and_b32 v200, 15, v219
    v_cmp_eq_u32 s[44:45], s74, v200
    s_nop 0
    s_and_b32 s72, s44, 0xffff
    s_cmp_lg_u32 s72, 0xffff
    s_cselect_b32 s61, 1, s61
    s_mov_b32 s83, s82
    s_lshl_b32 s84, s83, 13
    s_add_u32 s84, s84, s78
    s_add_u32 s83, s83, 1
    s_cmp_eq_u32 s83, 7
    s_cselect_b32 s83, 0, s83
    s_add_u32 m0, s62, 0
    s_add_u32 s79, s84, 0
    buffer_load_dwordx4 v2, s[32:35], s79 offen sc1 lds
    s_add_u32 m0, s62, 4096
    s_add_u32 s79, s84, 4096
    buffer_load_dwordx4 v2, s[32:35], s79 offen sc1 lds
    s_lshl_b32 s84, s83, 13
    s_add_u32 s84, s84, s78
    s_add_u32 s83, s83, 1
    s_cmp_eq_u32 s83, 7
    s_cselect_b32 s83, 0, s83
    s_add_u32 m0, s62, 8192
    s_add_u32 s79, s84, 0
    buffer_load_dwordx4 v2, s[32:35], s79 offen sc1 lds
    s_add_u32 m0, s62, 12288
    s_add_u32 s79, s84, 4096
    buffer_load_dwordx4 v2, s[32:35], s79 offen sc1 lds
    s_lshl_b32 s84, s83, 13
    s_add_u32 s84, s84, s78
    s_add_u32 s83, s83, 1
    s_cmp_eq_u32 s83, 7
    s_cselect_b32 s83, 0, s83
    s_add_u32 m0, s62, 16384
    s_add_u32 s79, s84, 0
    buffer_load_dwordx4 v2, s[32:35], s79 offen sc1 lds
    s_add_u32 m0, s62, 20480
    s_add_u32 s79, s84, 4096
    buffer_load_dwordx4 v2, s[32:35], s79 offen sc1 lds
    s_lshl_b32 s84, s83, 13
    s_add_u32 s84, s84, s78
    s_add_u32 s83, s83, 1
    s_cmp_eq_u32 s83, 7
    s_cselect_b32 s83, 0, s83
    s_add_u32 m0, s62, 24576
    s_add_u32 s79, s84, 0
    buffer_load_dwordx4 v2, s[32:35], s79 offen sc1 lds
    s_add_u32 m0, s62, 28672
    s_add_u32 s79, s84, 4096
    buffer_load_dwordx4 v2, s[32:35], s79 offen sc1 lds
    s_lshl_b32 s84, s83, 13
    s_add_u32 s84, s84, s78
    s_add_u32 s83, s83, 1
    s_cmp_eq_u32 s83, 7
    s_cselect_b32 s83, 0, s83
    s_add_u32 m0, s62, 32768
    s_add_u32 s79, s84, 0
    buffer_load_dwordx4 v2, s[32:35], s79 offen sc1 lds
    s_add_u32 m0, s62, 36864
    s_add_u32 s79, s84, 4096
    buffer_load_dwordx4 v2, s[32:35], s79 offen sc1 lds
    s_lshl_b32 s84, s83, 13
    s_add_u32 s84, s84, s78
    s_add_u32 s83, s83, 1
    s_cmp_eq_u32 s83, 7
    s_cselect_b32 s83, 0, s83
    s_add_u32 m0, s62, 40960
    s_add_u32 s79, s84, 0
    buffer_load_dwordx4 v2, s[32:35], s79 offen sc1 lds
    ds_read_b128 v[108:111], v220 offset:16384
    ds_read_b128 v[112:115], v221 offset:16384
    ds_read_b128 v[116:119], v222 offset:16384
    ds_read_b128 v[120:123], v223 offset:16384
    s_waitcnt lgkmcnt(3)
    v_mfma_f32_32x32x16_bf16 a[24:39], v[108:111], v[108:111], a[24:39]
    s_waitcnt lgkmcnt(2)
    v_mfma_f32_32x32x16_bf16 a[24:39], v[112:115], v[112:115], a[24:39]
    s_waitcnt lgkmcnt(1)
    v_mfma_f32_32x32x16_bf16 a[24:39], v[116:119], v[116:119], a[24:39]
    s_waitcnt lgkmcnt(0)
    v_mfma_f32_32x32x16_bf16 a[24:39], v[120:123], v[120:123], a[24:39]
    ds_read_b128 v[124:127], v220 offset:32768
    ds_read_b128 v[128:131], v221 offset:32768
    ds_read_b128 v[132:135], v222 offset:32768
    ds_read_b128 v[136:139], v223 offset:32768
    s_waitcnt lgkmcnt(3)
    v_mfma_f32_32x32x16_bf16 a[24:39], v[124:127], v[124:127], a[24:39]
    s_waitcnt lgkmcnt(2)
    v_mfma_f32_32x32x16_bf16 a[24:39], v[128:131], v[128:131], a[24:39]
    s_waitcnt lgkmcnt(1)
    v_mfma_f32_32x32x16_bf16 a[24:39], v[132:135], v[132:135], a[24:39]
    s_waitcnt lgkmcnt(0)
    v_mfma_f32_32x32x16_bf16 a[24:39], v[136:139], v[136:139], a[24:39]
    v_lshl_or_b32 v8, v9, 16, v8
    v_lshl_or_b32 v10, v11, 16, v10
    v_lshl_or_b32 v12, v13, 16, v12
    v_lshl_or_b32 v14, v15, 16, v14
    v_lshl_or_b32 v16, v17, 16, v16
    v_lshl_or_b32 v18, v19, 16, v18
    v_lshl_or_b32 v20, v21, 16, v20
    v_lshl_or_b32 v22, v23, 16, v22
    v_cndmask_b32 v8, v8, 0, s[50:51]
    v_cndmask_b32 v10, v10, 0, s[50:51]
    v_cndmask_b32 v12, v12, 0, s[50:51]
    v_cndmask_b32 v14, v14, 0, s[50:51]
    v_cndmask_b32 v16, v16, 0, s[50:51]
    v_cndmask_b32 v18, v18, 0, s[50:51]
    v_cndmask_b32 v20, v20, 0, s[50:51]
    v_cndmask_b32 v22, v22, 0, s[50:51]
    v_cndmask_b32 v8, v8, 0, s[40:41]
    v_cndmask_b32 v10, v10, 0, s[40:41]
    v_cndmask_b32 v20, v20, 0, s[42:43]
    v_cndmask_b32 v22, v22, 0, s[42:43]
    v_accvgpr_write_b32 a2, v8
    v_accvgpr_write_b32 a3, v10
    v_accvgpr_write_b32 a4, v12
    v_accvgpr_write_b32 a5, v14
    v_accvgpr_write_b32 a6, v16
    v_accvgpr_write_b32 a7, v18
    v_accvgpr_write_b32 a8, v20
    v_accvgpr_write_b32 a9, v22
    s_mov_b32 exec_lo, 1
    s_mov_b32 exec_hi, 16
    v_accvgpr_read_b32 v193, a24
    s_lshl_b64 exec, exec, 1
    v_accvgpr_read_b32 v193, a25
    s_lshl_b64 exec, exec, 1
    v_accvgpr_read_b32 v193, a26
    s_lshl_b64 exec, exec, 1
    v_accvgpr_read_b32 v193, a27
    s_lshl_b64 exec, exec, 5
    v_accvgpr_read_b32 v193, a28
    s_lshl_b64 exec, exec, 1
    v_accvgpr_read_b32 v193, a29
    s_lshl_b64 exec, exec, 1
    v_accvgpr_read_b32 v193, a30
    s_lshl_b64 exec, exec, 1
    v_accvgpr_read_b32 v193, a31
    s_lshl_b64 exec, exec, 5
    v_accvgpr_read_b32 v193, a32
    s_lshl_b64 exec, exec, 1
    v_accvgpr_read_b32 v193, a33
    s_lshl_b64 exec, exec, 1
    v_accvgpr_read_b32 v193, a34
    s_lshl_b64 exec, exec, 1
    v_accvgpr_read_b32 v193, a35
    s_lshl_b64 exec, exec, 5
    v_accvgpr_read_b32 v193, a36
    s_lshl_b64 exec, exec, 1
    v_accvgpr_read_b32 v193, a37
    s_lshl_b64 exec, exec, 1
    v_accvgpr_read_b32 v193, a38
    s_lshl_b64 exec, exec, 1
    v_accvgpr_read_b32 v193, a39
    s_mov_b64 exec, -1
    s_waitcnt vmcnt(9)
    s_barrier
    ds_read_b64_tr_b16 v[172:173], v212 offset:0
    ds_read_b64_tr_b16 v[174:175], v212 offset:512
    ds_read_b64_tr_b16 v[176:177], v213 offset:0
    ds_read_b64_tr_b16 v[178:179], v213 offset:512
    ds_read_b64_tr_b16 v[180:181], v226 offset:0
    ds_read_b64_tr_b16 v[182:183], v226 offset:512
    s_waitcnt lgkmcnt(2)
    v_mfma_f32_32x32x16_bf16 v[140:155], v[172:175], v[28:31], 0
    ds_read_b64_tr_b16 v[184:185], v212 offset:2048
    ds_read_b64_tr_b16 v[186:187], v212 offset:2560
    s_add_u32 m0, s62, 45056
    s_add_u32 s79, s84, 4096
    buffer_load_dwordx4 v2, s[32:35], s79 offen sc1 lds
    v_mfma_f32_32x32x16_bf16 v[156:171], v[176:179], v[28:31], 0
    ds_read_b64_tr_b16 v[188:189], v213 offset:2048
    ds_read_b64_tr_b16 v[190:191], v213 offset:2560
    s_waitcnt lgkmcnt(2)
    v_mfma_f32_16x16x32_bf16 v[216:219], a[248:251], v[180:183], 0
    ds_read_b64_tr_b16 v[172:173], v212 offset:4096
    ds_read_b64_tr_b16 v[174:175], v212 offset:4608
    v_mfma_f32_32x32x16_bf16 v[140:155], v[184:187], v[32:35], v[140:155]
    ds_read_b64_tr_b16 v[176:177], v213 offset:4096
    ds_read_b64_tr_b16 v[178:179], v213 offset:4608
    s_lshl_b32 s84, s83, 13
    s_add_u32 s84, s84, s78
    s_add_u32 s83, s83, 1
    s_cmp_eq_u32 s83, 7
    s_cselect_b32 s83, 0, s83
    s_add_u32 m0, s62, 49152
    s_add_u32 s79, s84, 0
    buffer_load_dwordx4 v2, s[32:35], s79 offen sc1 lds
    s_waitcnt lgkmcnt(2)
    v_mfma_f32_32x32x16_bf16 v[156:171], v[188:191], v[32:35], v[156:171]
    ds_read_b64_tr_b16 v[180:181], v226 offset:4096
    ds_read_b64_tr_b16 v[182:183], v226 offset:4608
    s_add_u32 m0, s62, 53248
    s_add_u32 s79, s84, 4096
    buffer_load_dwordx4 v2, s[32:35], s79 offen sc1 lds
    v_mfma_f32_32x32x16_bf16 v[140:155], v[172:175], v[36:39], v[140:155]
    ds_read_b64_tr_b16 v[184:185], v212 offset:6144
    ds_read_b64_tr_b16 v[186:187], v212 offset:6656
    s_waitcnt lgkmcnt(2)
    v_mfma_f32_32x32x16_bf16 v[156:171], v[176:179], v[36:39], v[156:171]
    ds_read_b64_tr_b16 v[188:189], v213 offset:6144
    ds_read_b64_tr_b16 v[190:191], v213 offset:6656
    s_mov_b32 s83, s82
    s_lshl_b32 s84, s83, 12
    s_add_u32 s84, s84, s78
    s_add_u32 s83, s83, 1
    s_cmp_eq_u32 s83, 7
    s_cselect_b32 s83, 0, s83
    s_add_u32 m0, s62, 57344
    s_add_u32 s79, s84, 57344
    buffer_load_dwordx4 v2, s[32:35], s79 offen sc1 lds
    v_mfma_f32_16x16x32_bf16 v[216:219], a[248:251], v[180:183], v[216:219]
    s_waitcnt lgkmcnt(0)
    v_mfma_f32_32x32x16_bf16 v[140:155], v[184:187], v[40:43], v[140:155]
    s_lshl_b32 s84, s83, 12
    s_add_u32 s84, s84, s78
    s_add_u32 s83, s83, 1
    s_cmp_eq_u32 s83, 7
    s_cselect_b32 s83, 0, s83
    s_add_u32 m0, s62, 61440
    s_add_u32 s79, s84, 57344
    buffer_load_dwordx4 v2, s[32:35], s79 offen sc1 lds
    v_mfma_f32_32x32x16_bf16 v[156:171], v[188:191], v[40:43], v[156:171]
    s_waitcnt vmcnt(10)
    s_barrier
    ds_read_b64_tr_b16 v[172:173], v212 offset:8192
    ds_read_b64_tr_b16 v[174:175], v212 offset:8704
    ds_read_b64_tr_b16 v[176:177], v213 offset:8192
    ds_read_b64_tr_b16 v[178:179], v213 offset:8704
    ds_read_b64_tr_b16 v[180:181], v226 offset:8192
    ds_read_b64_tr_b16 v[182:183], v226 offset:8704
    s_waitcnt lgkmcnt(2)
    v_mfma_f32_32x32x16_bf16 v[140:155], v[172:175], v[44:47], v[140:155]
    ds_read_b64_tr_b16 v[184:185], v212 offset:10240
    ds_read_b64_tr_b16 v[186:187], v212 offset:10752
    s_lshl_b32 s84, s83, 12
    s_add_u32 s84, s84, s78
    s_add_u32 s83, s83, 1
    s_cmp_eq_u32 s83, 7
    s_cselect_b32 s83, 0, s83
    s_add_u32 m0, s62, 65536
    s_add_u32 s79, s84, 57344
    buffer_load_dwordx4 v2, s[32:35], s79 offen sc1 lds
    v_mfma_f32_32x32x16_bf16 v[156:171], v[176:179], v[44:47], v[156:171]
    ds_read_b64_tr_b16 v[188:189], v213 offset:10240
    ds_read_b64_tr_b16 v[190:191], v213 offset:10752
    s_waitcnt lgkmcnt(2)
    v_mfma_f32_16x16x32_bf16 v[216:219], a[248:251], v[180:183], v[216:219]
    ds_read_b64_tr_b16 v[172:173], v212 offset:12288
    ds_read_b64_tr_b16 v[174:175], v212 offset:12800
    v_mfma_f32_32x32x16_bf16 v[140:155], v[184:187], v[48:51], v[140:155]
    ds_read_b64_tr_b16 v[176:177], v213 offset:12288
    ds_read_b64_tr_b16 v[178:179], v213 offset:12800
    s_lshl_b32 s84, s83, 12
    s_add_u32 s84, s84, s78
    s_add_u32 s83, s83, 1
    s_cmp_eq_u32 s83, 7
    s_cselect_b32 s83, 0, s83
    s_add_u32 m0, s62, 69632
    s_add_u32 s79, s84, 57344
    buffer_load_dwordx4 v2, s[32:35], s79 offen sc1 lds
    s_waitcnt lgkmcnt(2)
    v_mfma_f32_32x32x16_bf16 v[156:171], v[188:191], v[48:51], v[156:171]
    ds_read_b64_tr_b16 v[180:181], v226 offset:12288
    ds_read_b64_tr_b16 v[182:183], v226 offset:12800
    s_lshl_b32 s84, s83, 12
    s_add_u32 s84, s84, s78
    s_add_u32 s83, s83, 1
    s_cmp_eq_u32 s83, 7
    s_cselect_b32 s83, 0, s83
    s_add_u32 m0, s62, 73728
    s_add_u32 s79, s84, 57344
    buffer_load_dwordx4 v2, s[32:35], s79 offen sc1 lds
    v_mfma_f32_32x32x16_bf16 v[140:155], v[172:175], v[52:55], v[140:155]
    ds_read_b64_tr_b16 v[184:185], v212 offset:14336
    ds_read_b64_tr_b16 v[186:187], v212 offset:14848
    s_waitcnt lgkmcnt(2)
    v_mfma_f32_32x32x16_bf16 v[156:171], v[176:179], v[52:55], v[156:171]
    ds_read_b64_tr_b16 v[188:189], v213 offset:14336
    ds_read_b64_tr_b16 v[190:191], v213 offset:14848
    s_lshl_b32 s84, s83, 12
    s_add_u32 s84, s84, s78
    s_add_u32 s83, s83, 1
    s_cmp_eq_u32 s83, 7
    s_cselect_b32 s83, 0, s83
    s_add_u32 m0, s62, 77824
    s_add_u32 s79, s84, 57344
    buffer_load_dwordx4 v2, s[32:35], s79 offen sc1 lds
    v_mfma_f32_16x16x32_bf16 v[216:219], a[248:251], v[180:183], v[216:219]
    ds_read_b64_tr_b16 v[172:173], v212 offset:16384
    ds_read_b64_tr_b16 v[174:175], v212 offset:16896
    s_waitcnt lgkmcnt(2)
    v_mfma_f32_32x32x16_bf16 v[140:155], v[184:187], v[56:59], v[140:155]
    ds_read_b64_tr_b16 v[176:177], v213 offset:16384
    ds_read_b64_tr_b16 v[178:179], v213 offset:16896
    s_lshl_b32 s84, s83, 12
    s_add_u32 s84, s84, s78
    s_add_u32 s83, s83, 1
    s_cmp_eq_u32 s83, 7
    s_cselect_b32 s83, 0, s83
    s_add_u32 m0, s62, 81920
    s_add_u32 s79, s84, 57344
    buffer_load_dwordx4 v2, s[32:35], s79 offen sc1 lds
    v_mfma_f32_32x32x16_bf16 v[156:171], v[188:191], v[56:59], v[156:171]
    ds_read_b64_tr_b16 v[180:181], v226 offset:16384
    ds_read_b64_tr_b16 v[182:183], v226 offset:16896
    s_waitcnt vmcnt(13)
    s_barrier
    s_waitcnt lgkmcnt(2)
    v_mfma_f32_32x32x16_bf16 v[140:155], v[172:175], v[60:63], v[140:155]
    ds_read_b64_tr_b16 v[184:185], v212 offset:18432
    ds_read_b64_tr_b16 v[186:187], v212 offset:18944
    s_add_u32 m0, s62, 86016
    s_add_u32 s79, s66, 0
    buffer_load_dwordx4 v3, s[16:19], s79 offen lds
    v_mfma_f32_32x32x16_bf16 v[156:171], v[176:179], v[60:63], v[156:171]
    ds_read_b64_tr_b16 v[188:189], v213 offset:18432
    ds_read_b64_tr_b16 v[190:191], v213 offset:18944
    s_waitcnt lgkmcnt(2)
    v_mfma_f32_16x16x32_bf16 v[216:219], a[248:251], v[180:183], v[216:219]
    ds_read_b64_tr_b16 v[172:173], v212 offset:20480
    ds_read_b64_tr_b16 v[174:175], v212 offset:20992
    s_add_u32 m0, s62, 90112
    s_add_u32 s79, s66, 28672
    buffer_load_dwordx4 v3, s[16:19], s79 offen lds
    v_mfma_f32_32x32x16_bf16 v[140:155], v[184:187], v[64:67], v[140:155]
    ds_read_b64_tr_b16 v[176:177], v213 offset:20480
    ds_read_b64_tr_b16 v[178:179], v213 offset:20992
    s_waitcnt lgkmcnt(2)
    v_mfma_f32_32x32x16_bf16 v[156:171], v[188:191], v[64:67], v[156:171]
    ds_read_b64_tr_b16 v[180:181], v226 offset:20480
    ds_read_b64_tr_b16 v[182:183], v226 offset:20992
    s_add_u32 m0, s62, 94208
    s_add_u32 s79, s66, 57344
    buffer_load_dwordx4 v3, s[16:19], s79 offen lds
    v_mfma_f32_32x32x16_bf16 v[140:155], v[172:175], v[68:71], v[140:155]
    ds_read_b64_tr_b16 v[184:185], v212 offset:22528
    ds_read_b64_tr_b16 v[186:187], v212 offset:23040
    s_waitcnt lgkmcnt(2)
    v_mfma_f32_32x32x16_bf16 v[156:171], v[176:179], v[68:71], v[156:171]
    ds_read_b64_tr_b16 v[188:189], v213 offset:22528
    ds_read_b64_tr_b16 v[190:191], v213 offset:23040
    s_add_u32 m0, s62, 98304
    s_add_u32 s79, s66, 86016
    buffer_load_dwordx4 v3, s[16:19], s79 offen lds
    v_mfma_f32_16x16x32_bf16 v[216:219], a[248:251], v[180:183], v[216:219]
    ds_read_b64_tr_b16 v[172:173], v212 offset:24576
    ds_read_b64_tr_b16 v[174:175], v212 offset:25088
    s_waitcnt lgkmcnt(2)
    v_mfma_f32_32x32x16_bf16 v[140:155], v[184:187], v[72:75], v[140:155]
    ds_read_b64_tr_b16 v[176:177], v213 offset:24576
    ds_read_b64_tr_b16 v[178:179], v213 offset:25088
    s_add_u32 m0, s62, 102400
    s_add_u32 s79, s66, 114688
    buffer_load_dwordx4 v3, s[16:19], s79 offen lds
    v_mfma_f32_32x32x16_bf16 v[156:171], v[188:191], v[72:75], v[156:171]
    ds_read_b64_tr_b16 v[180:181], v226 offset:24576
    ds_read_b64_tr_b16 v[182:183], v226 offset:25088
    s_waitcnt vmcnt(16)
    s_barrier
    s_waitcnt lgkmcnt(2)
    v_mfma_f32_32x32x16_bf16 v[140:155], v[172:175], v[76:79], v[140:155]
    ds_read_b64_tr_b16 v[184:185], v212 offset:26624
    ds_read_b64_tr_b16 v[186:187], v212 offset:27136
    s_add_u32 m0, s62, 106496
    s_add_u32 s79, s66, 143360
    buffer_load_dwordx4 v3, s[16:19], s79 offen lds
    v_mfma_f32_32x32x16_bf16 v[156:171], v[176:179], v[76:79], v[156:171]
    ds_read_b64_tr_b16 v[188:189], v213 offset:26624
    ds_read_b64_tr_b16 v[190:191], v213 offset:27136
    s_waitcnt lgkmcnt(2)
    v_mfma_f32_16x16x32_bf16 v[216:219], a[248:251], v[180:183], v[216:219]
    ds_read_b64_tr_b16 v[172:173], v212 offset:28672
    ds_read_b64_tr_b16 v[174:175], v212 offset:29184
    s_add_u32 m0, s62, 110592
    s_add_u32 s79, s66, 172032
    buffer_load_dwordx4 v3, s[16:19], s79 offen lds
    v_mfma_f32_32x32x16_bf16 v[140:155], v[184:187], v[80:83], v[140:155]
    ds_read_b64_tr_b16 v[176:177], v213 offset:28672
    ds_read_b64_tr_b16 v[178:179], v213 offset:29184
    s_waitcnt lgkmcnt(2)
    v_mfma_f32_32x32x16_bf16 v[156:171], v[188:191], v[80:83], v[156:171]
    ds_read_b64_tr_b16 v[180:181], v226 offset:28672
    ds_read_b64_tr_b16 v[182:183], v226 offset:29184
    s_add_u32 m0, s62, 114688
    s_add_u32 s79, s66, 200704
    buffer_load_dwordx4 v3, s[16:19], s79 offen lds
    v_mfma_f32_32x32x16_bf16 v[140:155], v[172:175], v[84:87], v[140:155]
    ds_read_b64_tr_b16 v[184:185], v212 offset:30720
    ds_read_b64_tr_b16 v[186:187], v212 offset:31232
    s_waitcnt lgkmcnt(2)
    v_mfma_f32_32x32x16_bf16 v[156:171], v[176:179], v[84:87], v[156:171]
    ds_read_b64_tr_b16 v[188:189], v213 offset:30720
    ds_read_b64_tr_b16 v[190:191], v213 offset:31232
    s_add_u32 m0, s62, 118784
    s_add_u32 s79, s66, 229376
    buffer_load_dwordx4 v3, s[16:19], s79 offen lds
    v_mfma_f32_16x16x32_bf16 v[216:219], a[248:251], v[180:183], v[216:219]
    ds_read_b64_tr_b16 v[172:173], v212 offset:32768
    ds_read_b64_tr_b16 v[174:175], v212 offset:33280
    s_waitcnt lgkmcnt(2)
    v_mfma_f32_32x32x16_bf16 v[140:155], v[184:187], v[88:91], v[140:155]
    ds_read_b64_tr_b16 v[176:177], v213 offset:32768
    ds_read_b64_tr_b16 v[178:179], v213 offset:33280
    s_add_u32 m0, s62, 122880
    s_add_u32 s79, s66, 258048
    buffer_load_dwordx4 v3, s[16:19], s79 offen lds
    v_mfma_f32_32x32x16_bf16 v[156:171], v[188:191], v[88:91], v[156:171]
    ds_read_b64_tr_b16 v[180:181], v226 offset:32768
    ds_read_b64_tr_b16 v[182:183], v226 offset:33280
    s_waitcnt vmcnt(19)
    s_barrier
    s_waitcnt lgkmcnt(2)
    v_mfma_f32_32x32x16_bf16 v[140:155], v[172:175], v[92:95], v[140:155]
    ds_read_b64_tr_b16 v[184:185], v212 offset:34816
    ds_read_b64_tr_b16 v[186:187], v212 offset:35328
    s_add_u32 m0, s62, 126976
    s_add_u32 s79, s66, 286720
    buffer_load_dwordx4 v3, s[16:19], s79 offen lds
    v_mfma_f32_32x32x16_bf16 v[156:171], v[176:179], v[92:95], v[156:171]
    ds_read_b64_tr_b16 v[188:189], v213 offset:34816
    ds_read_b64_tr_b16 v[190:191], v213 offset:35328
    s_waitcnt lgkmcnt(2)
    v_mfma_f32_16x16x32_bf16 v[216:219], a[248:251], v[180:183], v[216:219]
    ds_read_b64_tr_b16 v[172:173], v212 offset:36864
    ds_read_b64_tr_b16 v[174:175], v212 offset:37376
    s_add_u32 m0, s62, 131072
    s_add_u32 s79, s66, 315392
    buffer_load_dwordx4 v3, s[16:19], s79 offen lds
    v_mfma_f32_32x32x16_bf16 v[140:155], v[184:187], v[96:99], v[140:155]
    ds_read_b64_tr_b16 v[176:177], v213 offset:36864
    ds_read_b64_tr_b16 v[178:179], v213 offset:37376
    s_waitcnt lgkmcnt(2)
    v_mfma_f32_32x32x16_bf16 v[156:171], v[188:191], v[96:99], v[156:171]
    ds_read_b64_tr_b16 v[180:181], v226 offset:36864
    ds_read_b64_tr_b16 v[182:183], v226 offset:37376
    s_add_u32 m0, s62, 135168
    s_add_u32 s79, s66, 344064
    buffer_load_dwordx4 v3, s[16:19], s79 offen lds
    v_mfma_f32_32x32x16_bf16 v[140:155], v[172:175], v[100:103], v[140:155]
    ds_read_b64_tr_b16 v[184:185], v212 offset:38912
    ds_read_b64_tr_b16 v[186:187], v212 offset:39424
    s_waitcnt lgkmcnt(2)
    v_mfma_f32_32x32x16_bf16 v[156:171], v[176:179], v[100:103], v[156:171]
    ds_read_b64_tr_b16 v[188:189], v213 offset:38912
    ds_read_b64_tr_b16 v[190:191], v213 offset:39424
    s_add_u32 m0, s62, 139264
    s_add_u32 s79, s66, 372736
    buffer_load_dwordx4 v3, s[16:19], s79 offen lds
    v_mfma_f32_16x16x32_bf16 v[216:219], a[248:251], v[180:183], v[216:219]
    ds_read_b64_tr_b16 v[172:173], v212 offset:40960
    ds_read_b64_tr_b16 v[174:175], v212 offset:41472
    s_waitcnt lgkmcnt(2)
    v_mfma_f32_32x32x16_bf16 v[140:155], v[184:187], v[104:107], v[140:155]
    ds_read_b64_tr_b16 v[176:177], v213 offset:40960
    ds_read_b64_tr_b16 v[178:179], v213 offset:41472
    s_add_u32 m0, s62, 143360
    s_add_u32 s79, s67, 0
    buffer_load_dwordx4 v6, s[20:23], s79 offen lds
    v_mfma_f32_32x32x16_bf16 v[156:171], v[188:191], v[104:107], v[156:171]
    ds_read_b64_tr_b16 v[180:181], v226 offset:40960
    ds_read_b64_tr_b16 v[182:183], v226 offset:41472
    s_waitcnt vmcnt(22)
    s_barrier
    s_waitcnt lgkmcnt(2)
    v_mfma_f32_32x32x16_bf16 v[140:155], v[172:175], v[108:111], v[140:155]
    ds_read_b64_tr_b16 v[184:185], v212 offset:43008
    ds_read_b64_tr_b16 v[186:187], v212 offset:43520
    s_add_u32 m0, s62, 147456
    s_add_u32 s79, s67, 128
    buffer_load_dwordx4 v6, s[20:23], s79 offen lds
    v_mfma_f32_32x32x16_bf16 v[156:171], v[176:179], v[108:111], v[156:171]
    ds_read_b64_tr_b16 v[188:189], v213 offset:43008
    ds_read_b64_tr_b16 v[190:191], v213 offset:43520
    s_waitcnt lgkmcnt(2)
    v_mfma_f32_16x16x32_bf16 v[216:219], a[248:251], v[180:183], v[216:219]
    ds_read_b64_tr_b16 v[172:173], v212 offset:45056
    ds_read_b64_tr_b16 v[174:175], v212 offset:45568
    s_add_u32 m0, s62, 151552
    s_add_u32 s79, s67, 57344
    buffer_load_dwordx4 v6, s[20:23], s79 offen lds
    v_mfma_f32_32x32x16_bf16 v[140:155], v[184:187], v[112:115], v[140:155]
    ds_read_b64_tr_b16 v[176:177], v213 offset:45056
    ds_read_b64_tr_b16 v[178:179], v213 offset:45568
    s_waitcnt lgkmcnt(2)
    v_mfma_f32_32x32x16_bf16 v[156:171], v[188:191], v[112:115], v[156:171]
    ds_read_b64_tr_b16 v[180:181], v226 offset:45056
    ds_read_b64_tr_b16 v[182:183], v226 offset:45568
    s_add_u32 m0, s62, 155648
    s_add_u32 s79, s67, 57472
    buffer_load_dwordx4 v6, s[20:23], s79 offen lds
    v_mfma_f32_32x32x16_bf16 v[140:155], v[172:175], v[116:119], v[140:155]
    ds_read_b64_tr_b16 v[184:185], v212 offset:47104
    ds_read_b64_tr_b16 v[186:187], v212 offset:47616
    s_waitcnt lgkmcnt(2)
    v_mfma_f32_32x32x16_bf16 v[156:171], v[176:179], v[116:119], v[156:171]
    ds_read_b64_tr_b16 v[188:189], v213 offset:47104
    ds_read_b64_tr_b16 v[190:191], v213 offset:47616
    v_mfma_f32_16x16x32_bf16 v[216:219], a[248:251], v[180:183], v[216:219]
    ds_read_b64_tr_b16 v[172:173], v212 offset:49152
    ds_read_b64_tr_b16 v[174:175], v212 offset:49664
    s_waitcnt lgkmcnt(2)
    v_mfma_f32_32x32x16_bf16 v[140:155], v[184:187], v[120:123], v[140:155]
    ds_read_b64_tr_b16 v[176:177], v213 offset:49152
    ds_read_b64_tr_b16 v[178:179], v213 offset:49664
    v_mfma_f32_32x32x16_bf16 v[156:171], v[188:191], v[120:123], v[156:171]
    ds_read_b64_tr_b16 v[180:181], v226 offset:49152
    ds_read_b64_tr_b16 v[182:183], v226 offset:49664
    s_lshl_b32 s69, s2, 2
    s_add_u32 s69, s69, s56
    s_lshl_b32 s70, s2, 1
    s_and_b32 s71, s56, 1
    s_add_u32 s70, s70, s71
    v_lshlrev_b32 v200, 7, v1
    s_mul_i32 s71, s69, 512
    s_mov_b64 exec, 0xf
    buffer_load_dword a0, v200, s[16:19], s71 offen
    s_mul_i32 s71, s70, 3200
    s_mov_b64 exec, 0x1ffffff
    buffer_load_dword a0, v200, s[20:23], s71 offen
    s_mul_i32 s71, s69, 1664
    s_mov_b64 exec, 0x1fff
    buffer_load_dword a0, v200, s[24:27], s71 offen
    s_mov_b64 exec, -1
    s_waitcnt lgkmcnt(2)
    v_mfma_f32_32x32x16_bf16 v[140:155], v[172:175], v[124:127], v[140:155]
    ds_read_b64_tr_b16 v[184:185], v212 offset:51200
    ds_read_b64_tr_b16 v[186:187], v212 offset:51712
    v_mfma_f32_32x32x16_bf16 v[156:171], v[176:179], v[124:127], v[156:171]
    ds_read_b64_tr_b16 v[188:189], v213 offset:51200
    ds_read_b64_tr_b16 v[190:191], v213 offset:51712
    s_waitcnt lgkmcnt(2)
    v_mfma_f32_16x16x32_bf16 v[216:219], a[248:251], v[180:183], v[216:219]
    ds_read_b64_tr_b16 v[172:173], v212 offset:53248
    ds_read_b64_tr_b16 v[174:175], v212 offset:53760
    v_mfma_f32_32x32x16_bf16 v[140:155], v[184:187], v[128:131], v[140:155]
    ds_read_b64_tr_b16 v[176:177], v213 offset:53248
    ds_read_b64_tr_b16 v[178:179], v213 offset:53760
    s_waitcnt lgkmcnt(2)
    v_mfma_f32_32x32x16_bf16 v[156:171], v[188:191], v[128:131], v[156:171]
    ds_read_b64_tr_b16 v[180:181], v226 offset:53248
    ds_read_b64_tr_b16 v[182:183], v226 offset:53760
    v_mfma_f32_32x32x16_bf16 v[140:155], v[172:175], v[132:135], v[140:155]
    ds_read_b64_tr_b16 v[184:185], v212 offset:55296
    ds_read_b64_tr_b16 v[186:187], v212 offset:55808
    s_waitcnt lgkmcnt(2)
    v_mfma_f32_32x32x16_bf16 v[156:171], v[176:179], v[132:135], v[156:171]
    ds_read_b64_tr_b16 v[188:189], v213 offset:55296
    ds_read_b64_tr_b16 v[190:191], v213 offset:55808
    v_mfma_f32_16x16x32_bf16 v[216:219], a[248:251], v[180:183], v[216:219]
    s_waitcnt lgkmcnt(0)
    v_mfma_f32_32x32x16_bf16 v[140:155], v[184:187], v[136:139], v[140:155]
    v_mfma_f32_32x32x16_bf16 v[156:171], v[188:191], v[136:139], v[156:171]
    s_mov_b64 exec, 0xffff
    s_nop 3
    ds_write_b32 v232, v216
    s_mov_b64 exec, -1
    s_mov_b32 s46, s40
    s_mov_b32 s47, s43
    s_nop 1
    v_cndmask_b32 v192, v152, v140, s[40:41]
    v_cndmask_b32 v192, 0, v192, s[46:47]
    v_mov_b32 v194, v192
    v_mov_b32 v195, v193
    s_nop 0
    v_permlane32_swap_b32 v194, v192
    v_permlane32_swap_b32 v195, v193
    v_add_f32 v192, v194, v192
    v_add_f32 v193, v195, v193
    v_mul_f32 v192, 0x3b124925, v192
    v_mul_f32 v193, 0x3b124925, v193
    v_cvt_pk_bf16_f32 v24, -v192, -v192
    v_fma_f32 v193, -v192, v192, v193
    v_max_f32 v193, 0, v193
    v_cvt_pk_bf16_f32 v193, v193, v193
    v_lshlrev_b32 v193, 16, v193
    v_add_f32 v193, 0x3727c5ac, v193
    v_cvt_pk_bf16_f32 v193, v193, v193
    v_lshlrev_b32 v193, 16, v193
    v_sqrt_f32 v193, v193
    s_nop 0
    v_cvt_pk_bf16_f32 v193, v193, v193
    v_lshlrev_b32 v193, 16, v193
    v_rcp_f32 v208, v193
    v_lshrrev_b32 v209, 16, v193
    v_mul_f32 v210, 0x3fb8aa3b, v208
    s_waitcnt lgkmcnt(0)
    s_barrier
    v_and_b32 v194, 127, v233
    v_add_u32 v194, 159744, v194
    ds_read2_b32 v[216:217], v194 offset0:0 offset1:32
    v_mov_b32 v206, v232
    v_mov_b32 v207, v233
    v_mov_b32 v205, v227
    s_waitcnt lgkmcnt(0)
    v_cndmask_b32 v216, v216, 0, s[38:39]
    v_cndmask_b32 v217, v217, 0, s[38:39]
    v_cvt_pk_bf16_f32 v194, v216, v216
    v_lshlrev_b32 v194, 16, v194
    v_sub_f32 v194, v216, v194
    v_cvt_pk_bf16_f32 v194, v216, v194
    v_accvgpr_write_b32 a10, v194
    v_cvt_pk_bf16_f32 v195, v217, v217
    v_lshlrev_b32 v195, 16, v195
    v_sub_f32 v195, v217, v195
    v_cvt_pk_bf16_f32 v195, v217, v195
    v_accvgpr_write_b32 a12, v195
    s_nop 1
    v_mfma_f32_32x32x16_bf16 v[140:155], a[10:13], v[24:27], v[140:155]
    v_mfma_f32_32x32x16_bf16 v[156:171], a[12:15], v[24:27], v[156:171]
    v_accvgpr_write_b32 a252, v205
    v_accvgpr_write_b32 a253, v206
    v_accvgpr_write_b32 a254, v207
    v_and_b32 v195, 31, v1
    v_mul_u32_u24 v194, 896, v195
    v_lshrrev_b32 v195, 5, v1
    v_lshl_add_u32 v194, v195, 4, v194
    s_lshl_b32 s69, s57, 2
    s_add_u32 s69, s69, s75
    s_mul_i32 s69, s69, 28672
    s_lshl_b32 s72, s60, 7
    s_add_u32 s69, s69, s72
    s_lshl_b32 s72, s76, 6
    s_add_u32 s69, s69, s72
    buffer_load_dwordx4 v[8:11], v194, s[4:7], s69 offen
    buffer_load_dwordx4 v[12:15], v194, s[4:7], s69 offen offset:32
    v_cvt_pk_bf16_f32 v172, v140, v141
    v_cvt_pk_bf16_f32 v173, v142, v143
    v_cvt_pk_bf16_f32 v174, v144, v145
    v_cvt_pk_bf16_f32 v175, v146, v147
    v_cvt_pk_bf16_f32 v176, v148, v149
    v_cvt_pk_bf16_f32 v177, v150, v151
    v_cvt_pk_bf16_f32 v178, v152, v153
    v_cvt_pk_bf16_f32 v179, v154, v155
    v_mfma_f32_32x32x16_bf16 v[220:235], a[2:5], v[172:175], 0
    s_nop 0
    v_mfma_f32_32x32x16_bf16 v[220:235], a[6:9], v[176:179], v[220:235]
    v_cvt_pk_bf16_f32 v180, v156, v157
    v_cvt_pk_bf16_f32 v181, v158, v159
    v_cvt_pk_bf16_f32 v182, v160, v161
    v_cvt_pk_bf16_f32 v183, v162, v163
    v_cvt_pk_bf16_f32 v184, v164, v165
    v_cvt_pk_bf16_f32 v185, v166, v167
    v_cvt_pk_bf16_f32 v186, v168, v169
    v_cvt_pk_bf16_f32 v187, v170, v171
    v_cndmask_b32 v180, v180, 0, s[40:41]
    v_cndmask_b32 v181, v181, v209, s[40:41]
    v_cndmask_b32 v186, v186, 0, s[42:43]
    v_cndmask_b32 v187, v187, v209, s[42:43]
    ds_write_b32 v240, v180 offset:16384
    ds_write_b32 v241, v181 offset:16384
    ds_write_b32 v242, v182 offset:16384
    ds_write_b32 v243, v183 offset:16384
    ds_write_b32 v244, v184 offset:16384
    ds_write_b32 v245, v185 offset:16384
    ds_write_b32 v246, v186 offset:16384
    ds_write_b32 v247, v187 offset:16384
    s_add_u32 m0, s62, 0
    s_add_u32 s79, s67, 114688
    buffer_load_dwordx4 v6, s[20:23], s79 offen lds
    v_max3_f32 v200, v220, v221, v222
    v_min3_f32 v201, v220, v221, v222
    v_max3_f32 v200, v200, v223, v224
    v_min3_f32 v201, v201, v223, v224
    v_max3_f32 v200, v200, v225, v226
    v_min3_f32 v201, v201, v225, v226
    v_max3_f32 v200, v200, v227, v228
    v_min3_f32 v201, v201, v227, v228
    v_max3_f32 v200, v200, v229, v230
    v_min3_f32 v201, v201, v229, v230
    v_max3_f32 v200, v200, v231, v232
    v_min3_f32 v201, v201, v231, v232
    v_max_f32 v200, v200, v233
    v_min_f32 v201, v201, v233
    v_mov_b32 v202, v200
    v_mov_b32 v203, v201
    s_add_u32 m0, s62, 4096
    s_add_u32 s79, s67, 114816
    buffer_load_dwordx4 v6, s[20:23], s79 offen lds
    v_mov_b32 v163, 0
    v_permlane32_swap_b32 v202, v200
    v_permlane32_swap_b32 v203, v201
    v_max_f32 v200, v202, v200
    v_min_f32 v201, v203, v201
    v_mul_f32 v204, -v210, v200
    v_mul_f32 v206, v210, v201
    v_pk_fma_f32 v[140:141], v[220:221], v[210:211], v[204:205] op_sel_hi:[1,0,0]
    v_pk_fma_f32 v[142:143], v[222:223], v[210:211], v[204:205] op_sel_hi:[1,0,0]
    v_pk_fma_f32 v[144:145], v[224:225], v[210:211], v[204:205] op_sel_hi:[1,0,0]
    v_pk_fma_f32 v[146:147], v[226:227], v[210:211], v[204:205] op_sel_hi:[1,0,0]
    v_pk_fma_f32 v[148:149], v[228:229], v[210:211], v[204:205] op_sel_hi:[1,0,0]
    v_pk_fma_f32 v[150:151], v[230:231], v[210:211], v[204:205] op_sel_hi:[1,0,0]
    v_pk_fma_f32 v[152:153], v[232:233], v[210:211], v[204:205] op_sel_hi:[1,0,0]
    v_pk_fma_f32 v[220:221], v[220:221], v[210:211], v[206:207] op_sel_hi:[1,0,0] neg_lo:[0,1,0] neg_hi:[0,1,0]
    v_pk_fma_f32 v[222:223], v[222:223], v[210:211], v[206:207] op_sel_hi:[1,0,0] neg_lo:[0,1,0] neg_hi:[0,1,0]
    s_add_u32 m0, s62, 8192
    s_add_u32 s79, s67, 172032
    buffer_load_dwordx4 v6, s[20:23], s79 offen lds
    v_pk_fma_f32 v[224:225], v[224:225], v[210:211], v[206:207] op_sel_hi:[1,0,0] neg_lo:[0,1,0] neg_hi:[0,1,0]
    v_pk_fma_f32 v[226:227], v[226:227], v[210:211], v[206:207] op_sel_hi:[1,0,0] neg_lo:[0,1,0] neg_hi:[0,1,0]
    v_pk_fma_f32 v[228:229], v[228:229], v[210:211], v[206:207] op_sel_hi:[1,0,0] neg_lo:[0,1,0] neg_hi:[0,1,0]
    v_pk_fma_f32 v[230:231], v[230:231], v[210:211], v[206:207] op_sel_hi:[1,0,0] neg_lo:[0,1,0] neg_hi:[0,1,0]
    v_pk_fma_f32 v[232:233], v[232:233], v[210:211], v[206:207] op_sel_hi:[1,0,0] neg_lo:[0,1,0] neg_hi:[0,1,0]
    v_exp_f32 v140, v140
    v_exp_f32 v141, v141
    v_exp_f32 v142, v142
    v_exp_f32 v143, v143
    v_exp_f32 v144, v144
    v_exp_f32 v145, v145
    v_exp_f32 v146, v146
    v_exp_f32 v147, v147
    v_exp_f32 v148, v148
    v_exp_f32 v149, v149
    v_exp_f32 v150, v150
    s_add_u32 m0, s62, 12288
    s_add_u32 s79, s67, 172160
    buffer_load_dwordx4 v6, s[20:23], s79 offen lds
    v_exp_f32 v151, v151
    v_exp_f32 v152, v152
    v_exp_f32 v153, v153
    v_exp_f32 v220, v220
    v_exp_f32 v221, v221
    v_exp_f32 v222, v222
    v_exp_f32 v223, v223
    v_exp_f32 v224, v224
    v_exp_f32 v225, v225
    v_exp_f32 v226, v226
    v_exp_f32 v227, v227
    v_exp_f32 v228, v228
    v_exp_f32 v229, v229
    v_exp_f32 v230, v230
    v_exp_f32 v231, v231
    s_add_u32 m0, s62, 16384
    s_add_u32 s79, s67, 229376
    buffer_load_dwordx4 v6, s[20:23], s79 offen lds
    v_exp_f32 v232, v232
    v_exp_f32 v233, v233
    v_pk_add_f32 v[200:201], v[140:141], v[142:143]
    v_pk_add_f32 v[202:203], v[220:221], v[222:223]
    v_pk_add_f32 v[200:201], v[200:201], v[144:145]
    v_pk_add_f32 v[202:203], v[202:203], v[224:225]
    v_pk_add_f32 v[200:201], v[200:201], v[146:147]
    v_pk_add_f32 v[202:203], v[202:203], v[226:227]
    v_pk_add_f32 v[200:201], v[200:201], v[148:149]
    v_pk_add_f32 v[202:203], v[202:203], v[228:229]
    v_pk_add_f32 v[200:201], v[200:201], v[150:151]
    v_pk_add_f32 v[202:203], v[202:203], v[230:231]
    v_pk_add_f32 v[200:201], v[200:201], v[152:153]
    v_pk_add_f32 v[202:203], v[202:203], v[232:233]
    v_add_f32 v200, v200, v201
    v_add_f32 v202, v202, v203
    s_add_u32 m0, s62, 20480
    s_add_u32 s79, s67, 229504
    buffer_load_dwordx4 v6, s[20:23], s79 offen lds
    v_mov_b32 v204, v200
    v_mov_b32 v206, v202
    v_mov_b32 v171, 0
    v_permlane32_swap_b32 v204, v200
    v_permlane32_swap_b32 v206, v202
    v_add_f32 v200, v200, v204
    v_add_f32 v202, v202, v206
    v_rcp_f32 v200, v200
    v_rcp_f32 v202, v202
    v_mul_f32 v200, v200, v208
    v_mul_f32 v202, v202, v208
    v_pk_mul_f32 v[140:141], v[140:141], v[200:201] op_sel_hi:[1,0]
    v_pk_mul_f32 v[142:143], v[142:143], v[200:201] op_sel_hi:[1,0]
    v_pk_mul_f32 v[144:145], v[144:145], v[200:201] op_sel_hi:[1,0]
    v_pk_mul_f32 v[146:147], v[146:147], v[200:201] op_sel_hi:[1,0]
    v_pk_mul_f32 v[148:149], v[148:149], v[200:201] op_sel_hi:[1,0]
    s_add_u32 m0, s62, 24576
    s_add_u32 s79, s67, 286720
    buffer_load_dwordx4 v6, s[20:23], s79 offen lds
    v_pk_mul_f32 v[150:151], v[150:151], v[200:201] op_sel_hi:[1,0]
    v_pk_mul_f32 v[152:153], v[152:153], v[200:201] op_sel_hi:[1,0]
    v_cvt_pk_bf16_f32 v156, v140, v141
    v_cvt_pk_bf16_f32 v157, v142, v143
    ds_write_b64 v236, v[156:157] offset:0
    v_cvt_pk_bf16_f32 v158, v144, v145
    v_cvt_pk_bf16_f32 v159, v146, v147
    ds_write_b64 v237, v[158:159] offset:0
    v_cvt_pk_bf16_f32 v160, v148, v149
    v_cvt_pk_bf16_f32 v161, v150, v151
    ds_write_b64 v238, v[160:161] offset:0
    v_cvt_pk_bf16_f32 v162, v152, v153
    ds_write_b64 v239, v[162:163] offset:0
    v_pk_mul_f32 v[220:221], v[220:221], v[202:203] op_sel_hi:[1,0]
    v_pk_mul_f32 v[222:223], v[222:223], v[202:203] op_sel_hi:[1,0]
    v_pk_mul_f32 v[224:225], v[224:225], v[202:203] op_sel_hi:[1,0]
    s_add_u32 m0, s62, 28672
    s_add_u32 s79, s67, 286848
    buffer_load_dwordx4 v6, s[20:23], s79 offen lds
    v_pk_mul_f32 v[226:227], v[226:227], v[202:203] op_sel_hi:[1,0]
    v_pk_mul_f32 v[228:229], v[228:229], v[202:203] op_sel_hi:[1,0]
    v_pk_mul_f32 v[230:231], v[230:231], v[202:203] op_sel_hi:[1,0]
    v_pk_mul_f32 v[232:233], v[232:233], v[202:203] op_sel_hi:[1,0]
    v_cvt_pk_bf16_f32 v164, v220, v221
    v_cvt_pk_bf16_f32 v165, v222, v223
    ds_write_b64 v236, v[164:165] offset:8192
    v_cvt_pk_bf16_f32 v166, v224, v225
    v_cvt_pk_bf16_f32 v167, v226, v227
    ds_write_b64 v237, v[166:167] offset:8192
    v_cvt_pk_bf16_f32 v168, v228, v229
    v_cvt_pk_bf16_f32 v169, v230, v231
    ds_write_b64 v238, v[168:169] offset:8192
    v_cvt_pk_bf16_f32 v170, v232, v233
    ds_write_b64 v239, v[170:171] offset:8192
    v_xor_b32 v236, 32, v250
    v_xor_b32 v237, 32, v251
    s_lshl_b32 s69, s56, 11
    s_add_u32 s69, s69, s89
    s_waitcnt lgkmcnt(0)
    s_barrier
    ds_read_b64_tr_b16 v[220:221], v248 offset:0
    ds_read_b64_tr_b16 v[222:223], v249 offset:256
    ds_read_b64_tr_b16 v[140:141], v250 offset:0
    ds_read_b64_tr_b16 v[142:143], v251 offset:256
    ds_read_b64_tr_b16 v[144:145], v236 offset:0
    ds_read_b64_tr_b16 v[146:147], v237 offset:256
    ds_read_b64_tr_b16 v[224:225], v248 offset:2048
    ds_read_b64_tr_b16 v[226:227], v249 offset:2304
    ds_read_b64_tr_b16 v[148:149], v250 offset:2048
    ds_read_b64_tr_b16 v[150:151], v251 offset:2304
    ds_read_b64_tr_b16 v[152:153], v236 offset:2048
    ds_read_b64_tr_b16 v[154:155], v237 offset:2304
    ds_read_b64_tr_b16 v[228:229], v248 offset:4096
    ds_read_b64_tr_b16 v[230:231], v249 offset:4352
    ds_read_b64_tr_b16 v[172:173], v250 offset:4096
    ds_read_b64_tr_b16 v[174:175], v251 offset:4352
    ds_read_b64_tr_b16 v[176:177], v236 offset:4096
    ds_read_b64_tr_b16 v[178:179], v237 offset:4352
    ds_read_b64_tr_b16 v[232:233], v248 offset:6144
    ds_read_b64_tr_b16 v[234:235], v249 offset:6400
    ds_read_b64_tr_b16 v[180:181], v250 offset:6144
    ds_read_b64_tr_b16 v[182:183], v251 offset:6400
    ds_read_b64_tr_b16 v[184:185], v236 offset:6144
    ds_read_b64_tr_b16 v[186:187], v237 offset:6400
    s_waitcnt lgkmcnt(15)
    v_mfma_f32_16x16x32_bf16 v[156:159], v[220:223], v[140:143], 0
    v_mfma_f32_16x16x32_bf16 v[160:163], v[220:223], v[144:147], 0
    s_waitcnt lgkmcnt(14)
    v_mfma_f32_16x16x32_bf16 v[156:159], v[224:227], v[148:151], v[156:159]
    s_waitcnt lgkmcnt(12)
    v_mfma_f32_16x16x32_bf16 v[160:163], v[224:227], v[152:155], v[160:163]
    s_waitcnt lgkmcnt(8)
    v_mfma_f32_16x16x32_bf16 v[156:159], v[228:231], v[172:175], v[156:159]
    s_waitcnt lgkmcnt(6)
    v_mfma_f32_16x16x32_bf16 v[160:163], v[228:231], v[176:179], v[160:163]
    s_waitcnt lgkmcnt(2)
    v_mfma_f32_16x16x32_bf16 v[156:159], v[232:235], v[180:183], v[156:159]
    s_waitcnt lgkmcnt(0)
    v_mfma_f32_16x16x32_bf16 v[160:163], v[232:235], v[184:187], v[160:163]
    s_bitcmp1_b32 s56, 0
    s_cselect_b32 s72, 0, -1
    s_nop 3
    v_cndmask_b32 v156, v156, 1.0, s[48:49]
    s_nop 0
    v_cndmask_b32 v160, v160, 1.0, s[54:55]
    buffer_atomic_add_f32 v156, v215, s[32:35], s69 offen offset:0
    buffer_atomic_add_f32 v160, v215, s[32:35], s69 offen offset:64
    v_cndmask_b32 v157, v157, 1.0, s[48:49]
    v_cndmask_b32 v161, v161, 1.0, s[54:55]
    buffer_atomic_add_f32 v157, v215, s[32:35], s69 offen offset:256
    buffer_atomic_add_f32 v161, v215, s[32:35], s69 offen offset:320
    s_mov_b32 exec_hi, s72
    v_cndmask_b32 v158, v158, 1.0, s[48:49]
    v_cndmask_b32 v162, v162, 1.0, s[54:55]
    buffer_atomic_add_f32 v158, v215, s[32:35], s69 offen offset:512
    buffer_atomic_add_f32 v162, v215, s[32:35], s69 offen offset:576
    v_cndmask_b32 v159, v159, 1.0, s[48:49]
    v_cndmask_b32 v163, v163, 1.0, s[54:55]
    buffer_atomic_add_f32 v159, v215, s[32:35], s69 offen offset:768
    buffer_atomic_add_f32 v163, v215, s[32:35], s69 offen offset:832
    s_mov_b64 exec, -1
    s_waitcnt vmcnt(39)
    s_barrier
    s_lshr_b32 s72, s2, 3
    s_lshl_b32 s72, s72, 2
    s_add_u32 s72, s72, s56
    s_mul_i32 s72, s72, 128
    s_add_u32 s72, s72, L_c_k2b0-interleave_layers__linear_kernel_hedgehog__glu_gated_geglu__prompt_kernel
    v_lshlrev_b32 v252, 7, v1
    v_add_u32 v252, s72, v252
    v_min_u32 v252, L_c_k40-interleave_layers__linear_kernel_hedgehog__glu_gated_geglu__prompt_kernel-4, v252
    s_mov_b64 exec, 1
    global_load_dword a0, v252, s[52:53]
    s_mov_b64 exec, -1
    v_accvgpr_read_b32 v236, a252
    v_accvgpr_read_b32 v237, a253
    v_accvgpr_read_b32 v238, a254
    ds_read_b64_tr_b16 v[172:173], v214 offset:57344
    ds_read_b64_tr_b16 v[174:175], v214 offset:57600
    ds_read_b64_tr_b16 v[176:177], v214 offset:58368
    ds_read_b64_tr_b16 v[178:179], v214 offset:58624
    ds_read_b64_tr_b16 v[180:181], v236 offset:57344
    ds_read_b64_tr_b16 v[182:183], v236 offset:57600
    s_waitcnt lgkmcnt(2)
    v_mfma_f32_32x32x16_bf16 v[140:155], v[172:175], v[28:31], 0
    ds_read_b64_tr_b16 v[184:185], v214 offset:59392
    ds_read_b64_tr_b16 v[186:187], v214 offset:59648
    s_add_u32 m0, s62, 32768
    s_add_u32 s79, s67, 344064
    buffer_load_dwordx4 v6, s[20:23], s79 offen lds
    v_mfma_f32_32x32x16_bf16 v[140:155], v[176:179], v[32:35], v[140:155]
    ds_read_b64_tr_b16 v[188:189], v214 offset:60416
    ds_read_b64_tr_b16 v[190:191], v214 offset:60672
    s_waitcnt lgkmcnt(2)
    v_mfma_f32_16x16x32_bf16 v[216:219], a[248:251], v[180:183], 0
    ds_read_b64_tr_b16 v[172:173], v214 offset:61440
    ds_read_b64_tr_b16 v[174:175], v214 offset:61696
    v_mfma_f32_32x32x16_bf16 v[140:155], v[184:187], v[36:39], v[140:155]
    ds_read_b64_tr_b16 v[176:177], v214 offset:62464
    ds_read_b64_tr_b16 v[178:179], v214 offset:62720
    s_waitcnt lgkmcnt(2)
    v_mfma_f32_32x32x16_bf16 v[140:155], v[188:191], v[40:43], v[140:155]
    ds_read_b64_tr_b16 v[180:181], v236 offset:61440
    ds_read_b64_tr_b16 v[182:183], v236 offset:61696
    v_mfma_f32_32x32x16_bf16 v[140:155], v[172:175], v[44:47], v[140:155]
    ds_read_b64_tr_b16 v[184:185], v214 offset:63488
    ds_read_b64_tr_b16 v[186:187], v214 offset:63744
    s_add_u32 m0, s62, 36864
    s_add_u32 s79, s67, 344192
    buffer_load_dwordx4 v6, s[20:23], s79 offen lds
    s_waitcnt lgkmcnt(2)
    v_mfma_f32_32x32x16_bf16 v[140:155], v[176:179], v[48:51], v[140:155]
    ds_read_b64_tr_b16 v[188:189], v214 offset:64512
    ds_read_b64_tr_b16 v[190:191], v214 offset:64768
    v_mfma_f32_16x16x32_bf16 v[216:219], a[248:251], v[180:183], v[216:219]
    v_add_u32 v214, 65536, v214
    ds_read_b64_tr_b16 v[172:173], v214 offset:0
    ds_read_b64_tr_b16 v[174:175], v214 offset:256
    s_waitcnt lgkmcnt(2)
    v_mfma_f32_32x32x16_bf16 v[140:155], v[184:187], v[52:55], v[140:155]
    ds_read_b64_tr_b16 v[176:177], v214 offset:1024
    ds_read_b64_tr_b16 v[178:179], v214 offset:1280
    v_mfma_f32_32x32x16_bf16 v[140:155], v[188:191], v[56:59], v[140:155]
    v_add_u32 v236, 65536, v236
    ds_read_b64_tr_b16 v[180:181], v236 offset:0
    ds_read_b64_tr_b16 v[182:183], v236 offset:256
    s_waitcnt lgkmcnt(2)
    v_mfma_f32_32x32x16_bf16 v[140:155], v[172:175], v[60:63], v[140:155]
    ds_read_b64_tr_b16 v[184:185], v214 offset:2048
    ds_read_b64_tr_b16 v[186:187], v214 offset:2304
    v_mfma_f32_32x32x16_bf16 v[140:155], v[176:179], v[64:67], v[140:155]
    ds_read_b64_tr_b16 v[188:189], v214 offset:3072
    ds_read_b64_tr_b16 v[190:191], v214 offset:3328
    s_add_u32 m0, s62, 40960
    s_add_u32 s79, s67, 401408
    buffer_load_dwordx4 v6, s[20:23], s79 offen lds
    s_waitcnt lgkmcnt(2)
    v_mfma_f32_16x16x32_bf16 v[216:219], a[248:251], v[180:183], v[216:219]
    ds_read_b64_tr_b16 v[172:173], v214 offset:4096
    ds_read_b64_tr_b16 v[174:175], v214 offset:4352
    v_mfma_f32_32x32x16_bf16 v[140:155], v[184:187], v[68:71], v[140:155]
    ds_read_b64_tr_b16 v[176:177], v214 offset:5120
    ds_read_b64_tr_b16 v[178:179], v214 offset:5376
    s_waitcnt lgkmcnt(2)
    v_mfma_f32_32x32x16_bf16 v[140:155], v[188:191], v[72:75], v[140:155]
    ds_read_b64_tr_b16 v[180:181], v236 offset:4096
    ds_read_b64_tr_b16 v[182:183], v236 offset:4352
    v_mfma_f32_32x32x16_bf16 v[140:155], v[172:175], v[76:79], v[140:155]
    ds_read_b64_tr_b16 v[184:185], v214 offset:6144
    ds_read_b64_tr_b16 v[186:187], v214 offset:6400
    s_waitcnt lgkmcnt(2)
    v_mfma_f32_32x32x16_bf16 v[140:155], v[176:179], v[80:83], v[140:155]
    ds_read_b64_tr_b16 v[188:189], v214 offset:7168
    ds_read_b64_tr_b16 v[190:191], v214 offset:7424
    v_mfma_f32_16x16x32_bf16 v[216:219], a[248:251], v[180:183], v[216:219]
    ds_read_b64_tr_b16 v[172:173], v214 offset:8192
    ds_read_b64_tr_b16 v[174:175], v214 offset:8448
    s_waitcnt lgkmcnt(2)
    v_mfma_f32_32x32x16_bf16 v[140:155], v[184:187], v[84:87], v[140:155]
    ds_read_b64_tr_b16 v[176:177], v214 offset:9216
    ds_read_b64_tr_b16 v[178:179], v214 offset:9472
    s_add_u32 m0, s62, 45056
    s_add_u32 s79, s67, 401536
    buffer_load_dwordx4 v6, s[20:23], s79 offen lds
    v_mfma_f32_32x32x16_bf16 v[140:155], v[188:191], v[88:91], v[140:155]
    ds_read_b64_tr_b16 v[180:181], v236 offset:8192
    ds_read_b64_tr_b16 v[182:183], v236 offset:8448
    s_waitcnt lgkmcnt(2)
    v_mfma_f32_32x32x16_bf16 v[140:155], v[172:175], v[92:95], v[140:155]
    ds_read_b64_tr_b16 v[184:185], v214 offset:10240
    ds_read_b64_tr_b16 v[186:187], v214 offset:10496
    v_mfma_f32_32x32x16_bf16 v[140:155], v[176:179], v[96:99], v[140:155]
    ds_read_b64_tr_b16 v[188:189], v214 offset:11264
    ds_read_b64_tr_b16 v[190:191], v214 offset:11520
    s_waitcnt lgkmcnt(2)
    v_mfma_f32_16x16x32_bf16 v[216:219], a[248:251], v[180:183], v[216:219]
    ds_read_b64_tr_b16 v[172:173], v214 offset:12288
    ds_read_b64_tr_b16 v[174:175], v214 offset:12544
    v_mfma_f32_32x32x16_bf16 v[140:155], v[184:187], v[100:103], v[140:155]
    ds_read_b64_tr_b16 v[176:177], v214 offset:13312
    ds_read_b64_tr_b16 v[178:179], v214 offset:13568
    s_add_u32 m0, s62, 49152
    s_add_u32 s79, s67, 458752
    buffer_load_dwordx4 v6, s[20:23], s79 offen lds
    s_waitcnt lgkmcnt(2)
    v_mfma_f32_32x32x16_bf16 v[140:155], v[188:191], v[104:107], v[140:155]
    ds_read_b64_tr_b16 v[180:181], v236 offset:12288
    ds_read_b64_tr_b16 v[182:183], v236 offset:12544
    v_mfma_f32_32x32x16_bf16 v[140:155], v[172:175], v[108:111], v[140:155]
    ds_read_b64_tr_b16 v[184:185], v214 offset:14336
    ds_read_b64_tr_b16 v[186:187], v214 offset:14592
    s_waitcnt lgkmcnt(2)
    v_mfma_f32_32x32x16_bf16 v[140:155], v[176:179], v[112:115], v[140:155]
    ds_read_b64_tr_b16 v[188:189], v214 offset:15360
    ds_read_b64_tr_b16 v[190:191], v214 offset:15616
    v_mfma_f32_16x16x32_bf16 v[216:219], a[248:251], v[180:183], v[216:219]
    ds_read_b64_tr_b16 v[172:173], v214 offset:16384
    ds_read_b64_tr_b16 v[174:175], v214 offset:16640
    s_waitcnt lgkmcnt(2)
    v_mfma_f32_32x32x16_bf16 v[140:155], v[184:187], v[116:119], v[140:155]
    ds_read_b64_tr_b16 v[176:177], v214 offset:17408
    ds_read_b64_tr_b16 v[178:179], v214 offset:17664
    v_mfma_f32_32x32x16_bf16 v[140:155], v[188:191], v[120:123], v[140:155]
    ds_read_b64_tr_b16 v[180:181], v236 offset:16384
    ds_read_b64_tr_b16 v[182:183], v236 offset:16640
    s_add_u32 m0, s62, 53248
    s_add_u32 s79, s67, 458880
    buffer_load_dwordx4 v6, s[20:23], s79 offen lds
    s_waitcnt lgkmcnt(2)
    v_mfma_f32_32x32x16_bf16 v[140:155], v[172:175], v[124:127], v[140:155]
    ds_read_b64_tr_b16 v[184:185], v214 offset:18432
    ds_read_b64_tr_b16 v[186:187], v214 offset:18688
    v_mfma_f32_32x32x16_bf16 v[140:155], v[176:179], v[128:131], v[140:155]
    ds_read_b64_tr_b16 v[188:189], v214 offset:19456
    ds_read_b64_tr_b16 v[190:191], v214 offset:19712
    s_waitcnt lgkmcnt(2)
    v_mfma_f32_16x16x32_bf16 v[216:219], a[248:251], v[180:183], v[216:219]
    v_mfma_f32_32x32x16_bf16 v[140:155], v[184:187], v[132:135], v[140:155]
    s_waitcnt lgkmcnt(0)
    v_mfma_f32_32x32x16_bf16 v[140:155], v[188:191], v[136:139], v[140:155]
    s_mov_b64 exec, 0xffff
    s_nop 3
    ds_write_b32 v237, v216 offset:256
    s_mov_b64 exec, -1
    s_waitcnt lgkmcnt(0)
    s_barrier
    s_lshl_b32 s69, s58, 2
    s_add_u32 s69, s69, s56
    s_mul_i32 s69, s69, 4864
    s_add_u32 s69, s69, s63
    s_add_u32 s69, s69, 0x1000
    v_lshlrev_b32 v194, 7, v1
    s_cmp_lg_u32 s61, 0
    s_cbranch_scc1 L_nopre
    s_mov_b32 exec_hi, 0x3f
    buffer_load_dword a0, v194, s[32:35], s69 offen
    s_mov_b64 exec, -1
L_nopre:
    ds_read_b32 v216, v238 offset:256
    s_waitcnt lgkmcnt(0)
    v_cvt_pk_bf16_f32 v194, v216, v216
    v_lshlrev_b32 v194, 16, v194
    v_sub_f32 v194, v216, v194
    v_cvt_pk_bf16_f32 v194, v216, v194
    v_accvgpr_write_b32 a14, v194
    s_nop 1
    v_mfma_f32_32x32x16_bf16 v[140:155], a[14:17], v[24:27], v[140:155]
    s_nop 11
    v_cvt_pk_bf16_f32 v172, v140, v141
    v_cvt_pk_bf16_f32 v173, v142, v143
    v_cvt_pk_bf16_f32 v174, v144, v145
    v_cvt_pk_bf16_f32 v175, v146, v147
    v_cvt_pk_bf16_f32 v176, v148, v149
    v_cvt_pk_bf16_f32 v177, v150, v151
    v_cvt_pk_bf16_f32 v178, v152, v153
    v_cvt_pk_bf16_f32 v179, v154, v155
    v_mfma_f32_32x32x16_bf16 v[220:235], a[2:5], v[172:175], 0
    s_nop 0
    v_mfma_f32_32x32x16_bf16 v[220:235], a[6:9], v[176:179], v[220:235]
    s_waitcnt vmcnt(23)
    v_permlane32_swap_b32 v8, v10
    v_permlane32_swap_b32 v9, v11
    v_permlane32_swap_b32 v12, v14
    v_permlane32_swap_b32 v13, v15
    v_and_b32 v23, 0xffff0000, v15
    v_lshlrev_b32 v22, 16, v15
    v_and_b32 v21, 0xffff0000, v14
    v_lshlrev_b32 v20, 16, v14
    v_and_b32 v19, 0xffff0000, v13
    v_lshlrev_b32 v18, 16, v13
    v_and_b32 v17, 0xffff0000, v12
    v_lshlrev_b32 v16, 16, v12
    v_and_b32 v15, 0xffff0000, v11
    v_lshlrev_b32 v14, 16, v11
    v_and_b32 v13, 0xffff0000, v10
    v_lshlrev_b32 v12, 16, v10
    v_and_b32 v11, 0xffff0000, v9
    v_lshlrev_b32 v10, 16, v9
    v_and_b32 v9, 0xffff0000, v8
    v_lshlrev_b32 v8, 16, v8
    v_lshlrev_b32 v194, 2, v1
    v_and_b32 v195, 3, v1
    v_lshlrev_b32 v195, 11, v195
    s_lshl_b32 s70, s56, 4
    s_add_u32 s70, s70, s58
    s_lshl_b32 s70, s70, 11
    s_add_u32 s70, s70, s63
    s_add_u32 s70, s70, 0x10000
    s_lshl_b32 s90, s56, 7
    s_add_u32 s90, s90, s63
    s_mul_i32 s72, s58, 4
    s_add_u32 s90, s90, s72
    s_add_u32 s90, s90, 0
    s_add_u32 s71, s89, 4096
    s_add_u32 m0, s62, 57344
    s_add_u32 s79, s67, 516096
    buffer_load_dwordx4 v6, s[20:23], s79 offen lds
    v_max3_f32 v200, v220, v221, v222
    v_min3_f32 v201, v220, v221, v222
    v_max3_f32 v200, v200, v223, v224
    v_min3_f32 v201, v201, v223, v224
    v_max3_f32 v200, v200, v225, v226
    v_min3_f32 v201, v201, v225, v226
    v_max3_f32 v200, v200, v227, v228
    v_min3_f32 v201, v201, v227, v228
    v_max3_f32 v200, v200, v229, v230
    v_min3_f32 v201, v201, v229, v230
    v_max3_f32 v200, v200, v231, v232
    v_min3_f32 v201, v201, v231, v232
    v_max_f32 v200, v200, v233
    v_min_f32 v201, v201, v233
    v_mov_b32 v202, v200
    v_mov_b32 v203, v201
    v_mov_b32 v163, 0
    s_add_u32 m0, s62, 61440
    s_add_u32 s79, s67, 516224
    buffer_load_dwordx4 v6, s[20:23], s79 offen lds
    v_permlane32_swap_b32 v202, v200
    v_permlane32_swap_b32 v203, v201
    v_max_f32 v200, v202, v200
    v_min_f32 v201, v203, v201
    v_mul_f32 v204, -v210, v200
    v_mul_f32 v206, v210, v201
    v_pk_fma_f32 v[140:141], v[220:221], v[210:211], v[204:205] op_sel_hi:[1,0,0]
    v_pk_fma_f32 v[142:143], v[222:223], v[210:211], v[204:205] op_sel_hi:[1,0,0]
    v_pk_fma_f32 v[144:145], v[224:225], v[210:211], v[204:205] op_sel_hi:[1,0,0]
    v_pk_fma_f32 v[146:147], v[226:227], v[210:211], v[204:205] op_sel_hi:[1,0,0]
    v_pk_fma_f32 v[148:149], v[228:229], v[210:211], v[204:205] op_sel_hi:[1,0,0]
    v_pk_fma_f32 v[150:151], v[230:231], v[210:211], v[204:205] op_sel_hi:[1,0,0]
    v_pk_fma_f32 v[152:153], v[232:233], v[210:211], v[204:205] op_sel_hi:[1,0,0]
    v_pk_fma_f32 v[220:221], v[220:221], v[210:211], v[206:207] op_sel_hi:[1,0,0] neg_lo:[0,1,0] neg_hi:[0,1,0]
    v_pk_fma_f32 v[222:223], v[222:223], v[210:211], v[206:207] op_sel_hi:[1,0,0] neg_lo:[0,1,0] neg_hi:[0,1,0]
    v_pk_fma_f32 v[224:225], v[224:225], v[210:211], v[206:207] op_sel_hi:[1,0,0] neg_lo:[0,1,0] neg_hi:[0,1,0]
    v_pk_fma_f32 v[226:227], v[226:227], v[210:211], v[206:207] op_sel_hi:[1,0,0] neg_lo:[0,1,0] neg_hi:[0,1,0]
    s_add_u32 m0, s62, 65536
    s_add_u32 s79, s67, 573440
    buffer_load_dwordx4 v6, s[20:23], s79 offen lds
    v_pk_fma_f32 v[228:229], v[228:229], v[210:211], v[206:207] op_sel_hi:[1,0,0] neg_lo:[0,1,0] neg_hi:[0,1,0]
    v_pk_fma_f32 v[230:231], v[230:231], v[210:211], v[206:207] op_sel_hi:[1,0,0] neg_lo:[0,1,0] neg_hi:[0,1,0]
    v_pk_fma_f32 v[232:233], v[232:233], v[210:211], v[206:207] op_sel_hi:[1,0,0] neg_lo:[0,1,0] neg_hi:[0,1,0]
    v_exp_f32 v140, v140
    v_exp_f32 v141, v141
    v_exp_f32 v142, v142
    v_exp_f32 v143, v143
    v_exp_f32 v144, v144
    v_exp_f32 v145, v145
    v_exp_f32 v146, v146
    v_exp_f32 v147, v147
    v_exp_f32 v148, v148
    v_exp_f32 v149, v149
    v_exp_f32 v150, v150
    v_exp_f32 v151, v151
    v_exp_f32 v152, v152
    s_add_u32 m0, s62, 69632
    s_add_u32 s79, s67, 573568
    buffer_load_dwordx4 v6, s[20:23], s79 offen lds
    v_exp_f32 v153, v153
    v_exp_f32 v220, v220
    v_exp_f32 v221, v221
    v_exp_f32 v222, v222
    v_exp_f32 v223, v223
    v_exp_f32 v224, v224
    v_exp_f32 v225, v225
    v_exp_f32 v226, v226
    v_exp_f32 v227, v227
    v_exp_f32 v228, v228
    v_exp_f32 v229, v229
    v_exp_f32 v230, v230
    v_exp_f32 v231, v231
    v_exp_f32 v232, v232
    v_exp_f32 v233, v233
    v_pk_add_f32 v[200:201], v[140:141], v[142:143]
    v_pk_add_f32 v[202:203], v[220:221], v[222:223]
    s_add_u32 m0, s62, 73728
    s_add_u32 s79, s67, 630784
    buffer_load_dwordx4 v6, s[20:23], s79 offen lds
    v_pk_add_f32 v[200:201], v[200:201], v[144:145]
    v_pk_add_f32 v[202:203], v[202:203], v[224:225]
    v_pk_add_f32 v[200:201], v[200:201], v[146:147]
    v_pk_add_f32 v[202:203], v[202:203], v[226:227]
    v_pk_add_f32 v[200:201], v[200:201], v[148:149]
    v_pk_add_f32 v[202:203], v[202:203], v[228:229]
    v_pk_add_f32 v[200:201], v[200:201], v[150:151]
    v_pk_add_f32 v[202:203], v[202:203], v[230:231]
    v_pk_add_f32 v[200:201], v[200:201], v[152:153]
    v_pk_add_f32 v[202:203], v[202:203], v[232:233]
    v_add_f32 v200, v200, v201
    v_add_f32 v202, v202, v203
    v_mov_b32 v204, v200
    v_mov_b32 v206, v202
    v_mov_b32 v171, 0
    v_permlane32_swap_b32 v204, v200
    s_add_u32 m0, s62, 77824
    s_add_u32 s79, s67, 630912
    buffer_load_dwordx4 v6, s[20:23], s79 offen lds
    v_permlane32_swap_b32 v206, v202
    v_add_f32 v200, v200, v204
    v_add_f32 v202, v202, v206
    v_rcp_f32 v200, v200
    v_rcp_f32 v202, v202
    v_pk_mul_f32 v[140:141], v[140:141], v[200:201] op_sel_hi:[1,0]
    v_pk_mul_f32 v[142:143], v[142:143], v[200:201] op_sel_hi:[1,0]
    v_pk_mul_f32 v[144:145], v[144:145], v[200:201] op_sel_hi:[1,0]
    v_pk_mul_f32 v[146:147], v[146:147], v[200:201] op_sel_hi:[1,0]
    v_pk_mul_f32 v[148:149], v[148:149], v[200:201] op_sel_hi:[1,0]
    v_pk_mul_f32 v[150:151], v[150:151], v[200:201] op_sel_hi:[1,0]
    v_pk_mul_f32 v[152:153], v[152:153], v[200:201] op_sel_hi:[1,0]
    v_cvt_pk_bf16_f32 v156, v140, v141
    v_cvt_pk_bf16_f32 v157, v142, v143
    v_cvt_pk_bf16_f32 v158, v144, v145
    v_cvt_pk_bf16_f32 v159, v146, v147
    v_cvt_pk_bf16_f32 v160, v148, v149
    s_add_u32 m0, s62, 81920
    s_add_u32 s79, s67, 688128
    buffer_load_dwordx4 v6, s[20:23], s79 offen lds
    v_cvt_pk_bf16_f32 v161, v150, v151
    v_cvt_pk_bf16_f32 v162, v152, v153
    v_pk_mul_f32 v[220:221], v[220:221], v[202:203] op_sel_hi:[1,0]
    v_pk_mul_f32 v[222:223], v[222:223], v[202:203] op_sel_hi:[1,0]
    v_pk_mul_f32 v[224:225], v[224:225], v[202:203] op_sel_hi:[1,0]
    v_pk_mul_f32 v[226:227], v[226:227], v[202:203] op_sel_hi:[1,0]
    v_pk_mul_f32 v[228:229], v[228:229], v[202:203] op_sel_hi:[1,0]
    v_pk_mul_f32 v[230:231], v[230:231], v[202:203] op_sel_hi:[1,0]
    v_pk_mul_f32 v[232:233], v[232:233], v[202:203] op_sel_hi:[1,0]
    v_cvt_pk_bf16_f32 v164, v220, v221
    v_cvt_pk_bf16_f32 v165, v222, v223
    v_cvt_pk_bf16_f32 v166, v224, v225
    v_cvt_pk_bf16_f32 v167, v226, v227
    v_cvt_pk_bf16_f32 v168, v228, v229
    v_cvt_pk_bf16_f32 v169, v230, v231
    v_cvt_pk_bf16_f32 v170, v232, v233
    s_mov_b32 s30, 1835008
    s_mov_b32 s31, 0x20000
    s_and_b32 s50, s56, 1
    s_lshl_b32 s51, s60, 7
    s_mul_i32 s68, s50, 7168
    s_mul_i32 s50, s76, 802816
    s_add_u32 s68, s68, s50
    s_add_u32 s68, s68, s51
    s_add_u32 s87, s76, s59
    s_and_b32 s87, s87, 1
    s_mul_i32 s50, s87, 688128
    s_sub_u32 s86, s68, s50
    s_mul_i32 s50, s87, 114688
    s_add_u32 s68, s68, s50
    v_accvgpr_write_b32 a19, 0
    v_accvgpr_write_b32 a21, 0
    v_accvgpr_write_b32 a22, 0
    v_accvgpr_write_b32 a23, 0
    s_mov_b32 s73, 0
    s_mov_b32 s72, 0x41800000
    s_waitcnt vmcnt(0)
    s_branch L_kv_108_go
L_kv_108:
    buffer_load_dword v197, v195, s[32:35], s89 offen offset:892 sc1
    s_waitcnt vmcnt(0)
    v_cmp_eq_u32 s[44:45], s72, v197
    s_add_u32 s73, s73, 1
    s_cmp_eq_u64 s[44:45], -1
    s_cbranch_scc1 L_kv_108_go
    s_sleep 1
    s_cmp_lt_u32 s73, 262144
    s_cbranch_scc1 L_kv_108
L_kv_108_go:
    buffer_load_dword v28, v194, s[32:35], s89 offen offset:0 sc1
    buffer_load_dword v29, v194, s[32:35], s89 offen offset:256 sc1
    buffer_load_dword v30, v194, s[32:35], s89 offen offset:512 sc1
    buffer_load_dword v31, v194, s[32:35], s89 offen offset:768 sc1
    buffer_load_dword v32, v194, s[32:35], s89 offen offset:1024 sc1
    buffer_load_dword v33, v194, s[32:35], s89 offen offset:1280 sc1
    buffer_load_dword v34, v194, s[32:35], s89 offen offset:1536 sc1
    buffer_load_dword v35, v194, s[32:35], s89 offen offset:1792 sc1
    buffer_load_dword v36, v194, s[32:35], s89 offen offset:2048 sc1
    buffer_load_dword v37, v194, s[32:35], s89 offen offset:2304 sc1
    buffer_load_dword v38, v194, s[32:35], s89 offen offset:2560 sc1
    buffer_load_dword v39, v194, s[32:35], s89 offen offset:2816 sc1
    buffer_load_dword v40, v194, s[32:35], s89 offen offset:3072 sc1
    buffer_load_dword v41, v194, s[32:35], s89 offen offset:3328 sc1
    buffer_load_dword v44, v194, s[32:35], s71 offen offset:0 sc1
    buffer_load_dword v45, v194, s[32:35], s71 offen offset:256 sc1
    buffer_load_dword v46, v194, s[32:35], s71 offen offset:512 sc1
    buffer_load_dword v47, v194, s[32:35], s71 offen offset:768 sc1
    buffer_load_dword v48, v194, s[32:35], s71 offen offset:1024 sc1
    buffer_load_dword v49, v194, s[32:35], s71 offen offset:1280 sc1
    buffer_load_dword v50, v194, s[32:35], s71 offen offset:1536 sc1
    buffer_load_dword v51, v194, s[32:35], s71 offen offset:1792 sc1
    buffer_load_dword v52, v194, s[32:35], s71 offen offset:2048 sc1
    buffer_load_dword v53, v194, s[32:35], s71 offen offset:2304 sc1
    buffer_load_dword v54, v194, s[32:35], s71 offen offset:2560 sc1
    buffer_load_dword v55, v194, s[32:35], s71 offen offset:2816 sc1
    buffer_load_dword v56, v194, s[32:35], s71 offen offset:3072 sc1
    buffer_load_dword v57, v194, s[32:35], s71 offen offset:3328 sc1
    v_mov_b32 v67, 0
    v_mov_b32 v75, 0
    s_waitcnt vmcnt(20)
    v_cvt_pk_bf16_f32 v60, v28, v29
    v_cvt_pk_bf16_f32 v61, v30, v31
    v_cvt_pk_bf16_f32 v62, v32, v33
    v_cvt_pk_bf16_f32 v63, v34, v35
    s_nop 1
    v_mfma_f32_32x32x16_bf16 v[220:235], v[60:63], v[156:159], 0
    v_min_f32 v197, v28, v29
    v_min3_f32 v197, v197, v30, v31
    v_min3_f32 v197, v197, v32, v33
    v_min3_f32 v197, v197, v34, v35
    s_waitcnt vmcnt(14)
    v_cvt_pk_bf16_f32 v64, v36, v37
    v_cvt_pk_bf16_f32 v65, v38, v39
    v_cvt_pk_bf16_f32 v66, v40, v41
    s_nop 1
    v_mfma_f32_32x32x16_bf16 v[220:235], v[64:67], v[160:163], v[220:235]
    v_min3_f32 v197, v197, v36, v37
    v_min3_f32 v197, v197, v38, v39
    v_min3_f32 v197, v197, v40, v41
    s_waitcnt vmcnt(6)
    v_cvt_pk_bf16_f32 v68, v44, v45
    v_cvt_pk_bf16_f32 v69, v46, v47
    v_cvt_pk_bf16_f32 v70, v48, v49
    v_cvt_pk_bf16_f32 v71, v50, v51
    s_nop 1
    v_mfma_f32_32x32x16_bf16 v[220:235], v[68:71], v[164:167], v[220:235]
    v_min3_f32 v197, v197, v44, v45
    v_min3_f32 v197, v197, v46, v47
    v_min3_f32 v197, v197, v48, v49
    v_min3_f32 v197, v197, v50, v51
    s_waitcnt vmcnt(0)
    v_cvt_pk_bf16_f32 v72, v52, v53
    v_cvt_pk_bf16_f32 v73, v54, v55
    v_cvt_pk_bf16_f32 v74, v56, v57
    s_nop 1
    v_mfma_f32_32x32x16_bf16 v[220:235], v[72:75], v[168:171], v[220:235]
    v_min3_f32 v197, v197, v52, v53
    v_min3_f32 v197, v197, v54, v55
    v_min3_f32 v197, v197, v56, v57
    v_cmp_ne_u32 s[44:45], s72, v197
    s_add_u32 s73, s73, 1
    s_or_b32 s44, s44, s45
    s_and_b32 s44, s44, 0x80004000
    s_cselect_b32 s79, s73, 262144
    s_cmp_lt_u32 s79, 262144
    s_cbranch_scc1 L_kv_108
    s_nop 1
    v_mov_b32 v194, v234
    v_mov_b32 v196, v234
    s_nop 1
    v_permlane32_swap_b32 v194, v196
    v_add_f32 v196, 0x358637bd, v196
    v_rcp_f32 v196, v196
    s_nop 0
    v_pk_mul_f32 v[220:221], v[220:221], v[196:197] op_sel_hi:[1,0]
    v_pk_mul_f32 v[222:223], v[222:223], v[196:197] op_sel_hi:[1,0]
    v_pk_mul_f32 v[224:225], v[224:225], v[196:197] op_sel_hi:[1,0]
    v_pk_mul_f32 v[226:227], v[226:227], v[196:197] op_sel_hi:[1,0]
    v_pk_mul_f32 v[228:229], v[228:229], v[196:197] op_sel_hi:[1,0]
    v_pk_mul_f32 v[230:231], v[230:231], v[196:197] op_sel_hi:[1,0]
    v_pk_mul_f32 v[232:233], v[232:233], v[196:197] op_sel_hi:[1,0]
    v_pk_mul_f32 v[234:235], v[234:235], v[196:197] op_sel_hi:[1,0]
    v_cvt_pk_bf16_f32 v172, v220, v221
    v_cvt_pk_bf16_f32 v173, v222, v223
    v_cvt_pk_bf16_f32 v174, v224, v225
    v_cvt_pk_bf16_f32 v175, v226, v227
    v_cvt_pk_bf16_f32 v176, v228, v229
    v_cvt_pk_bf16_f32 v177, v230, v231
    v_cvt_pk_bf16_f32 v178, v232, v233
    v_cvt_pk_bf16_f32 v179, v234, v235
    v_cndmask_b32 v175, v175, 0, s[38:39]
    v_cndmask_b32 v179, v179, 0, s[38:39]
    s_cmp_lg_u32 s61, 0
    s_cbranch_scc1 L_var1_wt
    buffer_store_dwordx4 v[172:175], v2, s[32:35], s70 offen offset:0
    buffer_store_dwordx4 v[176:179], v2, s[32:35], s70 offen offset:1024
L_var1_end:
    s_cmp_ge_u32 s58, 14
    s_cbranch_scc1 L_idle0
L_c_k2b0:
    v_lshrrev_b32 v28, 4, v1
    v_bfe_u32 v29, v1, 2, 2
    v_and_b32 v30, 3, v1
    v_and_b32 v31, 1, v28
    v_and_b32 v34, 15, v1
    v_cmp_eq_u32 vcc, v34, v31
    v_mov_b32 v35, 0x3f803f80
    s_nop 0
    v_cndmask_b32 v34, 0, v35, vcc
    v_mov_b32 v35, v34
    v_mov_b32 v36, v34
    v_mov_b32 v37, v34
    v_lshrrev_b32 v28, 1, v28
    v_lshl_add_u32 v28, v28, 2, v29
    v_lshlrev_b32 v28, 7, v28
    v_lshl_add_u32 v28, v31, 11, v28
    v_and_b32 v29, 2, v29
    v_lshl_add_u32 v29, v31, 2, v29
    v_lshrrev_b32 v31, 1, v30
    v_xor_b32 v29, v29, v31
    s_lshl_b32 s71, s56, 1
    v_xor_b32 v29, s71, v29
    v_lshl_add_u32 v28, v29, 4, v28
    v_and_b32 v30, 1, v30
    v_lshl_add_u32 v32, v30, 3, v28
    v_lshrrev_b32 v28, 4, v1
    v_bfe_u32 v29, v1, 2, 2
    v_and_b32 v30, 3, v1
    v_and_b32 v31, 1, v28
    v_lshlrev_b32 v31, 1, v31
    v_lshrrev_b32 v166, 1, v30
    v_add_u32 v31, v31, v166
    v_and_b32 v166, 2, v29
    v_lshlrev_b32 v166, 1, v166
    v_xor_b32 v31, v31, v166
    v_lshlrev_b32 v31, 4, v31
    v_and_b32 v30, 1, v30
    v_lshl_add_u32 v31, v30, 3, v31
    v_lshrrev_b32 v28, 1, v28
    v_lshl_add_u32 v29, v28, 2, v29
    v_lshl_add_u32 v33, v29, 7, v31
    v_xor_b32 v166, 64, v33
    s_mul_i32 s69, s76, 28672
    s_lshl_b32 s71, s76, 6
    v_xor_b32 v33, s71, v33
    v_add_u32 v33, s69, v33
    v_xor_b32 v166, s71, v166
    v_add_u32 v166, s69, v166
    v_and_b32 v28, 40, v1
    v_cmp_eq_u32 vcc, 40, v28
    v_add_u32 v28, -256, v33
    v_add_u32 v29, -256, v166
    v_cndmask_b32 v167, v166, v28, vcc
    v_cndmask_b32 v168, v33, v29, vcc
    s_lshl_b32 s88, s56, 12
    s_add_u32 s88, s88, 86016
    v_add_u32 v28, s88, v2
    s_xor_b32 s88, s56, 2
    s_lshl_b32 s88, s88, 12
    s_add_u32 s88, s88, 86016
    v_add_u32 v29, s88, v2
    s_mul_i32 s88, s75, 28672
    s_lshl_b32 s91, s60, 12
    s_add_u32 s88, s88, s91
    s_lshl_b32 s91, s76, 11
    s_add_u32 s88, s88, s91
    s_add_u32 s88, s88, s63
    s_add_u32 s88, s88, 0x30000
    s_lshl_b32 s89, s60, 1
    s_add_u32 s89, s89, s76
    s_lshl_b32 s91, s75, 7
    s_add_u32 s91, s91, s63
    s_mul_i32 s72, s89, 4
    s_add_u32 s91, s91, s72
    s_add_u32 s91, s91, 512
    s_cmp_ge_u32 s89, 7
    s_cselect_b32 s72, 7, 0
    s_sub_u32 s89, s89, s72
    s_mul_i32 s72, s72, 73
    s_add_u32 s72, s72, 1
    s_and_b32 s72, s72, 512
    s_lshr_b32 s79, s89, 1
    s_lshl_b32 s79, s79, 10
    s_add_u32 s72, s72, s79
    s_and_b32 s89, s89, 1
    s_lshl_b32 s89, s89, 3
    s_add_u32 s89, s89, s72
    s_lshl_b32 s72, s75, 12
    s_add_u32 s89, s89, s72
    s_add_u32 s89, s89, s63
    s_add_u32 s89, s89, 0x1000
    v_and_b32 v30, 31, v1
    v_lshlrev_b32 v30, 4, v30
    s_lshl_b32 s70, s75, 15
    s_lshl_b32 s71, s76, 14
    s_add_u32 s70, s70, s71
    s_add_u32 s70, s70, s63
    s_waitcnt vmcnt(0)
    v_mov_b32 v7, 1
    s_mov_b64 exec, 1
    s_cmp_lg_u32 s61, 0
    s_cbranch_scc1 L_var2_wt
    buffer_store_dword v7, off, s[32:35], s90
L_var2_end:
    s_mov_b64 exec, -1
    s_barrier
    v_add_u32 v32, 143360, v32
    ds_read_b64_tr_b16 a[24:25], v32 offset:0
    ds_read_b64_tr_b16 a[26:27], v32 offset:1024
    ds_read_b64_tr_b16 a[28:29], v32 offset:4096
    ds_read_b64_tr_b16 a[30:31], v32 offset:5120
    ds_read_b64_tr_b16 a[32:33], v32 offset:8192
    ds_read_b64_tr_b16 a[34:35], v32 offset:9216
    ds_read_b64_tr_b16 a[36:37], v32 offset:12288
    ds_read_b64_tr_b16 a[38:39], v32 offset:13312
    v_add_u32 v32, 4294823936, v32
    ds_read_b64_tr_b16 a[40:41], v32 offset:0
    ds_read_b64_tr_b16 a[42:43], v32 offset:1024
    s_waitcnt lgkmcnt(8)
    v_mfma_f32_16x16x32_bf16 v[38:41], v[34:37], a[24:27], 0
    ds_read_b64_tr_b16 a[44:45], v32 offset:4096
    ds_read_b64_tr_b16 a[46:47], v32 offset:5120
    s_waitcnt lgkmcnt(8)
    v_mfma_f32_16x16x32_bf16 v[42:45], v[34:37], a[28:31], 0
    ds_read_b64_tr_b16 a[48:49], v32 offset:8192
    ds_read_b64_tr_b16 a[50:51], v32 offset:9216
    s_waitcnt lgkmcnt(8)
    v_mfma_f32_16x16x32_bf16 v[38:41], v[34:37], a[32:35], v[38:41]
    ds_read_b64_tr_b16 a[52:53], v32 offset:12288
    ds_read_b64_tr_b16 a[54:55], v32 offset:13312
    s_waitcnt lgkmcnt(8)
    v_mfma_f32_16x16x32_bf16 v[42:45], v[34:37], a[36:39], v[42:45]
    ds_read_b64_tr_b16 a[56:57], v32 offset:16384
    ds_read_b64_tr_b16 a[58:59], v32 offset:17408
    s_waitcnt lgkmcnt(8)
    v_mfma_f32_16x16x32_bf16 v[38:41], v[34:37], a[40:43], v[38:41]
    ds_read_b64_tr_b16 a[60:61], v32 offset:20480
    ds_read_b64_tr_b16 a[62:63], v32 offset:21504
    s_waitcnt lgkmcnt(8)
    v_mfma_f32_16x16x32_bf16 v[42:45], v[34:37], a[44:47], v[42:45]
    ds_read_b64_tr_b16 a[64:65], v32 offset:24576
    ds_read_b64_tr_b16 a[66:67], v32 offset:25600
    s_waitcnt lgkmcnt(8)
    v_mfma_f32_16x16x32_bf16 v[38:41], v[34:37], a[48:51], v[38:41]
    ds_read_b64_tr_b16 a[68:69], v32 offset:28672
    ds_read_b64_tr_b16 a[70:71], v32 offset:29696
    s_waitcnt lgkmcnt(8)
    v_mfma_f32_16x16x32_bf16 v[42:45], v[34:37], a[52:55], v[42:45]
    ds_read_b64_tr_b16 a[72:73], v32 offset:32768
    ds_read_b64_tr_b16 a[74:75], v32 offset:33792
    s_waitcnt lgkmcnt(8)
    v_mfma_f32_16x16x32_bf16 v[38:41], v[34:37], a[56:59], v[38:41]
    ds_read_b64_tr_b16 a[76:77], v32 offset:36864
    ds_read_b64_tr_b16 a[78:79], v32 offset:37888
    s_waitcnt lgkmcnt(8)
    v_mfma_f32_16x16x32_bf16 v[42:45], v[34:37], a[60:63], v[42:45]
    ds_read_b64_tr_b16 a[80:81], v32 offset:40960
    ds_read_b64_tr_b16 a[82:83], v32 offset:41984
    s_waitcnt lgkmcnt(8)
    v_mfma_f32_16x16x32_bf16 v[38:41], v[34:37], a[64:67], v[38:41]
    ds_read_b64_tr_b16 a[84:85], v32 offset:45056
    ds_read_b64_tr_b16 a[86:87], v32 offset:46080
    s_waitcnt lgkmcnt(8)
    v_mfma_f32_16x16x32_bf16 v[42:45], v[34:37], a[68:71], v[42:45]
    ds_read_b64_tr_b16 a[88:89], v32 offset:49152
    ds_read_b64_tr_b16 a[90:91], v32 offset:50176
    s_waitcnt lgkmcnt(8)
    v_mfma_f32_16x16x32_bf16 v[38:41], v[34:37], a[72:75], v[38:41]
    ds_read_b64_tr_b16 a[92:93], v32 offset:53248
    ds_read_b64_tr_b16 a[94:95], v32 offset:54272
    s_waitcnt lgkmcnt(8)
    v_mfma_f32_16x16x32_bf16 v[42:45], v[34:37], a[76:79], v[42:45]
    ds_read_b64_tr_b16 a[96:97], v32 offset:57344
    ds_read_b64_tr_b16 a[98:99], v32 offset:58368
    s_waitcnt lgkmcnt(8)
    v_mfma_f32_16x16x32_bf16 v[38:41], v[34:37], a[80:83], v[38:41]
    ds_read_b64_tr_b16 a[100:101], v32 offset:61440
    ds_read_b64_tr_b16 a[102:103], v32 offset:62464
    s_waitcnt lgkmcnt(8)
    v_mfma_f32_16x16x32_bf16 v[42:45], v[34:37], a[84:87], v[42:45]
    v_add_u32 v32, 65536, v32
    ds_read_b64_tr_b16 a[104:105], v32 offset:0
    ds_read_b64_tr_b16 a[106:107], v32 offset:1024
    s_waitcnt lgkmcnt(8)
    v_mfma_f32_16x16x32_bf16 v[38:41], v[34:37], a[88:91], v[38:41]
    ds_read_b64_tr_b16 a[108:109], v32 offset:4096
    ds_read_b64_tr_b16 a[110:111], v32 offset:5120
    s_waitcnt lgkmcnt(8)
    v_mfma_f32_16x16x32_bf16 v[42:45], v[34:37], a[92:95], v[42:45]
    ds_read_b64_tr_b16 a[112:113], v32 offset:8192
    ds_read_b64_tr_b16 a[114:115], v32 offset:9216
    s_waitcnt lgkmcnt(8)
    v_mfma_f32_16x16x32_bf16 v[38:41], v[34:37], a[96:99], v[38:41]
    ds_read_b64_tr_b16 a[116:117], v32 offset:12288
    ds_read_b64_tr_b16 a[118:119], v32 offset:13312
    s_waitcnt lgkmcnt(8)
    v_mfma_f32_16x16x32_bf16 v[42:45], v[34:37], a[100:103], v[42:45]
    ds_read_b64_tr_b16 a[120:121], v32 offset:16384
    ds_read_b64_tr_b16 a[122:123], v32 offset:17408
    s_waitcnt lgkmcnt(8)
    v_mfma_f32_16x16x32_bf16 v[38:41], v[34:37], a[104:107], v[38:41]
    s_waitcnt lgkmcnt(6)
    v_mfma_f32_16x16x32_bf16 v[42:45], v[34:37], a[108:111], v[42:45]
    s_waitcnt lgkmcnt(4)
    v_mfma_f32_16x16x32_bf16 v[38:41], v[34:37], a[112:115], v[38:41]
    s_waitcnt lgkmcnt(2)
    v_mfma_f32_16x16x32_bf16 v[42:45], v[34:37], a[116:119], v[42:45]
    s_waitcnt lgkmcnt(0)
    v_mfma_f32_16x16x32_bf16 v[38:41], v[34:37], a[120:123], v[38:41]
    s_lshl_b32 s69, s75, 7
    s_add_u32 s69, s69, s63
    s_mul_i32 s72, s76, 32
    s_add_u32 s69, s69, s72
    s_add_u32 s69, s69, 0
    v_min_u32 v170, 7, v1
    v_lshlrev_b32 v170, 2, v170
    s_mov_b32 s73, 0
L_poll_109:
    buffer_load_dword v171, v170, s[32:35], s69 offen sc1
    s_waitcnt vmcnt(0)
    v_cmp_le_u32 s[44:45], 1, v171
    s_add_u32 s73, s73, 1
    s_cmp_eq_u64 s[44:45], -1
    s_cbranch_scc1 L_poll_109_ok
    s_cmp_lt_u32 s73, 262144
    s_cbranch_scc1 L_poll_109
L_poll_109_ok:
    s_add_u32 s71, s70, 0x10000
    buffer_load_dwordx4 v[46:49], v2, s[32:35], s71 offen offset:0 sc1
    buffer_load_dwordx4 v[50:53], v2, s[32:35], s71 offen offset:1024 sc1
    buffer_load_dwordx4 v[54:57], v2, s[32:35], s71 offen offset:2048 sc1
    buffer_load_dwordx4 v[58:61], v2, s[32:35], s71 offen offset:3072 sc1
    s_add_u32 s71, s70, 0x11000
    buffer_load_dwordx4 v[62:65], v2, s[32:35], s71 offen offset:0 sc1
    buffer_load_dwordx4 v[66:69], v2, s[32:35], s71 offen offset:1024 sc1
    buffer_load_dwordx4 v[70:73], v2, s[32:35], s71 offen offset:2048 sc1
    buffer_load_dwordx4 v[74:77], v2, s[32:35], s71 offen offset:3072 sc1
    v_add_u32 v33, 86016, v33
    ds_read_b64_tr_b16 v[142:143], v33 offset:0
    ds_read_b64_tr_b16 v[144:145], v33 offset:1024
    v_add_u32 v166, 86016, v166
    ds_read_b64_tr_b16 v[146:147], v166 offset:0
    ds_read_b64_tr_b16 v[148:149], v166 offset:1024
    ds_read_b64_tr_b16 v[150:151], v166 offset:1792
    v_add_u32 v167, 86016, v167
    ds_read_b64_tr_b16 v[152:153], v167 offset:2816
    ds_read_b64_tr_b16 v[154:155], v33 offset:1792
    v_add_u32 v168, 86016, v168
    ds_read_b64_tr_b16 v[156:157], v168 offset:2816
    s_waitcnt vmcnt(7) lgkmcnt(4)
    v_mfma_f32_32x32x16_bf16 v[110:125], v[142:145], v[46:49], 0
    ds_read_b64_tr_b16 v[158:159], v33 offset:3584
    ds_read_b64_tr_b16 v[160:161], v33 offset:4608
    s_add_u32 s71, s70, 0x12000
    buffer_load_dwordx4 v[78:81], v2, s[32:35], s71 offen offset:0 sc1
    v_mfma_f32_32x32x16_bf16 v[126:141], v[146:149], v[46:49], 0
    ds_read_b64_tr_b16 v[162:163], v166 offset:3584
    ds_read_b64_tr_b16 v[164:165], v166 offset:4608
    buffer_load_dwordx4 v[82:85], v2, s[32:35], s71 offen offset:1024 sc1
    s_waitcnt vmcnt(8) lgkmcnt(4)
    v_mfma_f32_32x32x16_bf16 v[110:125], v[150:153], v[50:53], v[110:125]
    ds_read_b64_tr_b16 v[142:143], v166 offset:5376
    ds_read_b64_tr_b16 v[144:145], v167 offset:6400
    buffer_load_dwordx4 v[86:89], v2, s[32:35], s71 offen offset:2048 sc1
    v_mfma_f32_32x32x16_bf16 v[126:141], v[154:157], v[50:53], v[126:141]
    ds_read_b64_tr_b16 v[146:147], v33 offset:5376
    ds_read_b64_tr_b16 v[148:149], v168 offset:6400
    buffer_load_dwordx4 v[90:93], v2, s[32:35], s71 offen offset:3072 sc1
    s_waitcnt vmcnt(9) lgkmcnt(4)
    v_mfma_f32_32x32x16_bf16 v[110:125], v[158:161], v[54:57], v[110:125]
    ds_read_b64_tr_b16 v[150:151], v33 offset:7168
    ds_read_b64_tr_b16 v[152:153], v33 offset:8192
    s_add_u32 s71, s70, 0x13000
    buffer_load_dwordx4 v[94:97], v2, s[32:35], s71 offen offset:0 sc1
    v_mfma_f32_32x32x16_bf16 v[126:141], v[162:165], v[54:57], v[126:141]
    ds_read_b64_tr_b16 v[154:155], v166 offset:7168
    ds_read_b64_tr_b16 v[156:157], v166 offset:8192
    buffer_load_dwordx4 v[98:101], v2, s[32:35], s71 offen offset:1024 sc1
    s_waitcnt vmcnt(10) lgkmcnt(4)
    v_mfma_f32_32x32x16_bf16 v[110:125], v[142:145], v[58:61], v[110:125]
    ds_read_b64_tr_b16 v[158:159], v166 offset:8960
    ds_read_b64_tr_b16 v[160:161], v167 offset:9984
    buffer_load_dwordx4 v[102:105], v2, s[32:35], s71 offen offset:2048 sc1
    v_mfma_f32_32x32x16_bf16 v[126:141], v[146:149], v[58:61], v[126:141]
    ds_read_b64_tr_b16 v[162:163], v33 offset:8960
    ds_read_b64_tr_b16 v[164:165], v168 offset:9984
    buffer_load_dwordx4 v[106:109], v2, s[32:35], s71 offen offset:3072 sc1
    s_waitcnt vmcnt(11) lgkmcnt(4)
    v_mfma_f32_32x32x16_bf16 v[110:125], v[150:153], v[62:65], v[110:125]
    ds_read_b64_tr_b16 v[142:143], v33 offset:10752
    ds_read_b64_tr_b16 v[144:145], v33 offset:11776
    v_mfma_f32_32x32x16_bf16 v[126:141], v[154:157], v[62:65], v[126:141]
    ds_read_b64_tr_b16 v[146:147], v166 offset:10752
    ds_read_b64_tr_b16 v[148:149], v166 offset:11776
    s_waitcnt vmcnt(10) lgkmcnt(4)
    v_mfma_f32_32x32x16_bf16 v[110:125], v[158:161], v[66:69], v[110:125]
    ds_read_b64_tr_b16 v[150:151], v166 offset:12544
    ds_read_b64_tr_b16 v[152:153], v167 offset:13568
    v_mfma_f32_32x32x16_bf16 v[126:141], v[162:165], v[66:69], v[126:141]
    ds_read_b64_tr_b16 v[154:155], v33 offset:12544
    ds_read_b64_tr_b16 v[156:157], v168 offset:13568
    s_waitcnt vmcnt(9) lgkmcnt(4)
    v_mfma_f32_32x32x16_bf16 v[110:125], v[142:145], v[70:73], v[110:125]
    ds_read_b64_tr_b16 v[158:159], v33 offset:14336
    ds_read_b64_tr_b16 v[160:161], v33 offset:15360
    v_mfma_f32_32x32x16_bf16 v[126:141], v[146:149], v[70:73], v[126:141]
    ds_read_b64_tr_b16 v[162:163], v166 offset:14336
    ds_read_b64_tr_b16 v[164:165], v166 offset:15360
    s_waitcnt vmcnt(8) lgkmcnt(4)
    v_mfma_f32_32x32x16_bf16 v[110:125], v[150:153], v[74:77], v[110:125]
    ds_read_b64_tr_b16 v[142:143], v166 offset:16128
    ds_read_b64_tr_b16 v[144:145], v167 offset:17152
    v_mfma_f32_32x32x16_bf16 v[126:141], v[154:157], v[74:77], v[126:141]
    ds_read_b64_tr_b16 v[146:147], v33 offset:16128
    ds_read_b64_tr_b16 v[148:149], v168 offset:17152
    s_waitcnt vmcnt(7) lgkmcnt(4)
    v_mfma_f32_32x32x16_bf16 v[110:125], v[158:161], v[78:81], v[110:125]
    ds_read_b64_tr_b16 v[150:151], v33 offset:17920
    ds_read_b64_tr_b16 v[152:153], v33 offset:18944
    v_mfma_f32_32x32x16_bf16 v[126:141], v[162:165], v[78:81], v[126:141]
    ds_read_b64_tr_b16 v[154:155], v166 offset:17920
    ds_read_b64_tr_b16 v[156:157], v166 offset:18944
    s_waitcnt vmcnt(6) lgkmcnt(4)
    v_mfma_f32_32x32x16_bf16 v[110:125], v[142:145], v[82:85], v[110:125]
    ds_read_b64_tr_b16 v[158:159], v166 offset:19712
    ds_read_b64_tr_b16 v[160:161], v167 offset:20736
    v_mfma_f32_32x32x16_bf16 v[126:141], v[146:149], v[82:85], v[126:141]
    ds_read_b64_tr_b16 v[162:163], v33 offset:19712
    ds_read_b64_tr_b16 v[164:165], v168 offset:20736
    s_waitcnt vmcnt(5) lgkmcnt(4)
    v_mfma_f32_32x32x16_bf16 v[110:125], v[150:153], v[86:89], v[110:125]
    ds_read_b64_tr_b16 v[142:143], v33 offset:21504
    ds_read_b64_tr_b16 v[144:145], v33 offset:22528
    v_mfma_f32_32x32x16_bf16 v[126:141], v[154:157], v[86:89], v[126:141]
    ds_read_b64_tr_b16 v[146:147], v166 offset:21504
    ds_read_b64_tr_b16 v[148:149], v166 offset:22528
    s_waitcnt vmcnt(4) lgkmcnt(4)
    v_mfma_f32_32x32x16_bf16 v[110:125], v[158:161], v[90:93], v[110:125]
    ds_read_b64_tr_b16 v[150:151], v166 offset:23296
    ds_read_b64_tr_b16 v[152:153], v167 offset:24320
    v_mfma_f32_32x32x16_bf16 v[126:141], v[162:165], v[90:93], v[126:141]
    ds_read_b64_tr_b16 v[154:155], v33 offset:23296
    ds_read_b64_tr_b16 v[156:157], v168 offset:24320
    s_waitcnt vmcnt(3) lgkmcnt(4)
    v_mfma_f32_32x32x16_bf16 v[110:125], v[142:145], v[94:97], v[110:125]
    ds_read_b64_tr_b16 v[158:159], v33 offset:25088
    ds_read_b64_tr_b16 v[160:161], v33 offset:26112
    v_mfma_f32_32x32x16_bf16 v[126:141], v[146:149], v[94:97], v[126:141]
    ds_read_b64_tr_b16 v[162:163], v166 offset:25088
    ds_read_b64_tr_b16 v[164:165], v166 offset:26112
    s_barrier
    s_waitcnt vmcnt(2) lgkmcnt(4)
    v_mfma_f32_32x32x16_bf16 v[110:125], v[150:153], v[98:101], v[110:125]
    ds_read_b64_tr_b16 v[142:143], v166 offset:26880
    ds_read_b64_tr_b16 v[144:145], v167 offset:27904
    v_mfma_f32_32x32x16_bf16 v[126:141], v[154:157], v[98:101], v[126:141]
    ds_read_b64_tr_b16 v[146:147], v33 offset:26880
    ds_read_b64_tr_b16 v[148:149], v168 offset:27904
    s_waitcnt vmcnt(1) lgkmcnt(4)
    v_mfma_f32_32x32x16_bf16 v[110:125], v[158:161], v[102:105], v[110:125]
    v_mfma_f32_32x32x16_bf16 v[126:141], v[162:165], v[102:105], v[126:141]
    s_waitcnt vmcnt(0) lgkmcnt(0)
    v_mfma_f32_32x32x16_bf16 v[110:125], v[142:145], v[106:109], v[110:125]
    v_mfma_f32_32x32x16_bf16 v[126:141], v[146:149], v[106:109], v[126:141]
    s_nop 11
    ds_write_b128 v28, v[126:129] offset:0
    ds_write_b128 v28, v[130:133] offset:1024
    ds_write_b128 v28, v[134:137] offset:2048
    ds_write_b128 v28, v[138:141] offset:3072
    v_pk_add_f32 v[8:9], v[8:9], v[110:111]
    v_pk_add_f32 v[10:11], v[10:11], v[112:113]
    v_pk_add_f32 v[12:13], v[12:13], v[114:115]
    v_pk_add_f32 v[14:15], v[14:15], v[116:117]
    v_pk_add_f32 v[16:17], v[16:17], v[118:119]
    v_pk_add_f32 v[18:19], v[18:19], v[120:121]
    v_pk_add_f32 v[20:21], v[20:21], v[122:123]
    v_pk_add_f32 v[22:23], v[22:23], v[124:125]
    s_waitcnt lgkmcnt(0)
    s_barrier
    ds_read_b128 v[126:129], v29 offset:0
    ds_read_b128 v[130:133], v29 offset:1024
    ds_read_b128 v[134:137], v29 offset:2048
    ds_read_b128 v[138:141], v29 offset:3072
    s_waitcnt lgkmcnt(3)
    v_pk_add_f32 v[8:9], v[8:9], v[126:127]
    v_pk_add_f32 v[10:11], v[10:11], v[128:129]
    v_cvt_pk_bf16_f32 v110, v8, v9
    v_cvt_pk_bf16_f32 v111, v10, v11
    v_pk_add_f32 v[118:119], v[8:9], v[10:11]
    v_pk_mul_f32 v[120:121], v[8:9], v[8:9]
    v_pk_fma_f32 v[120:121], v[10:11], v[10:11], v[120:121]
    s_waitcnt lgkmcnt(2)
    v_pk_add_f32 v[12:13], v[12:13], v[130:131]
    v_pk_add_f32 v[14:15], v[14:15], v[132:133]
    v_cvt_pk_bf16_f32 v112, v12, v13
    v_cvt_pk_bf16_f32 v113, v14, v15
    s_cmp_lg_u32 s61, 0
    s_cbranch_scc1 L_var3_wt
    buffer_store_dwordx4 v[110:113], v2, s[32:35], s88 offen offset:0
L_var3_end:
    v_pk_add_f32 v[118:119], v[118:119], v[12:13]
    v_pk_fma_f32 v[120:121], v[12:13], v[12:13], v[120:121]
    v_pk_add_f32 v[118:119], v[118:119], v[14:15]
    v_pk_fma_f32 v[120:121], v[14:15], v[14:15], v[120:121]
    s_waitcnt lgkmcnt(1)
    v_pk_add_f32 v[16:17], v[16:17], v[134:135]
    v_pk_add_f32 v[18:19], v[18:19], v[136:137]
    v_cvt_pk_bf16_f32 v114, v16, v17
    v_cvt_pk_bf16_f32 v115, v18, v19
    v_pk_add_f32 v[118:119], v[118:119], v[16:17]
    v_pk_fma_f32 v[120:121], v[16:17], v[16:17], v[120:121]
    v_pk_add_f32 v[118:119], v[118:119], v[18:19]
    v_pk_fma_f32 v[120:121], v[18:19], v[18:19], v[120:121]
    s_waitcnt lgkmcnt(0)
    v_pk_add_f32 v[20:21], v[20:21], v[138:139]
    v_pk_add_f32 v[22:23], v[22:23], v[140:141]
    v_cvt_pk_bf16_f32 v116, v20, v21
    v_cvt_pk_bf16_f32 v117, v22, v23
    s_cmp_lg_u32 s61, 0
    s_cbranch_scc1 L_var4_wt
    buffer_store_dwordx4 v[114:117], v2, s[32:35], s88 offen offset:1024
L_var4_end:
    v_pk_add_f32 v[118:119], v[118:119], v[20:21]
    v_pk_fma_f32 v[120:121], v[20:21], v[20:21], v[120:121]
    v_pk_add_f32 v[118:119], v[118:119], v[22:23]
    v_pk_fma_f32 v[120:121], v[22:23], v[22:23], v[120:121]
    v_add_f32 v118, v118, v119
    v_add_f32 v119, v120, v121
    v_mov_b32 v120, v118
    v_mov_b32 v121, v119
    v_mov_b32 v7, 1
    v_permlane32_swap_b32 v120, v118
    v_permlane32_swap_b32 v121, v119
    v_pk_add_f32 v[118:119], v[118:119], v[120:121]
    s_cmp_lg_u32 s61, 0
    s_cbranch_scc1 L_var5_wt
    buffer_store_dwordx2 v[118:119], v30, s[32:35], s89 offen
L_var5_end:
L_c_k30:
    v_mov_b32 v33, v2
    v_lshlrev_b32 v236, 3, v1
    v_add_u32 v236, 159744, v236
    s_add_u32 s90, s63, s62
    s_add_u32 s90, s90, 0x30000
    s_lshl_b32 s88, s58, 13
    s_add_u32 s88, s88, s62
    s_add_u32 s88, s88, s63
    s_lshl_b32 s89, s58, 2
    s_add_u32 s89, s89, s56
    s_lshl_b32 s89, s89, 2
    s_add_u32 s89, s89, s63
    s_add_u32 s89, s89, 1024
    s_and_b32 s69, s58, 1
    s_mul_i32 s71, s69, 57344
    s_sub_u32 s94, s90, s71
    s_add_u32 s90, s90, s71
    s_mul_i32 s71, s69, 229376
    s_sub_u32 s92, s88, s71
    s_add_u32 s88, s88, s71
    s_mul_i32 s71, s69, 512
    s_sub_u32 s93, s89, s71
    s_add_u32 s89, s89, s71
    s_lshl_b32 s69, s69, 10
    v_xor_b32 v238, s69, v236
    v_xor_b32 v239, 1024, v238
    s_lshl_b32 s95, s75, 8
    s_add_u32 s95, s95, s63
    s_mul_i32 s72, s76, 112
    s_add_u32 s95, s95, s72
    s_add_u32 s95, s95, 1024
    v_min_u32 v240, 27, v1
    v_lshlrev_b32 v240, 2, v240
    s_lshl_b32 s96, s75, 8
    s_add_u32 s96, s96, s63
    s_mul_i32 s72, s76, 112
    s_add_u32 s96, s96, s72
    s_add_u32 s96, s96, 1024
    v_min_u32 v242, 11, v1
    v_lshlrev_b32 v242, 2, v242
    v_and_b32 v243, 48, v242
    v_add_u32 v242, v242, v243
    s_lshl_b32 s69, s87, 4
    s_add_u32 s96, s96, s69
    s_mul_i32 s97, s75, 114688
    s_mul_i32 s71, s76, 57344
    s_add_u32 s97, s97, s71
    s_add_u32 s97, s97, s63
    s_mul_i32 s71, s87, 49152
    s_sub_u32 s99, s97, s71
    s_lshl_b32 s71, s87, 13
    s_add_u32 s97, s97, s71
    v_and_b32 v244, 15, v1
    v_min_u32 v244, 13, v244
    v_lshrrev_b32 v245, 4, v1
    v_lshlrev_b32 v245, 5, v245
    v_add_lshl_u32 v244, v244, v245, 2
    s_add_u32 s69, s63, 512
    s_waitcnt vmcnt(0)
    v_mov_b32 v7, 1
    s_mov_b64 exec, 1
    s_cmp_lg_u32 s61, 0
    s_cbranch_scc1 L_var6_wt
    buffer_store_dword v7, off, s[32:35], s91
L_var6_end:
    s_mov_b64 exec, -1
    s_lshr_b32 s72, s2, 3
    s_lshl_b32 s72, s72, 2
    s_add_u32 s72, s72, s56
    s_mul_i32 s72, s72, 256
    s_add_u32 s72, s72, L_c_k30+4096-interleave_layers__linear_kernel_hedgehog__glu_gated_geglu__prompt_kernel
    v_lshlrev_b32 v237, 7, v1
    v_add_u32 v237, s72, v237
    v_min_u32 v237, L_k1b-interleave_layers__linear_kernel_hedgehog__glu_gated_geglu__prompt_kernel-4, v237
    s_mov_b64 exec, 3
    global_load_dword a0, v237, s[52:53]
    s_mov_b64 exec, -1
    s_barrier
    s_add_u32 s69, s63, 512
    s_mov_b32 s73, 0
L_poll_144:
    buffer_load_dword v245, v244, s[32:35], s69 offen sc1
    s_waitcnt vmcnt(0)
    v_cmp_le_u32 s[44:45], 1, v245
    s_add_u32 s73, s73, 1
    s_cmp_eq_u64 s[44:45], -1
    s_cbranch_scc1 L_poll_144_ok
    s_cmp_lt_u32 s73, 262144
    s_cbranch_scc1 L_poll_144
L_poll_144_ok:
    s_add_u32 m0, s62, 0
    s_add_u32 s79, s90, 0
    buffer_load_dwordx4 v2, s[32:35], s79 offen sc1 lds
    s_add_u32 m0, s62, 28672
    s_add_u32 s79, s90, 28672
    buffer_load_dwordx4 v2, s[32:35], s79 offen sc1 lds
    s_add_u32 m0, s62, 4096
    s_add_u32 s79, s90, 4096
    buffer_load_dwordx4 v2, s[32:35], s79 offen sc1 lds
    s_add_u32 m0, s62, 32768
    s_add_u32 s79, s90, 32768
    buffer_load_dwordx4 v2, s[32:35], s79 offen sc1 lds
    s_add_u32 m0, s62, 8192
    s_add_u32 s79, s90, 8192
    buffer_load_dwordx4 v2, s[32:35], s79 offen sc1 lds
    s_add_u32 m0, s62, 36864
    s_add_u32 s79, s90, 36864
    buffer_load_dwordx4 v2, s[32:35], s79 offen sc1 lds
    s_add_u32 m0, s62, 12288
    s_add_u32 s79, s90, 12288
    buffer_load_dwordx4 v2, s[32:35], s79 offen sc1 lds
    s_add_u32 m0, s62, 40960
    s_add_u32 s79, s90, 40960
    buffer_load_dwordx4 v2, s[32:35], s79 offen sc1 lds
    s_waitcnt vmcnt(6)
    s_barrier
    ds_read_b128 v[174:177], v33 offset:0
    ds_read_b128 v[178:181], v33 offset:28672
    ds_read_b128 v[182:185], v33 offset:1024
    ds_read_b128 v[186:189], v33 offset:29696
    s_waitcnt lgkmcnt(3)
    v_mfma_f32_32x32x16_bf16 v[46:61], a[24:27], v[174:177], 0
    s_lshl_b32 s69, s56, 12
    s_add_u32 s69, s69, s63
    s_add_u32 s69, s69, 0x1000
    buffer_load_dwordx4 v[198:201], v2, s[32:35], s69 offen offset:0 sc1
    v_mfma_f32_32x32x16_bf16 v[62:77], a[28:31], v[174:177], 0
    ds_read_b128 v[190:193], v33 offset:2048
    buffer_load_dwordx4 v[202:205], v2, s[32:35], s69 offen offset:1024 sc1
    buffer_load_dwordx4 v[206:209], v2, s[32:35], s69 offen offset:2048 sc1
    s_waitcnt lgkmcnt(3)
    v_mfma_f32_32x32x16_bf16 v[78:93], a[24:27], v[178:181], 0
    buffer_load_dwordx4 v[210:213], v2, s[32:35], s69 offen offset:3072 sc1
    v_mfma_f32_32x32x16_bf16 v[94:109], a[28:31], v[178:181], 0
    ds_read_b128 v[194:197], v33 offset:30720
    s_waitcnt lgkmcnt(3)
    v_mfma_f32_32x32x16_bf16 v[46:61], a[32:35], v[182:185], v[46:61]
    v_mfma_f32_32x32x16_bf16 v[62:77], a[36:39], v[182:185], v[62:77]
    ds_read_b128 v[174:177], v33 offset:3072
    s_waitcnt lgkmcnt(3)
    v_mfma_f32_32x32x16_bf16 v[78:93], a[32:35], v[186:189], v[78:93]
    s_add_u32 m0, s62, 16384
    s_add_u32 s79, s90, 16384
    buffer_load_dwordx4 v2, s[32:35], s79 offen sc1 lds
    v_mfma_f32_32x32x16_bf16 v[94:109], a[36:39], v[186:189], v[94:109]
    ds_read_b128 v[178:181], v33 offset:31744
    s_waitcnt lgkmcnt(3)
    v_mfma_f32_32x32x16_bf16 v[46:61], a[40:43], v[190:193], v[46:61]
    s_add_u32 m0, s62, 45056
    s_add_u32 s79, s90, 45056
    buffer_load_dwordx4 v2, s[32:35], s79 offen sc1 lds
    v_mfma_f32_32x32x16_bf16 v[62:77], a[44:47], v[190:193], v[62:77]
    s_waitcnt lgkmcnt(2)
    v_mfma_f32_32x32x16_bf16 v[78:93], a[40:43], v[194:197], v[78:93]
    s_add_u32 m0, s62, 57344
    s_add_u32 s79, s67, 688256
    buffer_load_dwordx4 v6, s[20:23], s79 offen lds
    v_mfma_f32_32x32x16_bf16 v[94:109], a[44:47], v[194:197], v[94:109]
    s_add_u32 m0, s62, 61440
    s_add_u32 s79, s67, 745472
    buffer_load_dwordx4 v6, s[20:23], s79 offen lds
    s_waitcnt lgkmcnt(1)
    v_mfma_f32_32x32x16_bf16 v[46:61], a[48:51], v[174:177], v[46:61]
    v_mfma_f32_32x32x16_bf16 v[62:77], a[52:55], v[174:177], v[62:77]
    s_add_u32 m0, s62, 65536
    s_add_u32 s79, s67, 745600
    buffer_load_dwordx4 v6, s[20:23], s79 offen lds
    s_waitcnt lgkmcnt(0)
    v_mfma_f32_32x32x16_bf16 v[78:93], a[48:51], v[178:181], v[78:93]
    v_mfma_f32_32x32x16_bf16 v[94:109], a[52:55], v[178:181], v[94:109]
    s_waitcnt vmcnt(11)
    s_barrier
    ds_read_b128 v[182:185], v33 offset:4096
    ds_read_b128 v[186:189], v33 offset:32768
    ds_read_b128 v[190:193], v33 offset:5120
    ds_read_b128 v[194:197], v33 offset:33792
    s_waitcnt lgkmcnt(3)
    v_mfma_f32_32x32x16_bf16 v[46:61], a[56:59], v[182:185], v[46:61]
    s_add_u32 m0, s62, 69632
    s_add_u32 s79, s67, 802816
    buffer_load_dwordx4 v6, s[20:23], s79 offen lds
    v_mfma_f32_32x32x16_bf16 v[62:77], a[60:63], v[182:185], v[62:77]
    ds_read_b128 v[174:177], v33 offset:6144
    s_add_u32 m0, s62, 73728
    s_add_u32 s79, s67, 802944
    buffer_load_dwordx4 v6, s[20:23], s79 offen lds
    s_waitcnt lgkmcnt(3)
    v_mfma_f32_32x32x16_bf16 v[78:93], a[56:59], v[186:189], v[78:93]
    s_add_u32 m0, s62, 77824
    s_add_u32 s79, s67, 860160
    buffer_load_dwordx4 v6, s[20:23], s79 offen lds
    v_mfma_f32_32x32x16_bf16 v[94:109], a[60:63], v[186:189], v[94:109]
    ds_read_b128 v[178:181], v33 offset:34816
    s_waitcnt lgkmcnt(3)
    v_mfma_f32_32x32x16_bf16 v[46:61], a[64:67], v[190:193], v[46:61]
    s_add_u32 m0, s62, 81920
    s_add_u32 s79, s67, 860288
    buffer_load_dwordx4 v6, s[20:23], s79 offen lds
    v_mfma_f32_32x32x16_bf16 v[62:77], a[68:71], v[190:193], v[62:77]
    ds_read_b128 v[182:185], v33 offset:7168
    s_waitcnt lgkmcnt(3)
    v_mfma_f32_32x32x16_bf16 v[78:93], a[64:67], v[194:197], v[78:93]
    s_add_u32 m0, s62, 20480
    s_add_u32 s79, s90, 20480
    buffer_load_dwordx4 v2, s[32:35], s79 offen sc1 lds
    v_mfma_f32_32x32x16_bf16 v[94:109], a[68:71], v[194:197], v[94:109]
    ds_read_b128 v[186:189], v33 offset:35840
    s_add_u32 m0, s62, 49152
    s_add_u32 s79, s90, 49152
    buffer_load_dwordx4 v2, s[32:35], s79 offen sc1 lds
    s_waitcnt lgkmcnt(3)
    v_mfma_f32_32x32x16_bf16 v[46:61], a[72:75], v[174:177], v[46:61]
    v_mfma_f32_32x32x16_bf16 v[62:77], a[76:79], v[174:177], v[62:77]
    ds_read_b128 v[190:193], v33 offset:8192
    s_add_u32 m0, s62, 86016
    s_add_u32 s79, s67, 917504
    buffer_load_dwordx4 v6, s[20:23], s79 offen lds
    s_waitcnt lgkmcnt(3)
    v_mfma_f32_32x32x16_bf16 v[78:93], a[72:75], v[178:181], v[78:93]
    v_mfma_f32_32x32x16_bf16 v[94:109], a[76:79], v[178:181], v[94:109]
    ds_read_b128 v[194:197], v33 offset:36864
    s_add_u32 m0, s62, 90112
    s_add_u32 s79, s67, 917632
    buffer_load_dwordx4 v6, s[20:23], s79 offen lds
    s_waitcnt lgkmcnt(3)
    v_mfma_f32_32x32x16_bf16 v[46:61], a[80:83], v[182:185], v[46:61]
    s_add_u32 m0, s62, 94208
    s_add_u32 s79, s67, 974848
    buffer_load_dwordx4 v6, s[20:23], s79 offen lds
    v_mfma_f32_32x32x16_bf16 v[62:77], a[84:87], v[182:185], v[62:77]
    ds_read_b128 v[174:177], v33 offset:9216
    s_waitcnt lgkmcnt(3)
    v_mfma_f32_32x32x16_bf16 v[78:93], a[80:83], v[186:189], v[78:93]
    s_add_u32 m0, s62, 98304
    s_add_u32 s79, s67, 974976
    buffer_load_dwordx4 v6, s[20:23], s79 offen lds
    v_mfma_f32_32x32x16_bf16 v[94:109], a[84:87], v[186:189], v[94:109]
    s_waitcnt vmcnt(19)
    s_barrier
    ds_read_b128 v[178:181], v33 offset:37888
    s_waitcnt lgkmcnt(3)
    v_mfma_f32_32x32x16_bf16 v[46:61], a[88:91], v[190:193], v[46:61]
    s_add_u32 m0, s62, 102400
    s_add_u32 s79, s67, 1032192
    buffer_load_dwordx4 v6, s[20:23], s79 offen lds
    v_mfma_f32_32x32x16_bf16 v[62:77], a[92:95], v[190:193], v[62:77]
    ds_read_b128 v[182:185], v33 offset:10240
    s_add_u32 m0, s62, 106496
    s_add_u32 s79, s67, 1032320
    buffer_load_dwordx4 v6, s[20:23], s79 offen lds
    s_waitcnt lgkmcnt(3)
    v_mfma_f32_32x32x16_bf16 v[78:93], a[88:91], v[194:197], v[78:93]
    v_mfma_f32_32x32x16_bf16 v[94:109], a[92:95], v[194:197], v[94:109]
    ds_read_b128 v[186:189], v33 offset:38912
    s_add_u32 m0, s62, 110592
    s_add_u32 s79, s67, 1089536
    buffer_load_dwordx4 v6, s[20:23], s79 offen lds
    s_waitcnt lgkmcnt(3)
    v_mfma_f32_32x32x16_bf16 v[46:61], a[96:99], v[174:177], v[46:61]
    s_waitcnt vmcnt(18)
    v_add_f32 v198, v198, v200
    v_mfma_f32_32x32x16_bf16 v[62:77], a[100:103], v[174:177], v[62:77]
    ds_read_b128 v[190:193], v33 offset:11264
    s_add_u32 m0, s62, 114688
    s_add_u32 s79, s67, 1089664
    buffer_load_dwordx4 v6, s[20:23], s79 offen lds
    s_waitcnt lgkmcnt(3)
    v_mfma_f32_32x32x16_bf16 v[78:93], a[96:99], v[178:181], v[78:93]
    v_add_f32 v199, v199, v201
    v_add_f32 v198, v198, v202
    v_add_f32 v199, v199, v203
    v_add_f32 v198, v198, v204
    v_mfma_f32_32x32x16_bf16 v[94:109], a[100:103], v[178:181], v[94:109]
    ds_read_b128 v[194:197], v33 offset:39936
    s_add_u32 m0, s62, 24576
    s_add_u32 s79, s90, 24576
    buffer_load_dwordx4 v2, s[32:35], s79 offen sc1 lds
    s_waitcnt lgkmcnt(3)
    v_mfma_f32_32x32x16_bf16 v[46:61], a[104:107], v[182:185], v[46:61]
    s_add_u32 m0, s62, 53248
    s_add_u32 s79, s90, 53248
    buffer_load_dwordx4 v2, s[32:35], s79 offen sc1 lds
    v_add_f32 v199, v199, v205
    v_add_f32 v198, v198, v206
    v_mfma_f32_32x32x16_bf16 v[62:77], a[108:111], v[182:185], v[62:77]
    ds_read_b128 v[174:177], v33 offset:12288
    v_add_f32 v199, v199, v207
    v_add_f32 v198, v198, v208
    v_add_f32 v199, v199, v209
    v_add_f32 v198, v198, v210
    s_waitcnt lgkmcnt(3)
    v_mfma_f32_32x32x16_bf16 v[78:93], a[104:107], v[186:189], v[78:93]
    s_add_u32 m0, s62, 118784
    s_add_u32 s79, s67, 1146880
    buffer_load_dwordx4 v6, s[20:23], s79 offen lds
    v_add_f32 v199, v199, v211
    v_mov_b32 v200, v198
    v_mfma_f32_32x32x16_bf16 v[94:109], a[108:111], v[186:189], v[94:109]
    ds_read_b128 v[178:181], v33 offset:40960
    v_mov_b32 v201, v199
    v_permlane32_swap_b32 v200, v198
    s_waitcnt lgkmcnt(3)
    v_mfma_f32_32x32x16_bf16 v[46:61], a[112:115], v[190:193], v[46:61]
    s_add_u32 m0, s62, 122880
    s_add_u32 s79, s67, 1147008
    buffer_load_dwordx4 v6, s[20:23], s79 offen lds
    v_permlane32_swap_b32 v201, v199
    v_add_f32 v198, v200, v198
    v_mfma_f32_32x32x16_bf16 v[62:77], a[116:119], v[190:193], v[62:77]
    ds_read_b128 v[182:185], v33 offset:13312
    s_add_u32 m0, s62, 126976
    s_add_u32 s79, s67, 1204224
    buffer_load_dwordx4 v6, s[20:23], s79 offen lds
    s_waitcnt lgkmcnt(3)
    v_mfma_f32_32x32x16_bf16 v[78:93], a[112:115], v[194:197], v[78:93]
    v_add_f32 v199, v201, v199
    v_mul_f32 v198, 0x3b124925, v198
    v_mul_f32 v199, 0x3b124925, v199
    v_cvt_pk_bf16_f32 v24, -v198, -v198
    v_mfma_f32_32x32x16_bf16 v[94:109], a[116:119], v[194:197], v[94:109]
    s_waitcnt vmcnt(15)
    s_barrier
    v_add_u32 v32, 4294959104, v32
    ds_read_b64_tr_b16 a[124:125], v32 offset:0
    ds_read_b64_tr_b16 a[126:127], v32 offset:1024
    ds_read_b64_tr_b16 a[128:129], v32 offset:4096
    ds_read_b64_tr_b16 a[130:131], v32 offset:5120
    ds_read_b64_tr_b16 a[132:133], v32 offset:8192
    ds_read_b64_tr_b16 a[134:135], v32 offset:9216
    ds_read_b64_tr_b16 a[136:137], v32 offset:12288
    ds_read_b64_tr_b16 a[138:139], v32 offset:13312
    ds_read_b64_tr_b16 a[140:141], v32 offset:16384
    ds_read_b64_tr_b16 a[142:143], v32 offset:17408
    ds_read_b64_tr_b16 a[144:145], v32 offset:20480
    ds_read_b64_tr_b16 a[146:147], v32 offset:21504
    ds_read_b64_tr_b16 a[148:149], v32 offset:24576
    ds_read_b64_tr_b16 a[150:151], v32 offset:25600
    ds_read_b128 v[186:189], v33 offset:41984
    s_waitcnt lgkmcnt(15)
    v_mfma_f32_32x32x16_bf16 v[46:61], a[120:123], v[174:177], v[46:61]
    s_add_u32 m0, s62, 131072
    s_add_u32 s79, s67, 1204352
    buffer_load_dwordx4 v6, s[20:23], s79 offen lds
    v_fma_f32 v199, -v198, v198, v199
    s_waitcnt lgkmcnt(13)
    v_mfma_f32_16x16x32_bf16 v[42:45], v[34:37], a[124:127], v[42:45]
    v_max_f32 v199, 0, v199
    v_cvt_pk_bf16_f32 v199, v199, v199
    v_mfma_f32_32x32x16_bf16 v[62:77], a[124:127], v[174:177], v[62:77]
    ds_read_b128 v[190:193], v33 offset:14336
    s_add_u32 m0, s62, 135168
    s_add_u32 s79, s67, 1261568
    buffer_load_dwordx4 v6, s[20:23], s79 offen lds
    v_mfma_f32_32x32x16_bf16 v[78:93], a[120:123], v[178:181], v[78:93]
    s_add_u32 m0, s62, 139264
    s_add_u32 s79, s67, 1261696
    buffer_load_dwordx4 v6, s[20:23], s79 offen lds
    v_lshlrev_b32 v199, 16, v199
    v_add_f32 v199, 0x3727c5ac, v199
    v_mfma_f32_32x32x16_bf16 v[94:109], a[124:127], v[178:181], v[94:109]
    ds_read_b128 v[194:197], v33 offset:43008
    s_add_u32 m0, s62, 143360
    s_add_u32 s79, s67, 1318912
    buffer_load_dwordx4 v6, s[20:23], s79 offen lds
    s_waitcnt lgkmcnt(13)
    v_mfma_f32_16x16x32_bf16 v[38:41], v[34:37], a[128:131], v[38:41]
    v_cvt_pk_bf16_f32 v199, v199, v199
    v_mfma_f32_32x32x16_bf16 v[46:61], a[128:131], v[182:185], v[46:61]
    s_add_u32 m0, s62, 147456
    s_add_u32 s79, s67, 1319040
    buffer_load_dwordx4 v6, s[20:23], s79 offen lds
    v_lshlrev_b32 v199, 16, v199
    s_waitcnt lgkmcnt(11)
    v_mfma_f32_16x16x32_bf16 v[42:45], v[34:37], a[132:135], v[42:45]
    v_sqrt_f32 v199, v199
    v_mfma_f32_32x32x16_bf16 v[62:77], a[132:135], v[182:185], v[62:77]
    ds_read_b128 v[174:177], v33 offset:15360
    s_add_u32 m0, s62, 151552
    s_add_u32 s79, s67, 1376256
    buffer_load_dwordx4 v6, s[20:23], s79 offen lds
    s_waitcnt lgkmcnt(3)
    v_mfma_f32_32x32x16_bf16 v[78:93], a[128:131], v[186:189], v[78:93]
    s_add_u32 m0, s62, 155648
    s_add_u32 s79, s67, 1376384
    buffer_load_dwordx4 v6, s[20:23], s79 offen lds
    v_cvt_pk_bf16_f32 v199, v199, v199
    v_lshlrev_b32 v199, 16, v199
    v_mfma_f32_32x32x16_bf16 v[94:109], a[132:135], v[186:189], v[94:109]
    ds_read_b128 v[178:181], v33 offset:44032
    v_rcp_f32 v28, v199
    v_mov_b32 v198, v24
    v_lshlrev_b32 v200, 9, s56
    v_mfma_f32_16x16x32_bf16 v[38:41], v[34:37], a[136:139], v[38:41]
    v_add_u32 v200, v200, v236
    s_waitcnt lgkmcnt(3)
    v_mfma_f32_32x32x16_bf16 v[46:61], a[136:139], v[190:193], v[46:61]
    ds_write_b64 v200, v[198:199]
    v_mfma_f32_16x16x32_bf16 v[42:45], v[34:37], a[140:143], v[42:45]
    v_mfma_f32_32x32x16_bf16 v[62:77], a[140:143], v[190:193], v[62:77]
    ds_read_b128 v[182:185], v33 offset:16384
    s_waitcnt lgkmcnt(4)
    v_mfma_f32_32x32x16_bf16 v[78:93], a[136:139], v[194:197], v[78:93]
    v_mfma_f32_32x32x16_bf16 v[94:109], a[140:143], v[194:197], v[94:109]
    ds_read_b128 v[186:189], v33 offset:45056
    v_mfma_f32_16x16x32_bf16 v[38:41], v[34:37], a[144:147], v[38:41]
    s_waitcnt lgkmcnt(4)
    v_mfma_f32_32x32x16_bf16 v[46:61], a[144:147], v[174:177], v[46:61]
    v_mfma_f32_16x16x32_bf16 v[42:45], v[34:37], a[148:151], v[42:45]
    v_mfma_f32_32x32x16_bf16 v[62:77], a[148:151], v[174:177], v[62:77]
    ds_read_b128 v[190:193], v33 offset:17408
    s_waitcnt lgkmcnt(4)
    v_mfma_f32_32x32x16_bf16 v[78:93], a[144:147], v[178:181], v[78:93]
    v_mfma_f32_32x32x16_bf16 v[94:109], a[148:151], v[178:181], v[94:109]
    s_waitcnt vmcnt(12)
    s_barrier
    ds_read_b64_tr_b16 a[152:153], v32 offset:28672
    ds_read_b64_tr_b16 a[154:155], v32 offset:29696
    ds_read_b64_tr_b16 a[156:157], v32 offset:32768
    ds_read_b64_tr_b16 a[158:159], v32 offset:33792
    ds_read_b64_tr_b16 a[160:161], v32 offset:36864
    ds_read_b64_tr_b16 a[162:163], v32 offset:37888
    ds_read_b64_tr_b16 a[164:165], v32 offset:40960
    ds_read_b64_tr_b16 a[166:167], v32 offset:41984
    ds_read_b64_tr_b16 a[168:169], v32 offset:45056
    ds_read_b64_tr_b16 a[170:171], v32 offset:46080
    ds_read_b64_tr_b16 a[172:173], v32 offset:49152
    ds_read_b64_tr_b16 a[174:175], v32 offset:50176
    ds_read_b64_tr_b16 a[176:177], v32 offset:53248
    ds_read_b64_tr_b16 a[178:179], v32 offset:54272
    ds_read_b64_tr_b16 a[180:181], v32 offset:57344
    ds_read_b64_tr_b16 a[182:183], v32 offset:58368
    ds_read_b128 v[194:197], v33 offset:46080
    s_waitcnt lgkmcnt(15)
    v_mfma_f32_16x16x32_bf16 v[38:41], v[34:37], a[152:155], v[38:41]
    v_mfma_f32_32x32x16_bf16 v[46:61], a[152:155], v[182:185], v[46:61]
    s_waitcnt lgkmcnt(13)
    v_mfma_f32_16x16x32_bf16 v[42:45], v[34:37], a[156:159], v[42:45]
    v_mfma_f32_32x32x16_bf16 v[62:77], a[156:159], v[182:185], v[62:77]
    ds_read_b128 v[174:177], v33 offset:18432
    v_mfma_f32_32x32x16_bf16 v[78:93], a[152:155], v[186:189], v[78:93]
    v_mfma_f32_32x32x16_bf16 v[94:109], a[156:159], v[186:189], v[94:109]
    ds_read_b128 v[178:181], v33 offset:47104
    s_waitcnt lgkmcnt(13)
    v_mfma_f32_16x16x32_bf16 v[38:41], v[34:37], a[160:163], v[38:41]
    v_mfma_f32_32x32x16_bf16 v[46:61], a[160:163], v[190:193], v[46:61]
    s_waitcnt lgkmcnt(11)
    v_mfma_f32_16x16x32_bf16 v[42:45], v[34:37], a[164:167], v[42:45]
    v_mfma_f32_32x32x16_bf16 v[62:77], a[164:167], v[190:193], v[62:77]
    ds_read_b128 v[182:185], v33 offset:19456
    s_waitcnt lgkmcnt(3)
    v_mfma_f32_32x32x16_bf16 v[78:93], a[160:163], v[194:197], v[78:93]
    v_mfma_f32_32x32x16_bf16 v[94:109], a[164:167], v[194:197], v[94:109]
    ds_read_b128 v[186:189], v33 offset:48128
    v_mfma_f32_16x16x32_bf16 v[38:41], v[34:37], a[168:171], v[38:41]
    s_waitcnt lgkmcnt(3)
    v_mfma_f32_32x32x16_bf16 v[46:61], a[168:171], v[174:177], v[46:61]
    v_mfma_f32_16x16x32_bf16 v[42:45], v[34:37], a[172:175], v[42:45]
    v_mfma_f32_32x32x16_bf16 v[62:77], a[172:175], v[174:177], v[62:77]
    ds_read_b128 v[190:193], v33 offset:20480
    s_waitcnt lgkmcnt(3)
    v_mfma_f32_32x32x16_bf16 v[78:93], a[168:171], v[178:181], v[78:93]
    v_mfma_f32_32x32x16_bf16 v[94:109], a[172:175], v[178:181], v[94:109]
    ds_read_b128 v[194:197], v33 offset:49152
    v_mfma_f32_16x16x32_bf16 v[38:41], v[34:37], a[176:179], v[38:41]
    s_waitcnt lgkmcnt(3)
    v_mfma_f32_32x32x16_bf16 v[46:61], a[176:179], v[182:185], v[46:61]
    v_mfma_f32_16x16x32_bf16 v[42:45], v[34:37], a[180:183], v[42:45]
    v_mfma_f32_32x32x16_bf16 v[62:77], a[180:183], v[182:185], v[62:77]
    ds_read_b128 v[174:177], v33 offset:21504
    s_waitcnt lgkmcnt(3)
    v_mfma_f32_32x32x16_bf16 v[78:93], a[176:179], v[186:189], v[78:93]
    v_mfma_f32_32x32x16_bf16 v[94:109], a[180:183], v[186:189], v[94:109]
    s_waitcnt vmcnt(2)
    s_barrier
    ds_read_b64_tr_b16 a[184:185], v32 offset:61440
    ds_read_b64_tr_b16 a[186:187], v32 offset:62464
    v_add_u32 v32, 65536, v32
    ds_read_b64_tr_b16 a[188:189], v32 offset:0
    ds_read_b64_tr_b16 a[190:191], v32 offset:1024
    ds_read_b64_tr_b16 a[192:193], v32 offset:4096
    ds_read_b64_tr_b16 a[194:195], v32 offset:5120
    ds_read_b64_tr_b16 a[196:197], v32 offset:8192
    ds_read_b64_tr_b16 a[198:199], v32 offset:9216
    ds_read_b64_tr_b16 a[200:201], v32 offset:12288
    ds_read_b64_tr_b16 a[202:203], v32 offset:13312
    ds_read_b64_tr_b16 a[204:205], v32 offset:16384
    ds_read_b64_tr_b16 a[206:207], v32 offset:17408
    ds_read_b64_tr_b16 a[208:209], v32 offset:20480
    ds_read_b64_tr_b16 a[210:211], v32 offset:21504
    ds_read_b64_tr_b16 a[212:213], v32 offset:24576
    ds_read_b64_tr_b16 a[214:215], v32 offset:25600
    ds_read_b128 v[178:181], v33 offset:50176
    s_waitcnt lgkmcnt(15)
    v_mfma_f32_16x16x32_bf16 v[38:41], v[34:37], a[184:187], v[38:41]
    ds_read_b64 v[220:221], v238 offset:0
    v_mfma_f32_32x32x16_bf16 v[46:61], a[184:187], v[190:193], v[46:61]
    s_add_u32 m0, s62, 86016
    s_add_u32 s79, s67, 1433600
    buffer_load_dwordx4 v6, s[20:23], s79 offen lds
    ds_read_b64 v[222:223], v238 offset:512
    s_waitcnt lgkmcnt(15)
    v_mfma_f32_16x16x32_bf16 v[42:45], v[34:37], a[188:191], v[42:45]
    ds_read_b64 v[224:225], v239 offset:0
    ds_read_b64 v[226:227], v239 offset:512
    v_mfma_f32_32x32x16_bf16 v[62:77], a[188:191], v[190:193], v[62:77]
    ds_read_b128 v[182:185], v33 offset:22528
    s_add_u32 m0, s62, 90112
    s_add_u32 s79, s67, 1433728
    buffer_load_dwordx4 v6, s[20:23], s79 offen lds
    v_mfma_f32_32x32x16_bf16 v[78:93], a[184:187], v[194:197], v[78:93]
    s_add_u32 m0, s62, 94208
    s_add_u32 s79, s67, 1490944
    buffer_load_dwordx4 v6, s[20:23], s79 offen lds
    s_waitcnt lgkmcnt(1)
    v_mfma_f32_32x32x16_bf16 v[94:109], a[188:191], v[194:197], v[94:109]
    ds_read_b128 v[186:189], v33 offset:51200
    s_add_u32 m0, s62, 98304
    s_add_u32 s79, s67, 1491072
    buffer_load_dwordx4 v6, s[20:23], s79 offen lds
    v_mfma_f32_16x16x32_bf16 v[38:41], v[34:37], a[192:195], v[38:41]
    v_mfma_f32_32x32x16_bf16 v[46:61], a[192:195], v[174:177], v[46:61]
    s_add_u32 m0, s62, 102400
    s_add_u32 s79, s67, 1548288
    buffer_load_dwordx4 v6, s[20:23], s79 offen lds
    v_mfma_f32_16x16x32_bf16 v[42:45], v[34:37], a[196:199], v[42:45]
    v_rcp_f32 v31, v221
    v_mfma_f32_32x32x16_bf16 v[62:77], a[196:199], v[174:177], v[62:77]
    ds_read_b128 v[190:193], v33 offset:23552
    s_add_u32 m0, s62, 106496
    s_add_u32 s79, s67, 1548416
    buffer_load_dwordx4 v6, s[20:23], s79 offen lds
    v_mfma_f32_32x32x16_bf16 v[78:93], a[192:195], v[178:181], v[78:93]
    s_add_u32 m0, s62, 57344
    s_add_u32 s79, s94, 57344
    buffer_load_dwordx4 v2, s[32:35], s79 offen sc1 lds
    v_mul_f32 v221, v221, v221
    v_mul_f32 v30, 0xc0135761, v31
    v_mfma_f32_32x32x16_bf16 v[94:109], a[196:199], v[178:181], v[94:109]
    ds_read_b128 v[194:197], v33 offset:52224
    s_add_u32 m0, s62, 61440
    s_add_u32 s79, s94, 61440
    buffer_load_dwordx4 v2, s[32:35], s79 offen sc1 lds
    v_mfma_f32_16x16x32_bf16 v[38:41], v[34:37], a[200:203], v[38:41]
    v_mul_f32 v31, v31, v31
    s_waitcnt lgkmcnt(3)
    v_mfma_f32_32x32x16_bf16 v[46:61], a[200:203], v[182:185], v[46:61]
    s_add_u32 m0, s62, 65536
    s_add_u32 s79, s94, 65536
    buffer_load_dwordx4 v2, s[32:35], s79 offen sc1 lds
    v_mul_f32 v31, v30, v31
    v_mfma_f32_16x16x32_bf16 v[42:45], v[34:37], a[204:207], v[42:45]
    v_mul_f32 v31, 0x3d372713, v31
    v_mfma_f32_32x32x16_bf16 v[62:77], a[204:207], v[182:185], v[62:77]
    ds_read_b128 v[174:177], v33 offset:24576
    s_add_u32 m0, s62, 69632
    s_add_u32 s79, s94, 69632
    buffer_load_dwordx4 v2, s[32:35], s79 offen sc1 lds
    s_waitcnt lgkmcnt(3)
    v_mfma_f32_32x32x16_bf16 v[78:93], a[200:203], v[186:189], v[78:93]
    s_add_u32 m0, s62, 114688
    s_add_u32 s79, s68, 0
    buffer_load_dwordx4 v3, s[24:27], s79 offen lds
    v_rcp_f32 v215, v223
    v_mfma_f32_32x32x16_bf16 v[94:109], a[204:207], v[186:189], v[94:109]
    ds_read_b128 v[178:181], v33 offset:53248
    s_add_u32 m0, s62, 73728
    s_add_u32 s79, s94, 73728
    buffer_load_dwordx4 v2, s[32:35], s79 offen sc1 lds
    v_mfma_f32_16x16x32_bf16 v[38:41], v[34:37], a[208:211], v[38:41]
    v_mul_f32 v223, v223, v223
    s_waitcnt lgkmcnt(3)
    v_mfma_f32_32x32x16_bf16 v[46:61], a[208:211], v[190:193], v[46:61]
    s_add_u32 m0, s62, 77824
    s_add_u32 s79, s94, 77824
    buffer_load_dwordx4 v2, s[32:35], s79 offen sc1 lds
    v_mul_f32 v214, 0xc0135761, v215
    v_mfma_f32_16x16x32_bf16 v[42:45], v[34:37], a[212:215], v[42:45]
    v_mul_f32 v215, v215, v215
    v_mul_f32 v215, v214, v215
    v_mfma_f32_32x32x16_bf16 v[62:77], a[212:215], v[190:193], v[62:77]
    ds_read_b128 v[182:185], v33 offset:25600
    s_add_u32 m0, s62, 81920
    s_add_u32 s79, s94, 81920
    buffer_load_dwordx4 v2, s[32:35], s79 offen sc1 lds
    s_waitcnt lgkmcnt(3)
    v_mfma_f32_32x32x16_bf16 v[78:93], a[208:211], v[194:197], v[78:93]
    v_mul_f32 v215, 0x3d372713, v215
    v_rcp_f32 v217, v225
    v_mul_f32 v225, v225, v225
    v_mul_f32 v216, 0xc0135761, v217
    v_mul_f32 v217, v217, v217
    v_mfma_f32_32x32x16_bf16 v[94:109], a[212:215], v[194:197], v[94:109]
    s_waitcnt vmcnt(8)
    s_barrier
    ds_read_b64_tr_b16 a[216:217], v32 offset:28672
    ds_read_b64_tr_b16 a[218:219], v32 offset:29696
    ds_read_b64_tr_b16 a[220:221], v32 offset:32768
    ds_read_b64_tr_b16 a[222:223], v32 offset:33792
    v_add_u32 v32, 4294930432, v32
    ds_read_b64_tr_b16 a[224:225], v32 offset:0
    ds_read_b64_tr_b16 a[226:227], v32 offset:1024
    ds_read_b64_tr_b16 a[228:229], v32 offset:4096
    ds_read_b64_tr_b16 a[230:231], v32 offset:5120
    ds_read_b64_tr_b16 a[232:233], v32 offset:8192
    ds_read_b64_tr_b16 a[234:235], v32 offset:9216
    ds_read_b64_tr_b16 a[236:237], v32 offset:12288
    ds_read_b64_tr_b16 a[238:239], v32 offset:13312
    ds_read_b64_tr_b16 a[240:241], v32 offset:16384
    ds_read_b64_tr_b16 a[242:243], v32 offset:17408
    ds_read_b64_tr_b16 a[244:245], v32 offset:20480
    ds_read_b64_tr_b16 a[246:247], v32 offset:21504
    ds_read_b128 v[186:189], v33 offset:54272
    s_waitcnt lgkmcnt(15)
    v_mfma_f32_16x16x32_bf16 v[38:41], v[34:37], a[216:219], v[38:41]
    v_mul_f32 v217, v216, v217
    v_mfma_f32_32x32x16_bf16 v[46:61], a[216:219], v[174:177], v[46:61]
    s_add_u32 m0, s62, 118784
    s_add_u32 s79, s68, 14336
    buffer_load_dwordx4 v3, s[24:27], s79 offen lds
    v_mul_f32 v217, 0x3d372713, v217
    s_waitcnt lgkmcnt(13)
    v_mfma_f32_16x16x32_bf16 v[42:45], v[34:37], a[220:223], v[42:45]
    v_rcp_f32 v219, v227
    v_mfma_f32_32x32x16_bf16 v[62:77], a[220:223], v[174:177], v[62:77]
    ds_read_b128 v[190:193], v33 offset:26624
    s_add_u32 m0, s62, 122880
    s_add_u32 s79, s68, 28672
    buffer_load_dwordx4 v3, s[24:27], s79 offen lds
    v_mfma_f32_32x32x16_bf16 v[78:93], a[216:219], v[178:181], v[78:93]
    v_mul_f32 v227, v227, v227
    v_mul_f32 v218, 0xc0135761, v219
    v_mul_f32 v219, v219, v219
    v_mul_f32 v219, v218, v219
    v_mul_f32 v219, 0x3d372713, v219
    v_mfma_f32_32x32x16_bf16 v[94:109], a[220:223], v[178:181], v[94:109]
    ds_read_b128 v[194:197], v33 offset:55296
    s_waitcnt lgkmcnt(13)
    v_mfma_f32_16x16x32_bf16 v[38:41], v[34:37], a[224:227], v[38:41]
    v_mfma_f32_32x32x16_bf16 v[46:61], a[224:227], v[182:185], v[46:61]
    s_add_u32 m0, s62, 126976
    s_add_u32 s79, s68, 43008
    buffer_load_dwordx4 v3, s[24:27], s79 offen lds
    s_waitcnt lgkmcnt(11)
    v_mfma_f32_16x16x32_bf16 v[42:45], v[34:37], a[228:231], v[42:45]
    v_mfma_f32_32x32x16_bf16 v[62:77], a[228:231], v[182:185], v[62:77]
    ds_read_b128 v[174:177], v33 offset:27648
    s_add_u32 m0, s62, 131072
    s_add_u32 s79, s68, 57344
    buffer_load_dwordx4 v3, s[24:27], s79 offen lds
    s_waitcnt lgkmcnt(3)
    v_mfma_f32_32x32x16_bf16 v[78:93], a[224:227], v[186:189], v[78:93]
    v_mfma_f32_32x32x16_bf16 v[94:109], a[228:231], v[186:189], v[94:109]
    ds_read_b128 v[178:181], v33 offset:56320
    v_mfma_f32_16x16x32_bf16 v[38:41], v[34:37], a[232:235], v[38:41]
    s_waitcnt lgkmcnt(3)
    v_mfma_f32_32x32x16_bf16 v[46:61], a[232:235], v[190:193], v[46:61]
    s_add_u32 m0, s62, 135168
    s_add_u32 s79, s68, 71680
    buffer_load_dwordx4 v3, s[24:27], s79 offen lds
    v_mfma_f32_16x16x32_bf16 v[42:45], v[34:37], a[236:239], v[42:45]
    v_mfma_f32_32x32x16_bf16 v[62:77], a[236:239], v[190:193], v[62:77]
    s_add_u32 m0, s62, 139264
    s_add_u32 s79, s68, 86016
    buffer_load_dwordx4 v3, s[24:27], s79 offen lds
    s_waitcnt lgkmcnt(2)
    v_mfma_f32_32x32x16_bf16 v[78:93], a[232:235], v[194:197], v[78:93]
    v_mfma_f32_32x32x16_bf16 v[94:109], a[236:239], v[194:197], v[94:109]
    v_mfma_f32_16x16x32_bf16 v[38:41], v[34:37], a[240:243], v[38:41]
    s_waitcnt lgkmcnt(1)
    v_mfma_f32_32x32x16_bf16 v[46:61], a[240:243], v[174:177], v[46:61]
    s_add_u32 m0, s62, 143360
    s_add_u32 s79, s68, 100352
    buffer_load_dwordx4 v3, s[24:27], s79 offen lds
    v_mfma_f32_16x16x32_bf16 v[42:45], v[34:37], a[244:247], v[42:45]
    v_mfma_f32_32x32x16_bf16 v[62:77], a[244:247], v[174:177], v[62:77]
    s_add_u32 m0, s62, 147456
    s_add_u32 s79, s68, 229376
    buffer_load_dwordx4 v3, s[24:27], s79 offen lds
    s_waitcnt lgkmcnt(0)
    v_mfma_f32_32x32x16_bf16 v[78:93], a[240:243], v[178:181], v[78:93]
    v_mfma_f32_32x32x16_bf16 v[94:109], a[244:247], v[178:181], v[94:109]
    s_waitcnt vmcnt(8)
    s_barrier
    v_permlane16_swap_b32 v38, v39
    v_permlane16_swap_b32 v42, v43
    v_cvt_pk_bf16_f32 v40, v38, v38
    v_lshlrev_b32 v40, 16, v40
    v_sub_f32 v40, v38, v40
    v_cvt_pk_bf16_f32 v40, v38, v40
    v_accvgpr_write_b32 a18, v40
    v_cvt_pk_bf16_f32 v44, v42, v42
    v_lshlrev_b32 v44, 16, v44
    v_sub_f32 v44, v42, v44
    v_cvt_pk_bf16_f32 v44, v42, v44
    v_accvgpr_write_b32 a20, v44
    v_mov_b32 v24, v220
    s_nop 1
    v_mfma_f32_32x32x16_bf16 v[46:61], a[18:21], v[24:27], v[46:61]
    v_mfma_f32_32x32x16_bf16 v[62:77], a[20:23], v[24:27], v[62:77]
    v_mov_b32 v24, v222
    s_nop 1
    v_mfma_f32_32x32x16_bf16 v[78:93], a[18:21], v[24:27], v[78:93]
    s_nop 6
    v_mul_f32 v198, v46, v46
    v_mul_f32 v199, v47, v47
    v_mul_f32 v200, v48, v48
    v_mul_f32 v201, v49, v49
    v_fma_f32 v198, v198, v31, v30
    v_fma_f32 v199, v199, v31, v30
    v_mfma_f32_32x32x16_bf16 v[94:109], a[20:23], v[24:27], v[94:109]
    ds_read_b128 v[182:185], v33 offset:57344
    ds_read_b128 v[186:189], v33 offset:58368
    ds_read_b128 v[190:193], v33 offset:59392
    ds_read_b128 v[194:197], v33 offset:60416
    v_fma_f32 v200, v200, v31, v30
    s_waitcnt lgkmcnt(3)
    v_mfma_f32_32x32x16_bf16 v[110:125], a[24:27], v[182:185], 0
    s_add_u32 m0, s62, 86016
    s_add_u32 s79, s94, 86016
    buffer_load_dwordx4 v2, s[32:35], s79 offen sc1 lds
    v_fma_f32 v201, v201, v31, v30
    v_mul_f32 v198, v198, v46
    v_mfma_f32_32x32x16_bf16 v[126:141], a[28:31], v[182:185], 0
    ds_read_b128 v[174:177], v33 offset:61440
    v_mul_f32 v199, v199, v47
    v_mul_f32 v200, v200, v48
    v_mul_f32 v201, v201, v49
    s_waitcnt lgkmcnt(3)
    v_mfma_f32_32x32x16_bf16 v[110:125], a[32:35], v[186:189], v[110:125]
    v_exp_f32 v198, v198
    v_exp_f32 v199, v199
    v_exp_f32 v200, v200
    v_mfma_f32_32x32x16_bf16 v[126:141], a[36:39], v[186:189], v[126:141]
    ds_read_b128 v[178:181], v33 offset:62464
    v_exp_f32 v201, v201
    v_mul_f32 v46, v46, v54
    v_mul_f32 v47, v47, v55
    s_waitcnt lgkmcnt(3)
    v_mfma_f32_32x32x16_bf16 v[110:125], a[40:43], v[190:193], v[110:125]
    s_add_u32 m0, s62, 90112
    s_add_u32 s79, s94, 90112
    buffer_load_dwordx4 v2, s[32:35], s79 offen sc1 lds
    v_mul_f32 v48, v48, v56
    v_mul_f32 v49, v49, v57
    v_mfma_f32_32x32x16_bf16 v[126:141], a[44:47], v[190:193], v[126:141]
    ds_read_b128 v[182:185], v33 offset:63488
    v_fma_f32 v198, v198, v221, v221
    v_fma_f32 v199, v199, v221, v221
    v_fma_f32 v200, v200, v221, v221
    v_fma_f32 v201, v201, v221, v221
    s_waitcnt lgkmcnt(3)
    v_mfma_f32_32x32x16_bf16 v[110:125], a[48:51], v[194:197], v[110:125]
    v_rcp_f32 v198, v198
    v_rcp_f32 v199, v199
    v_rcp_f32 v200, v200
    v_mfma_f32_32x32x16_bf16 v[126:141], a[52:55], v[194:197], v[126:141]
    ds_read_b128 v[186:189], v33 offset:64512
    v_rcp_f32 v201, v201
    v_mul_f32 v46, v46, v198
    v_mul_f32 v47, v47, v199
    s_waitcnt lgkmcnt(3)
    v_mfma_f32_32x32x16_bf16 v[110:125], a[56:59], v[174:177], v[110:125]
    s_add_u32 m0, s62, 94208
    s_add_u32 s79, s94, 94208
    buffer_load_dwordx4 v2, s[32:35], s79 offen sc1 lds
    v_mul_f32 v48, v48, v200
    v_mul_f32 v49, v49, v201
    v_mfma_f32_32x32x16_bf16 v[126:141], a[60:63], v[174:177], v[126:141]
    v_add_u32 v33, 65536, v33
    ds_read_b128 v[190:193], v33 offset:0
    v_cvt_pk_bf16_f32 v228, v46, v47
    v_cvt_pk_bf16_f32 v229, v48, v49
    v_mul_f32 v198, v50, v50
    s_waitcnt lgkmcnt(3)
    v_mfma_f32_32x32x16_bf16 v[110:125], a[64:67], v[178:181], v[110:125]
    v_mul_f32 v199, v51, v51
    v_mul_f32 v200, v52, v52
    v_mul_f32 v201, v53, v53
    v_fma_f32 v198, v198, v31, v30
    v_fma_f32 v199, v199, v31, v30
    v_fma_f32 v200, v200, v31, v30
    v_mfma_f32_32x32x16_bf16 v[126:141], a[68:71], v[178:181], v[126:141]
    ds_read_b128 v[194:197], v33 offset:1024
    v_fma_f32 v201, v201, v31, v30
    v_mul_f32 v198, v198, v50
    v_mul_f32 v199, v199, v51
    v_mul_f32 v200, v200, v52
    s_waitcnt lgkmcnt(3)
    v_mfma_f32_32x32x16_bf16 v[110:125], a[72:75], v[182:185], v[110:125]
    s_add_u32 m0, s62, 98304
    s_add_u32 s79, s94, 98304
    buffer_load_dwordx4 v2, s[32:35], s79 offen sc1 lds
    v_mul_f32 v201, v201, v53
    v_mfma_f32_32x32x16_bf16 v[126:141], a[76:79], v[182:185], v[126:141]
    ds_read_b128 v[174:177], v33 offset:2048
    v_exp_f32 v198, v198
    v_exp_f32 v199, v199
    s_waitcnt lgkmcnt(3)
    v_mfma_f32_32x32x16_bf16 v[110:125], a[80:83], v[186:189], v[110:125]
    v_exp_f32 v200, v200
    v_exp_f32 v201, v201
    v_mul_f32 v50, v50, v58
    v_mul_f32 v51, v51, v59
    v_mfma_f32_32x32x16_bf16 v[126:141], a[84:87], v[186:189], v[126:141]
    ds_read_b128 v[178:181], v33 offset:3072
    v_mul_f32 v52, v52, v60
    v_mul_f32 v53, v53, v61
    v_fma_f32 v198, v198, v221, v221
    v_fma_f32 v199, v199, v221, v221
    s_waitcnt lgkmcnt(3)
    v_mfma_f32_32x32x16_bf16 v[110:125], a[88:91], v[190:193], v[110:125]
    s_add_u32 m0, s62, 102400
    s_add_u32 s79, s94, 102400
    buffer_load_dwordx4 v2, s[32:35], s79 offen sc1 lds
    v_fma_f32 v200, v200, v221, v221
    v_fma_f32 v201, v201, v221, v221
    v_mfma_f32_32x32x16_bf16 v[126:141], a[92:95], v[190:193], v[126:141]
    ds_read_b128 v[182:185], v33 offset:4096
    v_rcp_f32 v198, v198
    v_rcp_f32 v199, v199
    s_waitcnt lgkmcnt(3)
    v_mfma_f32_32x32x16_bf16 v[110:125], a[96:99], v[194:197], v[110:125]
    v_rcp_f32 v200, v200
    v_rcp_f32 v201, v201
    v_mul_f32 v50, v50, v198
    v_mul_f32 v51, v51, v199
    v_mfma_f32_32x32x16_bf16 v[126:141], a[100:103], v[194:197], v[126:141]
    ds_read_b128 v[186:189], v33 offset:5120
    v_mul_f32 v52, v52, v200
    v_mul_f32 v53, v53, v201
    v_cvt_pk_bf16_f32 v230, v50, v51
    v_cvt_pk_bf16_f32 v231, v52, v53
    s_waitcnt lgkmcnt(3)
    v_mfma_f32_32x32x16_bf16 v[110:125], a[104:107], v[174:177], v[110:125]
    s_add_u32 m0, s62, 106496
    s_add_u32 s79, s94, 106496
    buffer_load_dwordx4 v2, s[32:35], s79 offen sc1 lds
    s_add_u32 s71, s88, 0x70000
    buffer_store_dwordx4 v[228:231], v2, s[32:35], s71 offen sc1
    v_mfma_f32_32x32x16_bf16 v[126:141], a[108:111], v[174:177], v[126:141]
    ds_read_b128 v[190:193], v33 offset:6144
    v_mul_f32 v198, v62, v62
    v_mul_f32 v199, v63, v63
    v_mul_f32 v200, v64, v64
    v_mul_f32 v201, v65, v65
    s_waitcnt lgkmcnt(3)
    v_mfma_f32_32x32x16_bf16 v[110:125], a[112:115], v[178:181], v[110:125]
    v_fma_f32 v198, v198, v31, v30
    v_fma_f32 v199, v199, v31, v30
    v_fma_f32 v200, v200, v31, v30
    v_fma_f32 v201, v201, v31, v30
    v_mul_f32 v198, v198, v62
    v_mul_f32 v199, v199, v63
    v_mfma_f32_32x32x16_bf16 v[126:141], a[116:119], v[178:181], v[126:141]
    ds_read_b128 v[194:197], v33 offset:7168
    v_mul_f32 v200, v200, v64
    v_mul_f32 v201, v201, v65
    v_exp_f32 v198, v198
    s_waitcnt lgkmcnt(3)
    v_mfma_f32_32x32x16_bf16 v[110:125], a[120:123], v[182:185], v[110:125]
    s_add_u32 m0, s62, 110592
    s_add_u32 s79, s94, 110592
    buffer_load_dwordx4 v2, s[32:35], s79 offen sc1 lds
    v_exp_f32 v199, v199
    v_mfma_f32_32x32x16_bf16 v[126:141], a[124:127], v[182:185], v[126:141]
    ds_read_b128 v[174:177], v33 offset:8192
    v_exp_f32 v200, v200
    v_exp_f32 v201, v201
    s_waitcnt lgkmcnt(3)
    v_mfma_f32_32x32x16_bf16 v[110:125], a[128:131], v[186:189], v[110:125]
    v_mul_f32 v62, v62, v70
    v_mul_f32 v63, v63, v71
    v_mul_f32 v64, v64, v72
    v_mul_f32 v65, v65, v73
    v_fma_f32 v198, v198, v221, v221
    v_fma_f32 v199, v199, v221, v221
    v_mfma_f32_32x32x16_bf16 v[126:141], a[132:135], v[186:189], v[126:141]
    ds_read_b128 v[178:181], v33 offset:9216
    v_fma_f32 v200, v200, v221, v221
    v_fma_f32 v201, v201, v221, v221
    v_rcp_f32 v198, v198
    s_waitcnt lgkmcnt(3)
    v_mfma_f32_32x32x16_bf16 v[110:125], a[136:139], v[190:193], v[110:125]
    s_add_u32 m0, s62, 151552
    s_add_u32 s79, s68, 243712
    buffer_load_dwordx4 v3, s[24:27], s79 offen lds
    v_rcp_f32 v199, v199
    v_mfma_f32_32x32x16_bf16 v[126:141], a[140:143], v[190:193], v[126:141]
    ds_read_b128 v[182:185], v33 offset:10240
    v_rcp_f32 v200, v200
    v_rcp_f32 v201, v201
    s_waitcnt lgkmcnt(3)
    v_mfma_f32_32x32x16_bf16 v[110:125], a[144:147], v[194:197], v[110:125]
    v_mul_f32 v62, v62, v198
    v_mul_f32 v63, v63, v199
    v_mul_f32 v64, v64, v200
    v_mul_f32 v65, v65, v201
    v_cvt_pk_bf16_f32 v232, v62, v63
    v_cvt_pk_bf16_f32 v233, v64, v65
    v_mfma_f32_32x32x16_bf16 v[126:141], a[148:151], v[194:197], v[126:141]
    ds_read_b128 v[186:189], v33 offset:11264
    s_add_u32 m0, s62, 155648
    s_add_u32 s79, s68, 258048
    buffer_load_dwordx4 v3, s[24:27], s79 offen lds
    s_waitcnt lgkmcnt(3)
    v_mfma_f32_32x32x16_bf16 v[110:125], a[152:155], v[174:177], v[110:125]
    v_mul_f32 v198, v66, v66
    v_mul_f32 v199, v67, v67
    v_mul_f32 v200, v68, v68
    v_mul_f32 v201, v69, v69
    v_fma_f32 v198, v198, v31, v30
    v_fma_f32 v199, v199, v31, v30
    v_mfma_f32_32x32x16_bf16 v[126:141], a[156:159], v[174:177], v[126:141]
    ds_read_b128 v[190:193], v33 offset:12288
    v_fma_f32 v200, v200, v31, v30
    v_fma_f32 v201, v201, v31, v30
    v_mul_f32 v198, v198, v66
    v_mul_f32 v199, v199, v67
    s_waitcnt lgkmcnt(3)
    v_mfma_f32_32x32x16_bf16 v[110:125], a[160:163], v[178:181], v[110:125]
    s_add_u32 m0, s62, 0
    s_add_u32 s79, s68, 272384
    buffer_load_dwordx4 v3, s[24:27], s79 offen lds
    v_mul_f32 v200, v200, v68
    v_mul_f32 v201, v201, v69
    v_mfma_f32_32x32x16_bf16 v[126:141], a[164:167], v[178:181], v[126:141]
    ds_read_b128 v[194:197], v33 offset:13312
    v_exp_f32 v198, v198
    v_exp_f32 v199, v199
    s_waitcnt lgkmcnt(3)
    v_mfma_f32_32x32x16_bf16 v[110:125], a[168:171], v[182:185], v[110:125]
    v_exp_f32 v200, v200
    v_exp_f32 v201, v201
    v_mul_f32 v66, v66, v74
    v_mul_f32 v67, v67, v75
    v_mfma_f32_32x32x16_bf16 v[126:141], a[172:175], v[182:185], v[126:141]
    ds_read_b128 v[174:177], v33 offset:14336
    s_add_u32 m0, s62, 4096
    s_add_u32 s79, s68, 286720
    buffer_load_dwordx4 v3, s[24:27], s79 offen lds
    s_waitcnt lgkmcnt(3)
    v_mfma_f32_32x32x16_bf16 v[110:125], a[176:179], v[186:189], v[110:125]
    v_mul_f32 v68, v68, v76
    v_mul_f32 v69, v69, v77
    v_fma_f32 v198, v198, v221, v221
    v_fma_f32 v199, v199, v221, v221
    v_fma_f32 v200, v200, v221, v221
    v_fma_f32 v201, v201, v221, v221
    v_mfma_f32_32x32x16_bf16 v[126:141], a[180:183], v[186:189], v[126:141]
    ds_read_b128 v[178:181], v33 offset:15360
    v_rcp_f32 v198, v198
    v_rcp_f32 v199, v199
    s_waitcnt lgkmcnt(3)
    v_mfma_f32_32x32x16_bf16 v[110:125], a[184:187], v[190:193], v[110:125]
    s_add_u32 m0, s62, 8192
    s_add_u32 s79, s68, 301056
    buffer_load_dwordx4 v3, s[24:27], s79 offen lds
    v_rcp_f32 v200, v200
    v_mfma_f32_32x32x16_bf16 v[126:141], a[188:191], v[190:193], v[126:141]
    ds_read_b128 v[182:185], v33 offset:16384
    v_rcp_f32 v201, v201
    v_mul_f32 v66, v66, v198
    v_mul_f32 v67, v67, v199
    s_waitcnt lgkmcnt(3)
    v_mfma_f32_32x32x16_bf16 v[110:125], a[192:195], v[194:197], v[110:125]
    v_mul_f32 v68, v68, v200
    v_mul_f32 v69, v69, v201
    v_cvt_pk_bf16_f32 v234, v66, v67
    v_cvt_pk_bf16_f32 v235, v68, v69
    s_add_u32 s71, s88, 0x71000
    buffer_store_dwordx4 v[232:235], v2, s[32:35], s71 offen sc1
    v_mfma_f32_32x32x16_bf16 v[126:141], a[196:199], v[194:197], v[126:141]
    ds_read_b128 v[186:189], v33 offset:17408
    s_add_u32 m0, s62, 12288
    s_add_u32 s79, s68, 315392
    buffer_load_dwordx4 v3, s[24:27], s79 offen lds
    s_waitcnt lgkmcnt(3)
    v_mfma_f32_32x32x16_bf16 v[110:125], a[200:203], v[174:177], v[110:125]
    v_mul_f32 v198, v78, v78
    v_mul_f32 v199, v79, v79
    v_mul_f32 v200, v80, v80
    v_mul_f32 v201, v81, v81
    v_fma_f32 v198, v198, v215, v214
    v_fma_f32 v199, v199, v215, v214
    v_mfma_f32_32x32x16_bf16 v[126:141], a[204:207], v[174:177], v[126:141]
    ds_read_b128 v[190:193], v33 offset:18432
    v_fma_f32 v200, v200, v215, v214
    v_fma_f32 v201, v201, v215, v214
    v_mul_f32 v198, v198, v78
    v_mul_f32 v199, v199, v79
    s_waitcnt lgkmcnt(3)
    v_mfma_f32_32x32x16_bf16 v[110:125], a[208:211], v[178:181], v[110:125]
    s_add_u32 m0, s62, 16384
    s_add_u32 s79, s68, 329728
    buffer_load_dwordx4 v3, s[24:27], s79 offen lds
    v_mul_f32 v200, v200, v80
    v_mul_f32 v201, v201, v81
    v_mfma_f32_32x32x16_bf16 v[126:141], a[212:215], v[178:181], v[126:141]
    ds_read_b128 v[194:197], v33 offset:19456
    v_exp_f32 v198, v198
    v_exp_f32 v199, v199
    s_waitcnt lgkmcnt(3)
    v_mfma_f32_32x32x16_bf16 v[110:125], a[216:219], v[182:185], v[110:125]
    v_exp_f32 v200, v200
    v_exp_f32 v201, v201
    v_mul_f32 v78, v78, v86
    v_mul_f32 v79, v79, v87
    v_mfma_f32_32x32x16_bf16 v[126:141], a[220:223], v[182:185], v[126:141]
    s_add_u32 m0, s62, 20480
    s_add_u32 s79, s68, 458752
    buffer_load_dwordx4 v3, s[24:27], s79 offen lds
    v_mul_f32 v80, v80, v88
    s_waitcnt lgkmcnt(2)
    v_mfma_f32_32x32x16_bf16 v[110:125], a[224:227], v[186:189], v[110:125]
    v_mul_f32 v81, v81, v89
    v_fma_f32 v198, v198, v223, v223
    v_fma_f32 v199, v199, v223, v223
    v_fma_f32 v200, v200, v223, v223
    v_fma_f32 v201, v201, v223, v223
    v_mfma_f32_32x32x16_bf16 v[126:141], a[228:231], v[186:189], v[126:141]
    v_rcp_f32 v198, v198
    v_rcp_f32 v199, v199
    s_waitcnt lgkmcnt(1)
    v_mfma_f32_32x32x16_bf16 v[110:125], a[232:235], v[190:193], v[110:125]
    s_add_u32 m0, s62, 24576
    s_add_u32 s79, s68, 473088
    buffer_load_dwordx4 v3, s[24:27], s79 offen lds
    v_rcp_f32 v200, v200
    v_mfma_f32_32x32x16_bf16 v[126:141], a[236:239], v[190:193], v[126:141]
    v_rcp_f32 v201, v201
    v_mul_f32 v78, v78, v198
    v_mul_f32 v79, v79, v199
    v_mul_f32 v80, v80, v200
    s_waitcnt lgkmcnt(0)
    v_mfma_f32_32x32x16_bf16 v[110:125], a[240:243], v[194:197], v[110:125]
    v_mul_f32 v81, v81, v201
    v_cvt_pk_bf16_f32 v228, v78, v79
    v_cvt_pk_bf16_f32 v229, v80, v81
    v_mul_f32 v198, v82, v82
    v_mul_f32 v199, v83, v83
    v_mul_f32 v200, v84, v84
    v_mfma_f32_32x32x16_bf16 v[126:141], a[244:247], v[194:197], v[126:141]
    s_waitcnt vmcnt(10)
    s_barrier
    v_mov_b32 v24, v224
    s_add_u32 m0, s62, 28672
    s_add_u32 s79, s68, 487424
    buffer_load_dwordx4 v3, s[24:27], s79 offen lds
    v_mfma_f32_32x32x16_bf16 v[110:125], a[18:21], v[24:27], v[110:125]
    v_mul_f32 v201, v85, v85
    v_fma_f32 v198, v198, v215, v214
    v_fma_f32 v199, v199, v215, v214
    v_fma_f32 v200, v200, v215, v214
    v_fma_f32 v201, v201, v215, v214
    v_mul_f32 v198, v198, v82
    v_mfma_f32_32x32x16_bf16 v[126:141], a[20:23], v[24:27], v[126:141]
    ds_read_b128 v[174:177], v33 offset:20480
    ds_read_b128 v[178:181], v33 offset:21504
    ds_read_b128 v[182:185], v33 offset:22528
    ds_read_b128 v[186:189], v33 offset:23552
    v_mul_f32 v199, v199, v83
    s_waitcnt lgkmcnt(3)
    v_mfma_f32_32x32x16_bf16 v[142:157], a[24:27], v[174:177], 0
    s_add_u32 m0, s62, 32768
    s_add_u32 s79, s68, 501760
    buffer_load_dwordx4 v3, s[24:27], s79 offen lds
    v_mul_f32 v200, v200, v84
    v_mul_f32 v201, v201, v85
    v_mfma_f32_32x32x16_bf16 v[158:173], a[28:31], v[174:177], 0
    ds_read_b128 v[190:193], v33 offset:24576
    v_exp_f32 v198, v198
    v_exp_f32 v199, v199
    s_waitcnt lgkmcnt(3)
    v_mfma_f32_32x32x16_bf16 v[142:157], a[32:35], v[178:181], v[142:157]
    v_exp_f32 v200, v200
    v_exp_f32 v201, v201
    v_mul_f32 v82, v82, v90
    v_mul_f32 v83, v83, v91
    v_mfma_f32_32x32x16_bf16 v[158:173], a[36:39], v[178:181], v[158:173]
    ds_read_b128 v[194:197], v33 offset:25600
    s_add_u32 m0, s62, 36864
    s_add_u32 s79, s68, 516096
    buffer_load_dwordx4 v3, s[24:27], s79 offen lds
    s_waitcnt lgkmcnt(3)
    v_mfma_f32_32x32x16_bf16 v[142:157], a[40:43], v[182:185], v[142:157]
    v_mul_f32 v84, v84, v92
    v_mul_f32 v85, v85, v93
    v_fma_f32 v198, v198, v223, v223
    v_fma_f32 v199, v199, v223, v223
    v_fma_f32 v200, v200, v223, v223
    v_fma_f32 v201, v201, v223, v223
    v_mfma_f32_32x32x16_bf16 v[158:173], a[44:47], v[182:185], v[158:173]
    ds_read_b128 v[174:177], v33 offset:26624
    v_rcp_f32 v198, v198
    v_rcp_f32 v199, v199
    s_waitcnt lgkmcnt(3)
    v_mfma_f32_32x32x16_bf16 v[142:157], a[48:51], v[186:189], v[142:157]
    s_add_u32 m0, s62, 40960
    s_add_u32 s79, s68, 530432
    buffer_load_dwordx4 v3, s[24:27], s79 offen lds
    v_rcp_f32 v200, v200
    v_mfma_f32_32x32x16_bf16 v[158:173], a[52:55], v[186:189], v[158:173]
    ds_read_b128 v[178:181], v33 offset:27648
    v_rcp_f32 v201, v201
    v_mul_f32 v82, v82, v198
    v_mul_f32 v83, v83, v199
    s_waitcnt lgkmcnt(3)
    v_mfma_f32_32x32x16_bf16 v[142:157], a[56:59], v[190:193], v[142:157]
    v_mul_f32 v84, v84, v200
    v_mul_f32 v85, v85, v201
    v_cvt_pk_bf16_f32 v230, v82, v83
    v_cvt_pk_bf16_f32 v231, v84, v85
    s_add_u32 s71, s88, 0x8c000
    buffer_store_dwordx4 v[228:231], v2, s[32:35], s71 offen sc1
    v_mfma_f32_32x32x16_bf16 v[158:173], a[60:63], v[190:193], v[158:173]
    ds_read_b128 v[182:185], v33 offset:28672
    s_add_u32 m0, s62, 45056
    s_add_u32 s79, s68, 544768
    buffer_load_dwordx4 v3, s[24:27], s79 offen lds
    s_waitcnt lgkmcnt(3)
    v_mfma_f32_32x32x16_bf16 v[142:157], a[64:67], v[194:197], v[142:157]
    v_mul_f32 v198, v94, v94
    v_mul_f32 v199, v95, v95
    v_mul_f32 v200, v96, v96
    v_mul_f32 v201, v97, v97
    v_fma_f32 v198, v198, v215, v214
    v_fma_f32 v199, v199, v215, v214
    v_mfma_f32_32x32x16_bf16 v[158:173], a[68:71], v[194:197], v[158:173]
    ds_read_b128 v[186:189], v33 offset:29696
    v_fma_f32 v200, v200, v215, v214
    v_fma_f32 v201, v201, v215, v214
    v_mul_f32 v198, v198, v94
    v_mul_f32 v199, v199, v95
    s_waitcnt lgkmcnt(3)
    v_mfma_f32_32x32x16_bf16 v[142:157], a[72:75], v[174:177], v[142:157]
    s_add_u32 m0, s62, 49152
    s_add_u32 s79, s68, 559104
    buffer_load_dwordx4 v3, s[24:27], s79 offen lds
    v_mul_f32 v200, v200, v96
    v_mul_f32 v201, v201, v97
    v_mfma_f32_32x32x16_bf16 v[158:173], a[76:79], v[174:177], v[158:173]
    ds_read_b128 v[190:193], v33 offset:30720
    v_exp_f32 v198, v198
    v_exp_f32 v199, v199
    s_waitcnt lgkmcnt(3)
    v_mfma_f32_32x32x16_bf16 v[142:157], a[80:83], v[178:181], v[142:157]
    v_exp_f32 v200, v200
    v_exp_f32 v201, v201
    v_mul_f32 v94, v94, v102
    v_mul_f32 v95, v95, v103
    v_mfma_f32_32x32x16_bf16 v[158:173], a[84:87], v[178:181], v[158:173]
    ds_read_b128 v[194:197], v33 offset:31744
    s_add_u32 m0, s62, 53248
    s_add_u32 s79, s86, 688128
    buffer_load_dwordx4 v3, s[24:27], s79 offen lds
    s_waitcnt lgkmcnt(3)
    v_mfma_f32_32x32x16_bf16 v[142:157], a[88:91], v[182:185], v[142:157]
    v_mul_f32 v96, v96, v104
    v_mul_f32 v97, v97, v105
    v_fma_f32 v198, v198, v223, v223
    v_fma_f32 v199, v199, v223, v223
    v_fma_f32 v200, v200, v223, v223
    v_fma_f32 v201, v201, v223, v223
    v_mfma_f32_32x32x16_bf16 v[158:173], a[92:95], v[182:185], v[158:173]
    ds_read_b128 v[174:177], v33 offset:32768
    v_rcp_f32 v198, v198
    v_rcp_f32 v199, v199
    s_waitcnt lgkmcnt(3)
    v_mfma_f32_32x32x16_bf16 v[142:157], a[96:99], v[186:189], v[142:157]
    s_add_u32 m0, s62, 57344
    s_add_u32 s79, s86, 702464
    buffer_load_dwordx4 v3, s[24:27], s79 offen lds
    v_rcp_f32 v200, v200
    v_mfma_f32_32x32x16_bf16 v[158:173], a[100:103], v[186:189], v[158:173]
    ds_read_b128 v[178:181], v33 offset:33792
    v_rcp_f32 v201, v201
    v_mul_f32 v94, v94, v198
    v_mul_f32 v95, v95, v199
    s_waitcnt lgkmcnt(3)
    v_mfma_f32_32x32x16_bf16 v[142:157], a[104:107], v[190:193], v[142:157]
    v_mul_f32 v96, v96, v200
    v_mul_f32 v97, v97, v201
    v_cvt_pk_bf16_f32 v232, v94, v95
    v_cvt_pk_bf16_f32 v233, v96, v97
    v_mul_f32 v198, v98, v98
    v_mul_f32 v199, v99, v99
    v_mfma_f32_32x32x16_bf16 v[158:173], a[108:111], v[190:193], v[158:173]
    ds_read_b128 v[182:185], v33 offset:34816
    s_add_u32 m0, s62, 61440
    s_add_u32 s79, s86, 716800
    buffer_load_dwordx4 v3, s[24:27], s79 offen lds
    s_waitcnt lgkmcnt(3)
    v_mfma_f32_32x32x16_bf16 v[142:157], a[112:115], v[194:197], v[142:157]
    v_mul_f32 v200, v100, v100
    v_mul_f32 v201, v101, v101
    v_fma_f32 v198, v198, v215, v214
    v_fma_f32 v199, v199, v215, v214
    v_fma_f32 v200, v200, v215, v214
    v_fma_f32 v201, v201, v215, v214
    v_mfma_f32_32x32x16_bf16 v[158:173], a[116:119], v[194:197], v[158:173]
    s_barrier
    ds_read_b128 v[186:189], v33 offset:35840
    v_mul_f32 v198, v198, v98
    v_mul_f32 v199, v199, v99
    v_mul_f32 v200, v200, v100
    s_waitcnt lgkmcnt(3)
    v_mfma_f32_32x32x16_bf16 v[142:157], a[120:123], v[174:177], v[142:157]
    s_add_u32 m0, s62, 65536
    s_add_u32 s79, s86, 731136
    buffer_load_dwordx4 v3, s[24:27], s79 offen lds
    v_mul_f32 v201, v201, v101
    v_mfma_f32_32x32x16_bf16 v[158:173], a[124:127], v[174:177], v[158:173]
    ds_read_b128 v[190:193], v33 offset:36864
    v_exp_f32 v198, v198
    v_exp_f32 v199, v199
    s_waitcnt lgkmcnt(3)
    v_mfma_f32_32x32x16_bf16 v[142:157], a[128:131], v[178:181], v[142:157]
    v_exp_f32 v200, v200
    v_exp_f32 v201, v201
    v_mul_f32 v98, v98, v106
    v_mul_f32 v99, v99, v107
    v_mfma_f32_32x32x16_bf16 v[158:173], a[132:135], v[178:181], v[158:173]
    ds_read_b128 v[194:197], v33 offset:37888
    s_add_u32 m0, s62, 69632
    s_add_u32 s79, s86, 745472
    buffer_load_dwordx4 v3, s[24:27], s79 offen lds
    s_waitcnt lgkmcnt(3)
    v_mfma_f32_32x32x16_bf16 v[142:157], a[136:139], v[182:185], v[142:157]
    v_mul_f32 v100, v100, v108
    v_mul_f32 v101, v101, v109
    v_fma_f32 v198, v198, v223, v223
    v_fma_f32 v199, v199, v223, v223
    v_fma_f32 v200, v200, v223, v223
    v_fma_f32 v201, v201, v223, v223
    v_mfma_f32_32x32x16_bf16 v[158:173], a[140:143], v[182:185], v[158:173]
    ds_read_b128 v[174:177], v33 offset:38912
    v_rcp_f32 v198, v198
    v_rcp_f32 v199, v199
    s_waitcnt lgkmcnt(3)
    v_mfma_f32_32x32x16_bf16 v[142:157], a[144:147], v[186:189], v[142:157]
    s_add_u32 m0, s62, 73728
    s_add_u32 s79, s86, 759808
    buffer_load_dwordx4 v3, s[24:27], s79 offen lds
    v_rcp_f32 v200, v200
    v_mfma_f32_32x32x16_bf16 v[158:173], a[148:151], v[186:189], v[158:173]
    ds_read_b128 v[178:181], v33 offset:39936
    v_rcp_f32 v201, v201
    v_mul_f32 v98, v98, v198
    v_mul_f32 v99, v99, v199
    s_waitcnt lgkmcnt(3)
    v_mfma_f32_32x32x16_bf16 v[142:157], a[152:155], v[190:193], v[142:157]
    v_mul_f32 v100, v100, v200
    v_mul_f32 v101, v101, v201
    v_cvt_pk_bf16_f32 v234, v98, v99
    v_cvt_pk_bf16_f32 v235, v100, v101
    s_add_u32 s71, s88, 0x8d000
    buffer_store_dwordx4 v[232:235], v2, s[32:35], s71 offen sc1
    v_mfma_f32_32x32x16_bf16 v[158:173], a[156:159], v[190:193], v[158:173]
    ds_read_b128 v[182:185], v33 offset:40960
    s_add_u32 m0, s62, 77824
    s_add_u32 s79, s86, 774144
    buffer_load_dwordx4 v3, s[24:27], s79 offen lds
    s_waitcnt lgkmcnt(3)
    v_mfma_f32_32x32x16_bf16 v[142:157], a[160:163], v[194:197], v[142:157]
    v_mul_f32 v198, v110, v110
    v_mul_f32 v199, v111, v111
    v_mul_f32 v200, v112, v112
    v_mul_f32 v201, v113, v113
    v_fma_f32 v198, v198, v217, v216
    v_fma_f32 v199, v199, v217, v216
    v_mfma_f32_32x32x16_bf16 v[158:173], a[164:167], v[194:197], v[158:173]
    ds_read_b128 v[186:189], v33 offset:41984
    v_fma_f32 v200, v200, v217, v216
    v_fma_f32 v201, v201, v217, v216
    v_mul_f32 v198, v198, v110
    v_mul_f32 v199, v199, v111
    s_waitcnt lgkmcnt(3)
    v_mfma_f32_32x32x16_bf16 v[142:157], a[168:171], v[174:177], v[142:157]
    s_add_u32 m0, s62, 81920
    s_add_u32 s79, s86, 788480
    buffer_load_dwordx4 v3, s[24:27], s79 offen lds
    v_mul_f32 v200, v200, v112
    v_mul_f32 v201, v201, v113
    v_mfma_f32_32x32x16_bf16 v[158:173], a[172:175], v[174:177], v[158:173]
    ds_read_b128 v[190:193], v33 offset:43008
    v_exp_f32 v198, v198
    v_exp_f32 v199, v199
    s_waitcnt lgkmcnt(3)
    v_mfma_f32_32x32x16_bf16 v[142:157], a[176:179], v[178:181], v[142:157]
    v_exp_f32 v200, v200
    v_exp_f32 v201, v201
    v_mul_f32 v110, v110, v118
    v_mul_f32 v111, v111, v119
    v_mfma_f32_32x32x16_bf16 v[158:173], a[180:183], v[178:181], v[158:173]
    ds_read_b128 v[194:197], v33 offset:44032
    s_add_u32 m0, s62, 86016
    s_add_u32 s79, s68, 114688
    buffer_load_dwordx4 v3, s[24:27], s79 offen lds
    s_waitcnt lgkmcnt(3)
    v_mfma_f32_32x32x16_bf16 v[142:157], a[184:187], v[182:185], v[142:157]
    v_mul_f32 v112, v112, v120
    v_mul_f32 v113, v113, v121
    v_fma_f32 v198, v198, v225, v225
    v_fma_f32 v199, v199, v225, v225
    v_fma_f32 v200, v200, v225, v225
    v_fma_f32 v201, v201, v225, v225
    v_mfma_f32_32x32x16_bf16 v[158:173], a[188:191], v[182:185], v[158:173]
    ds_read_b128 v[174:177], v33 offset:45056
    v_rcp_f32 v198, v198
    v_rcp_f32 v199, v199
    s_waitcnt lgkmcnt(3)
    v_mfma_f32_32x32x16_bf16 v[142:157], a[192:195], v[186:189], v[142:157]
    s_add_u32 m0, s62, 90112
    s_add_u32 s79, s68, 129024
    buffer_load_dwordx4 v3, s[24:27], s79 offen lds
    v_rcp_f32 v200, v200
    v_mfma_f32_32x32x16_bf16 v[158:173], a[196:199], v[186:189], v[158:173]
    ds_read_b128 v[178:181], v33 offset:46080
    v_rcp_f32 v201, v201
    v_mul_f32 v110, v110, v198
    v_mul_f32 v111, v111, v199
    s_waitcnt lgkmcnt(3)
    v_mfma_f32_32x32x16_bf16 v[142:157], a[200:203], v[190:193], v[142:157]
    s_waitcnt vmcnt(4)
    v_mul_f32 v112, v112, v200
    v_mul_f32 v113, v113, v201
    v_cvt_pk_bf16_f32 v228, v110, v111
    v_cvt_pk_bf16_f32 v229, v112, v113
    v_mul_f32 v198, v114, v114
    v_mfma_f32_32x32x16_bf16 v[158:173], a[204:207], v[190:193], v[158:173]
    ds_read_b128 v[182:185], v33 offset:47104
    v_mov_b32 v7, 1
    s_mov_b64 exec, 1
    s_cmp_lg_u32 s61, 0
    s_cbranch_scc1 L_var7_wt
    buffer_store_dword v7, off, s[32:35], s89
L_var7_end:
    s_mov_b64 exec, -1
    s_add_u32 s91, s89, 256
    v_mov_b32 v7, 1
    s_mov_b64 exec, 1
    s_cmp_lg_u32 s61, 0
    s_cbranch_scc1 L_var8_wt
    buffer_store_dword v7, off, s[32:35], s91
L_var8_end:
    s_mov_b64 exec, -1
    s_waitcnt lgkmcnt(3)
    v_mfma_f32_32x32x16_bf16 v[142:157], a[208:211], v[194:197], v[142:157]
    s_add_u32 m0, s62, 94208
    s_add_u32 s79, s68, 143360
    buffer_load_dwordx4 v3, s[24:27], s79 offen lds
    v_mul_f32 v199, v115, v115
    v_mul_f32 v200, v116, v116
    v_mfma_f32_32x32x16_bf16 v[158:173], a[212:215], v[194:197], v[158:173]
    s_barrier
    ds_read_b128 v[186:189], v33 offset:48128
    v_mul_f32 v201, v117, v117
    v_fma_f32 v198, v198, v217, v216
    v_fma_f32 v199, v199, v217, v216
    s_waitcnt lgkmcnt(3)
    v_mfma_f32_32x32x16_bf16 v[142:157], a[216:219], v[174:177], v[142:157]
    s_add_u32 m0, s62, 98304
    s_add_u32 s79, s68, 157696
    buffer_load_dwordx4 v3, s[24:27], s79 offen lds
    v_fma_f32 v200, v200, v217, v216
    v_fma_f32 v201, v201, v217, v216
    v_mfma_f32_32x32x16_bf16 v[158:173], a[220:223], v[174:177], v[158:173]
    v_mul_f32 v198, v198, v114
    v_mul_f32 v199, v199, v115
    v_mul_f32 v200, v200, v116
    v_mul_f32 v201, v201, v117
    s_waitcnt lgkmcnt(2)
    v_mfma_f32_32x32x16_bf16 v[142:157], a[224:227], v[178:181], v[142:157]
    buffer_load_dword v243, v242, s[32:35], s96 offen sc1
    v_exp_f32 v198, v198
    v_exp_f32 v199, v199
    v_mfma_f32_32x32x16_bf16 v[158:173], a[228:231], v[178:181], v[158:173]
    s_add_u32 m0, s62, 102400
    s_add_u32 s79, s68, 172032
    buffer_load_dwordx4 v3, s[24:27], s79 offen lds
    s_waitcnt lgkmcnt(1)
    v_mfma_f32_32x32x16_bf16 v[142:157], a[232:235], v[182:185], v[142:157]
    v_exp_f32 v200, v200
    v_exp_f32 v201, v201
    v_mul_f32 v114, v114, v122
    v_mul_f32 v115, v115, v123
    v_mfma_f32_32x32x16_bf16 v[158:173], a[236:239], v[182:185], v[158:173]
    v_mul_f32 v116, v116, v124
    v_mul_f32 v117, v117, v125
    v_fma_f32 v198, v198, v225, v225
    v_fma_f32 v199, v199, v225, v225
    v_fma_f32 v200, v200, v225, v225
    s_waitcnt lgkmcnt(0)
    v_mfma_f32_32x32x16_bf16 v[142:157], a[240:243], v[186:189], v[142:157]
    s_add_u32 m0, s62, 106496
    s_add_u32 s79, s68, 186368
    buffer_load_dwordx4 v3, s[24:27], s79 offen lds
    v_fma_f32 v201, v201, v225, v225
    v_mfma_f32_32x32x16_bf16 v[158:173], a[244:247], v[186:189], v[158:173]
    v_rcp_f32 v198, v198
    v_rcp_f32 v199, v199
    v_rcp_f32 v200, v200
    v_rcp_f32 v201, v201
    v_mul_f32 v114, v114, v198
    v_mul_f32 v115, v115, v199
    v_mul_f32 v116, v116, v200
    v_mul_f32 v117, v117, v201
    v_cvt_pk_bf16_f32 v230, v114, v115
    v_cvt_pk_bf16_f32 v231, v116, v117
    s_add_u32 s71, s92, 0xa8000
    buffer_store_dwordx4 v[228:231], v2, s[32:35], s71 offen sc1
    v_mov_b32 v24, v226
    s_nop 1
    v_mfma_f32_32x32x16_bf16 v[142:157], a[18:21], v[24:27], v[142:157]
    v_mfma_f32_32x32x16_bf16 v[158:173], a[20:23], v[24:27], v[158:173]
    s_waitcnt vmcnt(3)
    s_mov_b32 s73, 0
L_peek_146:
    v_cmp_le_u32 s[44:45], 1, v243
    s_add_u32 s73, s73, 1
    s_cmp_eq_u64 s[44:45], -1
    s_cbranch_scc1 L_peek_146_ok
    s_cmp_ge_u32 s73, 262144
    s_cbranch_scc1 L_peek_146_ok
    buffer_load_dword v243, v242, s[32:35], s96 offen sc1
    s_waitcnt vmcnt(0)
    s_branch L_peek_146
L_peek_146_ok:
    s_add_u32 s98, s97, 0x70000
    buffer_load_dwordx4 v[46:49], v2, s[32:35], s98 offen offset:0 sc1
    v_pk_mul_f32 v[198:199], v[126:127], v[126:127]
    v_pk_mul_f32 v[200:201], v[128:129], v[128:129]
    v_pk_mul_f32 v[202:203], v[130:131], v[130:131]
    v_pk_mul_f32 v[204:205], v[132:133], v[132:133]
    v_pk_fma_f32 v[198:199], v[198:199], v[216:217], v[216:217] op_sel:[0,1,0] op_sel_hi:[1,1,0]
    v_pk_fma_f32 v[200:201], v[200:201], v[216:217], v[216:217] op_sel:[0,1,0] op_sel_hi:[1,1,0]
    v_pk_fma_f32 v[202:203], v[202:203], v[216:217], v[216:217] op_sel:[0,1,0] op_sel_hi:[1,1,0]
    v_pk_fma_f32 v[204:205], v[204:205], v[216:217], v[216:217] op_sel:[0,1,0] op_sel_hi:[1,1,0]
    v_pk_mul_f32 v[198:199], v[198:199], v[126:127]
    v_pk_mul_f32 v[200:201], v[200:201], v[128:129]
    v_pk_mul_f32 v[202:203], v[202:203], v[130:131]
    v_pk_mul_f32 v[204:205], v[204:205], v[132:133]
    buffer_load_dwordx4 v[50:53], v2, s[32:35], s98 offen offset:1024 sc1
    v_exp_f32 v198, v198
    v_exp_f32 v199, v199
    v_exp_f32 v200, v200
    v_exp_f32 v201, v201
    v_exp_f32 v202, v202
    v_exp_f32 v203, v203
    v_exp_f32 v204, v204
    v_exp_f32 v205, v205
    v_pk_mul_f32 v[126:127], v[126:127], v[134:135]
    v_pk_mul_f32 v[128:129], v[128:129], v[136:137]
    v_pk_mul_f32 v[130:131], v[130:131], v[138:139]
    v_pk_mul_f32 v[132:133], v[132:133], v[140:141]
    buffer_load_dwordx4 v[54:57], v2, s[32:35], s98 offen offset:2048 sc1
    v_pk_fma_f32 v[198:199], v[198:199], v[224:225], v[224:225] op_sel:[0,1,1] op_sel_hi:[1,1,1]
    v_pk_fma_f32 v[200:201], v[200:201], v[224:225], v[224:225] op_sel:[0,1,1] op_sel_hi:[1,1,1]
    v_pk_fma_f32 v[202:203], v[202:203], v[224:225], v[224:225] op_sel:[0,1,1] op_sel_hi:[1,1,1]
    v_pk_fma_f32 v[204:205], v[204:205], v[224:225], v[224:225] op_sel:[0,1,1] op_sel_hi:[1,1,1]
    v_rcp_f32 v198, v198
    v_rcp_f32 v199, v199
    v_rcp_f32 v200, v200
    v_rcp_f32 v201, v201
    v_rcp_f32 v202, v202
    v_rcp_f32 v203, v203
    v_rcp_f32 v204, v204
    v_rcp_f32 v205, v205
    buffer_load_dwordx4 v[58:61], v2, s[32:35], s98 offen offset:3072 sc1
    v_pk_mul_f32 v[126:127], v[126:127], v[198:199]
    v_pk_mul_f32 v[128:129], v[128:129], v[200:201]
    v_pk_mul_f32 v[130:131], v[130:131], v[202:203]
    v_pk_mul_f32 v[132:133], v[132:133], v[204:205]
    v_cvt_pk_bf16_f32 v232, v126, v127
    v_cvt_pk_bf16_f32 v233, v128, v129
    v_cvt_pk_bf16_f32 v234, v130, v131
    v_cvt_pk_bf16_f32 v235, v132, v133
    s_add_u32 s71, s92, 0xa9000
    buffer_store_dwordx4 v[232:235], v2, s[32:35], s71 offen sc1
    v_pk_mul_f32 v[206:207], v[142:143], v[142:143]
    v_pk_mul_f32 v[208:209], v[144:145], v[144:145]
    s_add_u32 s98, s97, 0x71000
    buffer_load_dwordx4 v[62:65], v2, s[32:35], s98 offen offset:0 sc1
    v_pk_mul_f32 v[210:211], v[146:147], v[146:147]
    v_pk_mul_f32 v[212:213], v[148:149], v[148:149]
    v_pk_fma_f32 v[206:207], v[206:207], v[218:219], v[218:219] op_sel:[0,1,0] op_sel_hi:[1,1,0]
    v_pk_fma_f32 v[208:209], v[208:209], v[218:219], v[218:219] op_sel:[0,1,0] op_sel_hi:[1,1,0]
    v_pk_fma_f32 v[210:211], v[210:211], v[218:219], v[218:219] op_sel:[0,1,0] op_sel_hi:[1,1,0]
    v_pk_fma_f32 v[212:213], v[212:213], v[218:219], v[218:219] op_sel:[0,1,0] op_sel_hi:[1,1,0]
    v_pk_mul_f32 v[206:207], v[206:207], v[142:143]
    v_pk_mul_f32 v[208:209], v[208:209], v[144:145]
    v_pk_mul_f32 v[210:211], v[210:211], v[146:147]
    v_pk_mul_f32 v[212:213], v[212:213], v[148:149]
    v_exp_f32 v206, v206
    v_exp_f32 v207, v207
    buffer_load_dwordx4 v[66:69], v2, s[32:35], s98 offen offset:1024 sc1
    v_exp_f32 v208, v208
    v_exp_f32 v209, v209
    v_exp_f32 v210, v210
    v_exp_f32 v211, v211
    v_exp_f32 v212, v212
    v_exp_f32 v213, v213
    v_pk_mul_f32 v[142:143], v[142:143], v[150:151]
    v_pk_mul_f32 v[144:145], v[144:145], v[152:153]
    v_pk_mul_f32 v[146:147], v[146:147], v[154:155]
    v_pk_mul_f32 v[148:149], v[148:149], v[156:157]
    v_pk_fma_f32 v[206:207], v[206:207], v[226:227], v[226:227] op_sel:[0,1,1] op_sel_hi:[1,1,1]
    v_pk_fma_f32 v[208:209], v[208:209], v[226:227], v[226:227] op_sel:[0,1,1] op_sel_hi:[1,1,1]
    buffer_load_dwordx4 v[70:73], v2, s[32:35], s98 offen offset:2048 sc1
    v_pk_fma_f32 v[210:211], v[210:211], v[226:227], v[226:227] op_sel:[0,1,1] op_sel_hi:[1,1,1]
    v_pk_fma_f32 v[212:213], v[212:213], v[226:227], v[226:227] op_sel:[0,1,1] op_sel_hi:[1,1,1]
    v_rcp_f32 v206, v206
    v_rcp_f32 v207, v207
    v_rcp_f32 v208, v208
    v_rcp_f32 v209, v209
    v_rcp_f32 v210, v210
    v_rcp_f32 v211, v211
    v_rcp_f32 v212, v212
    v_rcp_f32 v213, v213
    v_pk_mul_f32 v[142:143], v[142:143], v[206:207]
    v_pk_mul_f32 v[144:145], v[144:145], v[208:209]
    buffer_load_dwordx4 v[74:77], v2, s[32:35], s98 offen offset:3072 sc1
    v_pk_mul_f32 v[146:147], v[146:147], v[210:211]
    v_pk_mul_f32 v[148:149], v[148:149], v[212:213]
    v_cvt_pk_bf16_f32 v228, v142, v143
    v_cvt_pk_bf16_f32 v229, v144, v145
    v_cvt_pk_bf16_f32 v230, v146, v147
    v_cvt_pk_bf16_f32 v231, v148, v149
    s_add_u32 s71, s92, 0xc4000
    buffer_store_dwordx4 v[228:231], v2, s[32:35], s71 offen sc1
    v_pk_mul_f32 v[198:199], v[158:159], v[158:159]
    v_pk_mul_f32 v[200:201], v[160:161], v[160:161]
    v_pk_mul_f32 v[202:203], v[162:163], v[162:163]
    v_pk_mul_f32 v[204:205], v[164:165], v[164:165]
    s_add_u32 s98, s97, 0x74000
    buffer_load_dwordx4 v[78:81], v2, s[32:35], s98 offen offset:0 sc1
    v_pk_fma_f32 v[198:199], v[198:199], v[218:219], v[218:219] op_sel:[0,1,0] op_sel_hi:[1,1,0]
    v_pk_fma_f32 v[200:201], v[200:201], v[218:219], v[218:219] op_sel:[0,1,0] op_sel_hi:[1,1,0]
    v_pk_fma_f32 v[202:203], v[202:203], v[218:219], v[218:219] op_sel:[0,1,0] op_sel_hi:[1,1,0]
    v_pk_fma_f32 v[204:205], v[204:205], v[218:219], v[218:219] op_sel:[0,1,0] op_sel_hi:[1,1,0]
    v_pk_mul_f32 v[198:199], v[198:199], v[158:159]
    v_pk_mul_f32 v[200:201], v[200:201], v[160:161]
    v_pk_mul_f32 v[202:203], v[202:203], v[162:163]
    v_pk_mul_f32 v[204:205], v[204:205], v[164:165]
    v_exp_f32 v198, v198
    v_exp_f32 v199, v199
    v_exp_f32 v200, v200
    v_exp_f32 v201, v201
    buffer_load_dwordx4 v[82:85], v2, s[32:35], s98 offen offset:1024 sc1
    v_exp_f32 v202, v202
    v_exp_f32 v203, v203
    v_exp_f32 v204, v204
    v_exp_f32 v205, v205
    v_pk_mul_f32 v[158:159], v[158:159], v[166:167]
    v_pk_mul_f32 v[160:161], v[160:161], v[168:169]
    v_pk_mul_f32 v[162:163], v[162:163], v[170:171]
    v_pk_mul_f32 v[164:165], v[164:165], v[172:173]
    v_pk_fma_f32 v[198:199], v[198:199], v[226:227], v[226:227] op_sel:[0,1,1] op_sel_hi:[1,1,1]
    v_pk_fma_f32 v[200:201], v[200:201], v[226:227], v[226:227] op_sel:[0,1,1] op_sel_hi:[1,1,1]
    v_pk_fma_f32 v[202:203], v[202:203], v[226:227], v[226:227] op_sel:[0,1,1] op_sel_hi:[1,1,1]
    v_pk_fma_f32 v[204:205], v[204:205], v[226:227], v[226:227] op_sel:[0,1,1] op_sel_hi:[1,1,1]
    v_rcp_f32 v198, v198
    v_rcp_f32 v199, v199
    v_rcp_f32 v200, v200
    v_rcp_f32 v201, v201
    v_rcp_f32 v202, v202
    v_rcp_f32 v203, v203
    v_rcp_f32 v204, v204
    v_rcp_f32 v205, v205
    v_pk_mul_f32 v[158:159], v[158:159], v[198:199]
    v_pk_mul_f32 v[160:161], v[160:161], v[200:201]
    v_pk_mul_f32 v[162:163], v[162:163], v[202:203]
    v_pk_mul_f32 v[164:165], v[164:165], v[204:205]
    v_cvt_pk_bf16_f32 v232, v158, v159
    v_cvt_pk_bf16_f32 v233, v160, v161
    v_cvt_pk_bf16_f32 v234, v162, v163
    v_cvt_pk_bf16_f32 v235, v164, v165
    s_add_u32 s71, s92, 0xc5000
    buffer_store_dwordx4 v[232:235], v2, s[32:35], s71 offen sc1
L_c_k40:
    v_lshrrev_b32 v214, 4, v1
    v_bfe_u32 v215, v1, 2, 2
    v_and_b32 v216, 3, v1
    v_and_b32 v217, 1, v214
    v_lshlrev_b32 v217, 1, v217
    v_lshrrev_b32 v45, 1, v216
    v_add_u32 v217, v217, v45
    v_and_b32 v45, 2, v215
    v_lshlrev_b32 v45, 1, v45
    v_xor_b32 v217, v217, v45
    v_lshlrev_b32 v217, 4, v217
    v_and_b32 v216, 1, v216
    v_lshl_add_u32 v217, v216, 3, v217
    v_lshrrev_b32 v214, 1, v214
    v_lshl_add_u32 v215, v214, 2, v215
    v_lshl_add_u32 v44, v215, 7, v217
    v_xor_b32 v45, 64, v44
    s_mul_i32 s69, s76, 2048
    s_lshl_b32 s71, s76, 6
    v_xor_b32 v44, s71, v44
    v_add_u32 v44, s69, v44
    v_xor_b32 v45, s71, v45
    v_add_u32 v45, s69, v45
    s_lshl_b32 s88, s56, 12
    s_add_u32 s88, s88, 135168
    v_add_u32 v214, s88, v2
    s_xor_b32 s88, s56, 2
    s_lshl_b32 s88, s88, 12
    s_add_u32 s88, s88, 135168
    v_add_u32 v215, s88, v2
    s_mul_i32 s88, s75, 28672
    s_lshl_b32 s92, s60, 12
    s_add_u32 s88, s88, s92
    s_lshl_b32 s92, s76, 11
    s_add_u32 s88, s88, s92
    s_add_u32 s88, s88, s63
    s_add_u32 s88, s88, 0x50000
    s_lshl_b32 s90, s60, 1
    s_add_u32 s90, s90, s76
    s_lshl_b32 s92, s75, 7
    s_add_u32 s92, s92, s63
    s_mul_i32 s72, s90, 4
    s_add_u32 s92, s92, s72
    s_add_u32 s92, s92, 512
    s_cmp_ge_u32 s90, 7
    s_cselect_b32 s72, 7, 0
    s_sub_u32 s90, s90, s72
    s_mul_i32 s72, s72, 73
    s_add_u32 s72, s72, 1
    s_and_b32 s72, s72, 512
    s_lshr_b32 s79, s90, 1
    s_lshl_b32 s79, s79, 10
    s_add_u32 s72, s72, s79
    s_and_b32 s90, s90, 1
    s_lshl_b32 s90, s90, 3
    s_add_u32 s90, s90, s72
    s_lshl_b32 s72, s75, 12
    s_add_u32 s90, s90, s72
    s_add_u32 s90, s90, s63
    s_add_u32 s90, s90, 0x5000
    v_and_b32 v216, 31, v1
    v_lshlrev_b32 v216, 4, v216
    s_waitcnt vmcnt(0)
    s_add_u32 s91, s93, 512
    v_mov_b32 v7, 1
    s_mov_b64 exec, 1
    s_cmp_lg_u32 s61, 0
    s_cbranch_scc1 L_var9_wt
    buffer_store_dword v7, off, s[32:35], s91
L_var9_end:
    s_mov_b64 exec, -1
    s_add_u32 s91, s93, 768
    v_mov_b32 v7, 1
    s_mov_b64 exec, 1
    s_cmp_lg_u32 s61, 0
    s_cbranch_scc1 L_var10_wt
    buffer_store_dword v7, off, s[32:35], s91
L_var10_end:
    s_mov_b64 exec, -1
    s_lshr_b32 s72, s2, 3
    s_lshl_b32 s72, s72, 2
    s_add_u32 s72, s72, s56
    s_mul_i32 s72, s72, 128
    s_add_u32 s72, s72, L_k1b-interleave_layers__linear_kernel_hedgehog__glu_gated_geglu__prompt_kernel
    v_lshlrev_b32 v218, 7, v1
    v_add_u32 v218, s72, v218
    v_min_u32 v218, L_c_k2b1-interleave_layers__linear_kernel_hedgehog__glu_gated_geglu__prompt_kernel-4, v218
    s_mov_b64 exec, 1
    global_load_dword a0, v218, s[52:53]
    s_mov_b64 exec, -1
    s_barrier
    buffer_load_dwordx4 v[86:89], v2, s[32:35], s98 offen offset:2048 sc1
    buffer_load_dwordx4 v[90:93], v2, s[32:35], s98 offen offset:3072 sc1
    v_add_u32 v44, 114688, v44
    ds_read_b64_tr_b16 v[190:191], v44 offset:0
    ds_read_b64_tr_b16 v[192:193], v44 offset:1024
    v_add_u32 v45, 114688, v45
    ds_read_b64_tr_b16 v[194:195], v45 offset:0
    ds_read_b64_tr_b16 v[196:197], v45 offset:1024
    ds_read_b64_tr_b16 v[198:199], v44 offset:4096
    ds_read_b64_tr_b16 v[200:201], v44 offset:5120
    ds_read_b64_tr_b16 v[202:203], v45 offset:4096
    ds_read_b64_tr_b16 v[204:205], v45 offset:5120
    s_waitcnt lgkmcnt(4)
    v_mfma_f32_32x32x16_bf16 v[28:43], v[190:193], v[46:49], 0
    ds_read_b64_tr_b16 v[206:207], v44 offset:8192
    ds_read_b64_tr_b16 v[208:209], v44 offset:9216
    s_add_u32 s98, s97, 0x75000
    buffer_load_dwordx4 v[94:97], v2, s[32:35], s98 offen offset:0 sc1
    v_mfma_f32_32x32x16_bf16 v[174:189], v[194:197], v[46:49], 0
    ds_read_b64_tr_b16 v[210:211], v45 offset:8192
    ds_read_b64_tr_b16 v[212:213], v45 offset:9216
    s_add_u32 m0, s62, 110592
    s_add_u32 s79, s68, 200704
    buffer_load_dwordx4 v3, s[24:27], s79 offen lds
    s_waitcnt lgkmcnt(4)
    v_mfma_f32_32x32x16_bf16 v[28:43], v[198:201], v[50:53], v[28:43]
    ds_read_b64_tr_b16 v[190:191], v44 offset:12288
    ds_read_b64_tr_b16 v[192:193], v44 offset:13312
    v_mfma_f32_32x32x16_bf16 v[174:189], v[202:205], v[50:53], v[174:189]
    ds_read_b64_tr_b16 v[194:195], v45 offset:12288
    ds_read_b64_tr_b16 v[196:197], v45 offset:13312
    buffer_load_dwordx4 v[98:101], v2, s[32:35], s98 offen offset:1024 sc1
    s_waitcnt lgkmcnt(4)
    v_mfma_f32_32x32x16_bf16 v[28:43], v[206:209], v[54:57], v[28:43]
    ds_read_b64_tr_b16 v[198:199], v44 offset:16384
    ds_read_b64_tr_b16 v[200:201], v44 offset:17408
    buffer_load_dwordx4 v[102:105], v2, s[32:35], s98 offen offset:2048 sc1
    v_mfma_f32_32x32x16_bf16 v[174:189], v[210:213], v[54:57], v[174:189]
    ds_read_b64_tr_b16 v[202:203], v45 offset:16384
    ds_read_b64_tr_b16 v[204:205], v45 offset:17408
    s_waitcnt lgkmcnt(4)
    v_mfma_f32_32x32x16_bf16 v[28:43], v[190:193], v[58:61], v[28:43]
    ds_read_b64_tr_b16 v[206:207], v44 offset:20480
    ds_read_b64_tr_b16 v[208:209], v44 offset:21504
    buffer_load_dwordx4 v[106:109], v2, s[32:35], s98 offen offset:3072 sc1
    v_mfma_f32_32x32x16_bf16 v[174:189], v[194:197], v[58:61], v[174:189]
    ds_read_b64_tr_b16 v[210:211], v45 offset:20480
    ds_read_b64_tr_b16 v[212:213], v45 offset:21504
    s_barrier
    s_waitcnt lgkmcnt(4)
    v_mfma_f32_32x32x16_bf16 v[28:43], v[198:201], v[62:65], v[28:43]
    ds_read_b64_tr_b16 v[190:191], v44 offset:24576
    ds_read_b64_tr_b16 v[192:193], v44 offset:25600
    s_add_u32 s98, s97, 0x78000
    buffer_load_dwordx4 v[110:113], v2, s[32:35], s98 offen offset:0 sc1
    v_mfma_f32_32x32x16_bf16 v[174:189], v[202:205], v[62:65], v[174:189]
    ds_read_b64_tr_b16 v[194:195], v45 offset:24576
    ds_read_b64_tr_b16 v[196:197], v45 offset:25600
    s_add_u32 m0, s62, 114688
    s_add_u32 s79, s68, 215040
    buffer_load_dwordx4 v3, s[24:27], s79 offen lds
    s_waitcnt lgkmcnt(4)
    v_mfma_f32_32x32x16_bf16 v[28:43], v[206:209], v[66:69], v[28:43]
    ds_read_b64_tr_b16 v[198:199], v44 offset:28672
    ds_read_b64_tr_b16 v[200:201], v44 offset:29696
    buffer_load_dwordx4 v[114:117], v2, s[32:35], s98 offen offset:1024 sc1
    v_mfma_f32_32x32x16_bf16 v[174:189], v[210:213], v[66:69], v[174:189]
    ds_read_b64_tr_b16 v[202:203], v45 offset:28672
    ds_read_b64_tr_b16 v[204:205], v45 offset:29696
    s_waitcnt lgkmcnt(4)
    v_mfma_f32_32x32x16_bf16 v[28:43], v[190:193], v[70:73], v[28:43]
    ds_read_b64_tr_b16 v[206:207], v44 offset:32768
    ds_read_b64_tr_b16 v[208:209], v44 offset:33792
    s_add_u32 m0, s62, 118784
    s_add_u32 s79, s68, 344064
    buffer_load_dwordx4 v3, s[24:27], s79 offen lds
    v_mfma_f32_32x32x16_bf16 v[174:189], v[194:197], v[70:73], v[174:189]
    ds_read_b64_tr_b16 v[210:211], v45 offset:32768
    ds_read_b64_tr_b16 v[212:213], v45 offset:33792
    buffer_load_dwordx4 v[118:121], v2, s[32:35], s98 offen offset:2048 sc1
    s_waitcnt lgkmcnt(4)
    v_mfma_f32_32x32x16_bf16 v[28:43], v[198:201], v[74:77], v[28:43]
    ds_read_b64_tr_b16 v[190:191], v44 offset:36864
    ds_read_b64_tr_b16 v[192:193], v44 offset:37888
    buffer_load_dwordx4 v[122:125], v2, s[32:35], s98 offen offset:3072 sc1
    v_mfma_f32_32x32x16_bf16 v[174:189], v[202:205], v[74:77], v[174:189]
    ds_read_b64_tr_b16 v[194:195], v45 offset:36864
    ds_read_b64_tr_b16 v[196:197], v45 offset:37888
    s_barrier
    s_waitcnt lgkmcnt(4)
    v_mfma_f32_32x32x16_bf16 v[28:43], v[206:209], v[78:81], v[28:43]
    ds_read_b64_tr_b16 v[198:199], v44 offset:40960
    ds_read_b64_tr_b16 v[200:201], v44 offset:41984
    buffer_load_dword v241, v240, s[32:35], s95 offen sc1
    v_mfma_f32_32x32x16_bf16 v[174:189], v[210:213], v[78:81], v[174:189]
    ds_read_b64_tr_b16 v[202:203], v45 offset:40960
    ds_read_b64_tr_b16 v[204:205], v45 offset:41984
    s_add_u32 s98, s97, 0x79000
    buffer_load_dwordx4 v[126:129], v2, s[32:35], s98 offen offset:0 sc1
    s_waitcnt lgkmcnt(4)
    v_mfma_f32_32x32x16_bf16 v[28:43], v[190:193], v[82:85], v[28:43]
    v_add_u32 v44, 4294852608, v44
    ds_read_b64_tr_b16 v[206:207], v44 offset:0
    ds_read_b64_tr_b16 v[208:209], v44 offset:1024
    s_add_u32 m0, s62, 122880
    s_add_u32 s79, s68, 358400
    buffer_load_dwordx4 v3, s[24:27], s79 offen lds
    v_mfma_f32_32x32x16_bf16 v[174:189], v[194:197], v[82:85], v[174:189]
    v_add_u32 v45, 4294852608, v45
    ds_read_b64_tr_b16 v[210:211], v45 offset:0
    ds_read_b64_tr_b16 v[212:213], v45 offset:1024
    buffer_load_dwordx4 v[130:133], v2, s[32:35], s98 offen offset:1024 sc1
    s_waitcnt vmcnt(16) lgkmcnt(4)
    v_mfma_f32_32x32x16_bf16 v[28:43], v[198:201], v[86:89], v[28:43]
    ds_read_b64_tr_b16 v[190:191], v44 offset:4096
    ds_read_b64_tr_b16 v[192:193], v44 offset:5120
    s_add_u32 m0, s62, 126976
    s_add_u32 s79, s68, 372736
    buffer_load_dwordx4 v3, s[24:27], s79 offen lds
    v_mfma_f32_32x32x16_bf16 v[174:189], v[202:205], v[86:89], v[174:189]
    ds_read_b64_tr_b16 v[194:195], v45 offset:4096
    ds_read_b64_tr_b16 v[196:197], v45 offset:5120
    buffer_load_dwordx4 v[134:137], v2, s[32:35], s98 offen offset:2048 sc1
    s_waitcnt vmcnt(17) lgkmcnt(4)
    v_mfma_f32_32x32x16_bf16 v[28:43], v[206:209], v[90:93], v[28:43]
    ds_read_b64_tr_b16 v[198:199], v44 offset:8192
    ds_read_b64_tr_b16 v[200:201], v44 offset:9216
    buffer_load_dwordx4 v[138:141], v2, s[32:35], s98 offen offset:3072 sc1
    v_mfma_f32_32x32x16_bf16 v[174:189], v[210:213], v[90:93], v[174:189]
    ds_read_b64_tr_b16 v[202:203], v45 offset:8192
    ds_read_b64_tr_b16 v[204:205], v45 offset:9216
    s_barrier
    s_waitcnt vmcnt(6)
    s_mov_b32 s73, 0
L_peek_260:
    v_cmp_le_u32 s[44:45], 1, v241
    s_add_u32 s73, s73, 1
    s_cmp_eq_u64 s[44:45], -1
    s_cbranch_scc1 L_peek_260_ok
    s_cmp_ge_u32 s73, 262144
    s_cbranch_scc1 L_peek_260_ok
    buffer_load_dword v241, v240, s[32:35], s95 offen sc1
    s_waitcnt vmcnt(0)
    s_branch L_peek_260
L_peek_260_ok:
    s_waitcnt lgkmcnt(4)
    v_mfma_f32_32x32x16_bf16 v[28:43], v[190:193], v[94:97], v[28:43]
    ds_read_b64_tr_b16 v[206:207], v44 offset:12288
    ds_read_b64_tr_b16 v[208:209], v44 offset:13312
    s_add_u32 s98, s99, 0x7c000
    buffer_load_dwordx4 v[142:145], v2, s[32:35], s98 offen offset:0 sc1
    v_mfma_f32_32x32x16_bf16 v[174:189], v[194:197], v[94:97], v[174:189]
    ds_read_b64_tr_b16 v[210:211], v45 offset:12288
    ds_read_b64_tr_b16 v[212:213], v45 offset:13312
    s_add_u32 m0, s62, 131072
    s_add_u32 s79, s68, 387072
    buffer_load_dwordx4 v3, s[24:27], s79 offen lds
    s_waitcnt lgkmcnt(4)
    v_mfma_f32_32x32x16_bf16 v[28:43], v[198:201], v[98:101], v[28:43]
    ds_read_b64_tr_b16 v[190:191], v44 offset:16384
    ds_read_b64_tr_b16 v[192:193], v44 offset:17408
    buffer_load_dwordx4 v[146:149], v2, s[32:35], s98 offen offset:1024 sc1
    v_mfma_f32_32x32x16_bf16 v[174:189], v[202:205], v[98:101], v[174:189]
    ds_read_b64_tr_b16 v[194:195], v45 offset:16384
    ds_read_b64_tr_b16 v[196:197], v45 offset:17408
    s_waitcnt lgkmcnt(4)
    v_mfma_f32_32x32x16_bf16 v[28:43], v[206:209], v[102:105], v[28:43]
    ds_read_b64_tr_b16 v[198:199], v44 offset:20480
    ds_read_b64_tr_b16 v[200:201], v44 offset:21504
    s_add_u32 m0, s62, 135168
    s_add_u32 s79, s68, 401408
    buffer_load_dwordx4 v3, s[24:27], s79 offen lds
    v_mfma_f32_32x32x16_bf16 v[174:189], v[210:213], v[102:105], v[174:189]
    ds_read_b64_tr_b16 v[202:203], v45 offset:20480
    ds_read_b64_tr_b16 v[204:205], v45 offset:21504
    buffer_load_dwordx4 v[150:153], v2, s[32:35], s98 offen offset:2048 sc1
    s_waitcnt lgkmcnt(4)
    v_mfma_f32_32x32x16_bf16 v[28:43], v[190:193], v[106:109], v[28:43]
    ds_read_b64_tr_b16 v[206:207], v44 offset:24576
    ds_read_b64_tr_b16 v[208:209], v44 offset:25600
    buffer_load_dwordx4 v[154:157], v2, s[32:35], s98 offen offset:3072 sc1
    v_mfma_f32_32x32x16_bf16 v[174:189], v[194:197], v[106:109], v[174:189]
    ds_read_b64_tr_b16 v[210:211], v45 offset:24576
    ds_read_b64_tr_b16 v[212:213], v45 offset:25600
    s_barrier
    s_waitcnt lgkmcnt(4)
    v_mfma_f32_32x32x16_bf16 v[28:43], v[198:201], v[110:113], v[28:43]
    ds_read_b64_tr_b16 v[190:191], v44 offset:28672
    ds_read_b64_tr_b16 v[192:193], v44 offset:29696
    s_add_u32 s98, s99, 0x7d000
    buffer_load_dwordx4 v[158:161], v2, s[32:35], s98 offen offset:0 sc1
    v_mfma_f32_32x32x16_bf16 v[174:189], v[202:205], v[110:113], v[174:189]
    ds_read_b64_tr_b16 v[194:195], v45 offset:28672
    ds_read_b64_tr_b16 v[196:197], v45 offset:29696
    s_add_u32 m0, s62, 139264
    s_add_u32 s79, s68, 415744
    buffer_load_dwordx4 v3, s[24:27], s79 offen lds
    s_waitcnt lgkmcnt(4)
    v_mfma_f32_32x32x16_bf16 v[28:43], v[206:209], v[114:117], v[28:43]
    ds_read_b64_tr_b16 v[198:199], v44 offset:32768
    ds_read_b64_tr_b16 v[200:201], v44 offset:33792
    buffer_load_dwordx4 v[162:165], v2, s[32:35], s98 offen offset:1024 sc1
    v_mfma_f32_32x32x16_bf16 v[174:189], v[210:213], v[114:117], v[174:189]
    ds_read_b64_tr_b16 v[202:203], v45 offset:32768
    ds_read_b64_tr_b16 v[204:205], v45 offset:33792
    s_waitcnt lgkmcnt(4)
    v_mfma_f32_32x32x16_bf16 v[28:43], v[190:193], v[118:121], v[28:43]
    ds_read_b64_tr_b16 v[206:207], v44 offset:36864
    ds_read_b64_tr_b16 v[208:209], v44 offset:37888
    s_add_u32 m0, s62, 143360
    s_add_u32 s79, s68, 430080
    buffer_load_dwordx4 v3, s[24:27], s79 offen lds
    v_mfma_f32_32x32x16_bf16 v[174:189], v[194:197], v[118:121], v[174:189]
    ds_read_b64_tr_b16 v[210:211], v45 offset:36864
    ds_read_b64_tr_b16 v[212:213], v45 offset:37888
    buffer_load_dwordx4 v[166:169], v2, s[32:35], s98 offen offset:2048 sc1
    s_waitcnt lgkmcnt(4)
    v_mfma_f32_32x32x16_bf16 v[28:43], v[198:201], v[122:125], v[28:43]
    ds_read_b64_tr_b16 v[190:191], v44 offset:40960
    ds_read_b64_tr_b16 v[192:193], v44 offset:41984
    buffer_load_dwordx4 v[170:173], v2, s[32:35], s98 offen offset:3072 sc1
    v_mfma_f32_32x32x16_bf16 v[174:189], v[202:205], v[122:125], v[174:189]
    ds_read_b64_tr_b16 v[194:195], v45 offset:40960
    ds_read_b64_tr_b16 v[196:197], v45 offset:41984
    s_barrier
    s_waitcnt vmcnt(17) lgkmcnt(4)
    v_mfma_f32_32x32x16_bf16 v[28:43], v[206:209], v[126:129], v[28:43]
    ds_read_b64_tr_b16 v[198:199], v44 offset:45056
    ds_read_b64_tr_b16 v[200:201], v44 offset:46080
    s_add_u32 s98, s97, 0x72000
    buffer_load_dwordx4 v[46:49], v2, s[32:35], s98 offen offset:0 sc1
    v_mfma_f32_32x32x16_bf16 v[174:189], v[210:213], v[126:129], v[174:189]
    ds_read_b64_tr_b16 v[202:203], v45 offset:45056
    ds_read_b64_tr_b16 v[204:205], v45 offset:46080
    s_add_u32 m0, s62, 147456
    s_add_u32 s79, s68, 444416
    buffer_load_dwordx4 v3, s[24:27], s79 offen lds
    s_waitcnt vmcnt(17) lgkmcnt(4)
    v_mfma_f32_32x32x16_bf16 v[28:43], v[190:193], v[130:133], v[28:43]
    ds_read_b64_tr_b16 v[206:207], v44 offset:49152
    ds_read_b64_tr_b16 v[208:209], v44 offset:50176
    buffer_load_dwordx4 v[50:53], v2, s[32:35], s98 offen offset:1024 sc1
    v_mfma_f32_32x32x16_bf16 v[174:189], v[194:197], v[130:133], v[174:189]
    ds_read_b64_tr_b16 v[210:211], v45 offset:49152
    ds_read_b64_tr_b16 v[212:213], v45 offset:50176
    s_waitcnt vmcnt(16) lgkmcnt(4)
    v_mfma_f32_32x32x16_bf16 v[28:43], v[198:201], v[134:137], v[28:43]
    ds_read_b64_tr_b16 v[190:191], v44 offset:53248
    ds_read_b64_tr_b16 v[192:193], v44 offset:54272
    s_add_u32 m0, s62, 151552
    s_add_u32 s79, s68, 573440
    buffer_load_dwordx4 v3, s[24:27], s79 offen lds
    v_mfma_f32_32x32x16_bf16 v[174:189], v[202:205], v[134:137], v[174:189]
    ds_read_b64_tr_b16 v[194:195], v45 offset:53248
    ds_read_b64_tr_b16 v[196:197], v45 offset:54272
    buffer_load_dwordx4 v[54:57], v2, s[32:35], s98 offen offset:2048 sc1
    s_waitcnt vmcnt(17) lgkmcnt(4)
    v_mfma_f32_32x32x16_bf16 v[28:43], v[206:209], v[138:141], v[28:43]
    ds_read_b64_tr_b16 v[198:199], v44 offset:57344
    ds_read_b64_tr_b16 v[200:201], v44 offset:58368
    buffer_load_dwordx4 v[58:61], v2, s[32:35], s98 offen offset:3072 sc1
    v_mfma_f32_32x32x16_bf16 v[174:189], v[210:213], v[138:141], v[174:189]
    ds_read_b64_tr_b16 v[202:203], v45 offset:57344
    ds_read_b64_tr_b16 v[204:205], v45 offset:58368
    s_barrier
    s_waitcnt vmcnt(17) lgkmcnt(4)
    v_mfma_f32_32x32x16_bf16 v[28:43], v[190:193], v[142:145], v[28:43]
    ds_read_b64_tr_b16 v[206:207], v44 offset:61440
    ds_read_b64_tr_b16 v[208:209], v44 offset:62464
    s_add_u32 s98, s97, 0x73000
    buffer_load_dwordx4 v[62:65], v2, s[32:35], s98 offen offset:0 sc1
    v_mfma_f32_32x32x16_bf16 v[174:189], v[194:197], v[142:145], v[174:189]
    ds_read_b64_tr_b16 v[210:211], v45 offset:61440
    ds_read_b64_tr_b16 v[212:213], v45 offset:62464
    s_add_u32 m0, s62, 155648
    s_add_u32 s79, s68, 587776
    buffer_load_dwordx4 v3, s[24:27], s79 offen lds
    s_waitcnt vmcnt(17) lgkmcnt(4)
    v_mfma_f32_32x32x16_bf16 v[28:43], v[198:201], v[146:149], v[28:43]
    v_add_u32 v44, 65536, v44
    ds_read_b64_tr_b16 v[190:191], v44 offset:0
    ds_read_b64_tr_b16 v[192:193], v44 offset:1024
    buffer_load_dwordx4 v[66:69], v2, s[32:35], s98 offen offset:1024 sc1
    v_mfma_f32_32x32x16_bf16 v[174:189], v[202:205], v[146:149], v[174:189]
    v_add_u32 v45, 65536, v45
    ds_read_b64_tr_b16 v[194:195], v45 offset:0
    ds_read_b64_tr_b16 v[196:197], v45 offset:1024
    s_waitcnt vmcnt(16) lgkmcnt(4)
    v_mfma_f32_32x32x16_bf16 v[28:43], v[206:209], v[150:153], v[28:43]
    ds_read_b64_tr_b16 v[198:199], v44 offset:4096
    ds_read_b64_tr_b16 v[200:201], v44 offset:5120
    s_add_u32 m0, s62, 0
    s_add_u32 s79, s68, 602112
    buffer_load_dwordx4 v3, s[24:27], s79 offen lds
    v_mfma_f32_32x32x16_bf16 v[174:189], v[210:213], v[150:153], v[174:189]
    ds_read_b64_tr_b16 v[202:203], v45 offset:4096
    ds_read_b64_tr_b16 v[204:205], v45 offset:5120
    buffer_load_dwordx4 v[70:73], v2, s[32:35], s98 offen offset:2048 sc1
    s_waitcnt vmcnt(17) lgkmcnt(4)
    v_mfma_f32_32x32x16_bf16 v[28:43], v[190:193], v[154:157], v[28:43]
    ds_read_b64_tr_b16 v[206:207], v44 offset:8192
    ds_read_b64_tr_b16 v[208:209], v44 offset:9216
    buffer_load_dwordx4 v[74:77], v2, s[32:35], s98 offen offset:3072 sc1
    v_mfma_f32_32x32x16_bf16 v[174:189], v[194:197], v[154:157], v[174:189]
    ds_read_b64_tr_b16 v[210:211], v45 offset:8192
    ds_read_b64_tr_b16 v[212:213], v45 offset:9216
    s_barrier
    s_waitcnt vmcnt(17) lgkmcnt(4)
    v_mfma_f32_32x32x16_bf16 v[28:43], v[198:201], v[158:161], v[28:43]
    ds_read_b64_tr_b16 v[190:191], v44 offset:12288
    ds_read_b64_tr_b16 v[192:193], v44 offset:13312
    s_add_u32 s98, s97, 0x76000
    buffer_load_dwordx4 v[78:81], v2, s[32:35], s98 offen offset:0 sc1
    v_mfma_f32_32x32x16_bf16 v[174:189], v[202:205], v[158:161], v[174:189]
    ds_read_b64_tr_b16 v[194:195], v45 offset:12288
    ds_read_b64_tr_b16 v[196:197], v45 offset:13312
    s_add_u32 m0, s62, 4096
    s_add_u32 s79, s68, 616448
    buffer_load_dwordx4 v3, s[24:27], s79 offen lds
    s_waitcnt vmcnt(17) lgkmcnt(4)
    v_mfma_f32_32x32x16_bf16 v[28:43], v[206:209], v[162:165], v[28:43]
    ds_read_b64_tr_b16 v[198:199], v44 offset:16384
    ds_read_b64_tr_b16 v[200:201], v44 offset:17408
    buffer_load_dwordx4 v[82:85], v2, s[32:35], s98 offen offset:1024 sc1
    v_mfma_f32_32x32x16_bf16 v[174:189], v[210:213], v[162:165], v[174:189]
    ds_read_b64_tr_b16 v[202:203], v45 offset:16384
    ds_read_b64_tr_b16 v[204:205], v45 offset:17408
    s_waitcnt vmcnt(16) lgkmcnt(4)
    v_mfma_f32_32x32x16_bf16 v[28:43], v[190:193], v[166:169], v[28:43]
    ds_read_b64_tr_b16 v[206:207], v44 offset:20480
    ds_read_b64_tr_b16 v[208:209], v44 offset:21504
    s_add_u32 m0, s62, 8192
    s_add_u32 s79, s68, 630784
    buffer_load_dwordx4 v3, s[24:27], s79 offen lds
    v_mfma_f32_32x32x16_bf16 v[174:189], v[194:197], v[166:169], v[174:189]
    ds_read_b64_tr_b16 v[210:211], v45 offset:20480
    ds_read_b64_tr_b16 v[212:213], v45 offset:21504
    buffer_load_dwordx4 v[86:89], v2, s[32:35], s98 offen offset:2048 sc1
    s_waitcnt vmcnt(17) lgkmcnt(4)
    v_mfma_f32_32x32x16_bf16 v[28:43], v[198:201], v[170:173], v[28:43]
    ds_read_b64_tr_b16 v[190:191], v44 offset:24576
    ds_read_b64_tr_b16 v[192:193], v44 offset:25600
    buffer_load_dwordx4 v[90:93], v2, s[32:35], s98 offen offset:3072 sc1
    v_mfma_f32_32x32x16_bf16 v[174:189], v[202:205], v[170:173], v[174:189]
    ds_read_b64_tr_b16 v[194:195], v45 offset:24576
    ds_read_b64_tr_b16 v[196:197], v45 offset:25600
    s_barrier
    s_waitcnt vmcnt(17) lgkmcnt(4)
    v_mfma_f32_32x32x16_bf16 v[28:43], v[206:209], v[46:49], v[28:43]
    ds_read_b64_tr_b16 v[198:199], v44 offset:28672
    ds_read_b64_tr_b16 v[200:201], v44 offset:29696
    s_add_u32 s98, s97, 0x77000
    buffer_load_dwordx4 v[94:97], v2, s[32:35], s98 offen offset:0 sc1
    v_mfma_f32_32x32x16_bf16 v[174:189], v[210:213], v[46:49], v[174:189]
    ds_read_b64_tr_b16 v[202:203], v45 offset:28672
    ds_read_b64_tr_b16 v[204:205], v45 offset:29696
    s_add_u32 m0, s62, 12288
    s_add_u32 s79, s68, 645120
    buffer_load_dwordx4 v3, s[24:27], s79 offen lds
    s_waitcnt vmcnt(17) lgkmcnt(4)
    v_mfma_f32_32x32x16_bf16 v[28:43], v[190:193], v[50:53], v[28:43]
    ds_read_b64_tr_b16 v[206:207], v44 offset:32768
    ds_read_b64_tr_b16 v[208:209], v44 offset:33792
    v_mfma_f32_32x32x16_bf16 v[174:189], v[194:197], v[50:53], v[174:189]
    ds_read_b64_tr_b16 v[210:211], v45 offset:32768
    ds_read_b64_tr_b16 v[212:213], v45 offset:33792
    buffer_load_dwordx4 v[98:101], v2, s[32:35], s98 offen offset:1024 sc1
    s_waitcnt vmcnt(16) lgkmcnt(4)
    v_mfma_f32_32x32x16_bf16 v[28:43], v[198:201], v[54:57], v[28:43]
    ds_read_b64_tr_b16 v[190:191], v44 offset:36864
    ds_read_b64_tr_b16 v[192:193], v44 offset:37888
    s_add_u32 m0, s62, 16384
    s_add_u32 s79, s68, 659456
    buffer_load_dwordx4 v3, s[24:27], s79 offen lds
    v_mfma_f32_32x32x16_bf16 v[174:189], v[202:205], v[54:57], v[174:189]
    ds_read_b64_tr_b16 v[194:195], v45 offset:36864
    ds_read_b64_tr_b16 v[196:197], v45 offset:37888
    s_waitcnt vmcnt(16) lgkmcnt(4)
    v_mfma_f32_32x32x16_bf16 v[28:43], v[206:209], v[58:61], v[28:43]
    ds_read_b64_tr_b16 v[198:199], v44 offset:40960
    ds_read_b64_tr_b16 v[200:201], v44 offset:41984
    buffer_load_dwordx4 v[102:105], v2, s[32:35], s98 offen offset:2048 sc1
    v_mfma_f32_32x32x16_bf16 v[174:189], v[210:213], v[58:61], v[174:189]
    ds_read_b64_tr_b16 v[202:203], v45 offset:40960
    ds_read_b64_tr_b16 v[204:205], v45 offset:41984
    s_barrier
    s_waitcnt vmcnt(16) lgkmcnt(4)
    v_mfma_f32_32x32x16_bf16 v[28:43], v[190:193], v[62:65], v[28:43]
    ds_read_b64_tr_b16 v[206:207], v44 offset:45056
    ds_read_b64_tr_b16 v[208:209], v44 offset:46080
    buffer_load_dwordx4 v[106:109], v2, s[32:35], s98 offen offset:3072 sc1
    v_mfma_f32_32x32x16_bf16 v[174:189], v[194:197], v[62:65], v[174:189]
    ds_read_b64_tr_b16 v[210:211], v45 offset:45056
    ds_read_b64_tr_b16 v[212:213], v45 offset:46080
    s_add_u32 m0, s62, 20480
    s_add_u32 s79, s68, 673792
    buffer_load_dwordx4 v3, s[24:27], s79 offen lds
    s_waitcnt vmcnt(16) lgkmcnt(4)
    v_mfma_f32_32x32x16_bf16 v[28:43], v[198:201], v[66:69], v[28:43]
    ds_read_b64_tr_b16 v[190:191], v44 offset:49152
    ds_read_b64_tr_b16 v[192:193], v44 offset:50176
    v_mfma_f32_32x32x16_bf16 v[174:189], v[202:205], v[66:69], v[174:189]
    ds_read_b64_tr_b16 v[194:195], v45 offset:49152
    ds_read_b64_tr_b16 v[196:197], v45 offset:50176
    s_add_u32 s98, s97, 0x7a000
    buffer_load_dwordx4 v[110:113], v2, s[32:35], s98 offen offset:0 sc1
    s_waitcnt vmcnt(15) lgkmcnt(4)
    v_mfma_f32_32x32x16_bf16 v[28:43], v[206:209], v[70:73], v[28:43]
    ds_read_b64_tr_b16 v[198:199], v44 offset:53248
    ds_read_b64_tr_b16 v[200:201], v44 offset:54272
    s_add_u32 m0, s62, 24576
    s_add_u32 s79, s78, 0
    buffer_load_dwordx4 v2, s[32:35], s79 offen sc1 lds
    v_mfma_f32_32x32x16_bf16 v[174:189], v[210:213], v[70:73], v[174:189]
    ds_read_b64_tr_b16 v[202:203], v45 offset:53248
    ds_read_b64_tr_b16 v[204:205], v45 offset:54272
    s_waitcnt vmcnt(15) lgkmcnt(4)
    v_mfma_f32_32x32x16_bf16 v[28:43], v[190:193], v[74:77], v[28:43]
    ds_read_b64_tr_b16 v[206:207], v44 offset:57344
    ds_read_b64_tr_b16 v[208:209], v44 offset:58368
    buffer_load_dwordx4 v[114:117], v2, s[32:35], s98 offen offset:1024 sc1
    v_mfma_f32_32x32x16_bf16 v[174:189], v[194:197], v[74:77], v[174:189]
    ds_read_b64_tr_b16 v[210:211], v45 offset:57344
    ds_read_b64_tr_b16 v[212:213], v45 offset:58368
    s_barrier
    s_waitcnt vmcnt(15) lgkmcnt(4)
    v_mfma_f32_32x32x16_bf16 v[28:43], v[198:201], v[78:81], v[28:43]
    ds_read_b64_tr_b16 v[190:191], v44 offset:61440
    ds_read_b64_tr_b16 v[192:193], v44 offset:62464
    buffer_load_dwordx4 v[118:121], v2, s[32:35], s98 offen offset:2048 sc1
    v_mfma_f32_32x32x16_bf16 v[174:189], v[202:205], v[78:81], v[174:189]
    ds_read_b64_tr_b16 v[194:195], v45 offset:61440
    ds_read_b64_tr_b16 v[196:197], v45 offset:62464
    s_add_u32 m0, s62, 28672
    s_add_u32 s79, s78, 4096
    buffer_load_dwordx4 v2, s[32:35], s79 offen sc1 lds
    s_waitcnt vmcnt(15) lgkmcnt(4)
    v_mfma_f32_32x32x16_bf16 v[28:43], v[206:209], v[82:85], v[28:43]
    v_add_u32 v44, 65536, v44
    ds_read_b64_tr_b16 v[198:199], v44 offset:0
    ds_read_b64_tr_b16 v[200:201], v44 offset:1024
    buffer_load_dwordx4 v[122:125], v2, s[32:35], s98 offen offset:3072 sc1
    v_mfma_f32_32x32x16_bf16 v[174:189], v[210:213], v[82:85], v[174:189]
    v_add_u32 v45, 65536, v45
    ds_read_b64_tr_b16 v[202:203], v45 offset:0
    ds_read_b64_tr_b16 v[204:205], v45 offset:1024
    s_add_u32 m0, s62, 32768
    s_add_u32 s79, s78, 8192
    buffer_load_dwordx4 v2, s[32:35], s79 offen sc1 lds
    s_waitcnt vmcnt(15) lgkmcnt(4)
    v_mfma_f32_32x32x16_bf16 v[28:43], v[190:193], v[86:89], v[28:43]
    ds_read_b64_tr_b16 v[206:207], v44 offset:4096
    ds_read_b64_tr_b16 v[208:209], v44 offset:5120
    s_add_u32 s98, s97, 0x7b000
    buffer_load_dwordx4 v[126:129], v2, s[32:35], s98 offen offset:0 sc1
    v_mfma_f32_32x32x16_bf16 v[174:189], v[194:197], v[86:89], v[174:189]
    ds_read_b64_tr_b16 v[210:211], v45 offset:4096
    ds_read_b64_tr_b16 v[212:213], v45 offset:5120
    s_add_u32 m0, s62, 36864
    s_add_u32 s79, s78, 12288
    buffer_load_dwordx4 v2, s[32:35], s79 offen sc1 lds
    s_waitcnt vmcnt(16) lgkmcnt(4)
    v_mfma_f32_32x32x16_bf16 v[28:43], v[198:201], v[90:93], v[28:43]
    ds_read_b64_tr_b16 v[190:191], v44 offset:8192
    ds_read_b64_tr_b16 v[192:193], v44 offset:9216
    s_add_u32 m0, s62, 40960
    s_add_u32 s79, s78, 16384
    buffer_load_dwordx4 v2, s[32:35], s79 offen sc1 lds
    v_mfma_f32_32x32x16_bf16 v[174:189], v[202:205], v[90:93], v[174:189]
    ds_read_b64_tr_b16 v[194:195], v45 offset:8192
    ds_read_b64_tr_b16 v[196:197], v45 offset:9216
    s_add_u32 m0, s62, 45056
    s_add_u32 s79, s78, 20480
    buffer_load_dwordx4 v2, s[32:35], s79 offen sc1 lds
    s_barrier
    s_waitcnt vmcnt(17) lgkmcnt(4)
    v_mfma_f32_32x32x16_bf16 v[28:43], v[206:209], v[94:97], v[28:43]
    ds_read_b64_tr_b16 v[198:199], v44 offset:12288
    ds_read_b64_tr_b16 v[200:201], v44 offset:13312
    buffer_load_dwordx4 v[130:133], v2, s[32:35], s98 offen offset:1024 sc1
    v_mfma_f32_32x32x16_bf16 v[174:189], v[210:213], v[94:97], v[174:189]
    ds_read_b64_tr_b16 v[202:203], v45 offset:12288
    ds_read_b64_tr_b16 v[204:205], v45 offset:13312
    s_add_u32 m0, s62, 49152
    s_add_u32 s79, s78, 24576
    buffer_load_dwordx4 v2, s[32:35], s79 offen sc1 lds
    s_waitcnt vmcnt(17) lgkmcnt(4)
    v_mfma_f32_32x32x16_bf16 v[28:43], v[190:193], v[98:101], v[28:43]
    ds_read_b64_tr_b16 v[206:207], v44 offset:16384
    ds_read_b64_tr_b16 v[208:209], v44 offset:17408
    buffer_load_dwordx4 v[134:137], v2, s[32:35], s98 offen offset:2048 sc1
    v_mfma_f32_32x32x16_bf16 v[174:189], v[194:197], v[98:101], v[174:189]
    ds_read_b64_tr_b16 v[210:211], v45 offset:16384
    ds_read_b64_tr_b16 v[212:213], v45 offset:17408
    s_add_u32 m0, s62, 53248
    s_add_u32 s79, s78, 28672
    buffer_load_dwordx4 v2, s[32:35], s79 offen sc1 lds
    s_waitcnt vmcnt(17) lgkmcnt(4)
    v_mfma_f32_32x32x16_bf16 v[28:43], v[198:201], v[102:105], v[28:43]
    ds_read_b64_tr_b16 v[190:191], v44 offset:20480
    ds_read_b64_tr_b16 v[192:193], v44 offset:21504
    buffer_load_dwordx4 v[138:141], v2, s[32:35], s98 offen offset:3072 sc1
    v_mfma_f32_32x32x16_bf16 v[174:189], v[202:205], v[102:105], v[174:189]
    ds_read_b64_tr_b16 v[194:195], v45 offset:20480
    ds_read_b64_tr_b16 v[196:197], v45 offset:21504
    s_add_u32 m0, s62, 57344
    s_add_u32 s79, s78, 32768
    buffer_load_dwordx4 v2, s[32:35], s79 offen sc1 lds
    s_waitcnt vmcnt(18) lgkmcnt(4)
    v_mfma_f32_32x32x16_bf16 v[28:43], v[206:209], v[106:109], v[28:43]
    ds_read_b64_tr_b16 v[198:199], v44 offset:24576
    ds_read_b64_tr_b16 v[200:201], v44 offset:25600
    s_add_u32 m0, s62, 61440
    s_add_u32 s79, s78, 36864
    buffer_load_dwordx4 v2, s[32:35], s79 offen sc1 lds
    v_mfma_f32_32x32x16_bf16 v[174:189], v[210:213], v[106:109], v[174:189]
    ds_read_b64_tr_b16 v[202:203], v45 offset:24576
    ds_read_b64_tr_b16 v[204:205], v45 offset:25600
    s_add_u32 m0, s62, 65536
    s_add_u32 s79, s78, 40960
    buffer_load_dwordx4 v2, s[32:35], s79 offen sc1 lds
    s_waitcnt vmcnt(19)
    s_barrier
    s_waitcnt vmcnt(18) lgkmcnt(4)
    v_mfma_f32_32x32x16_bf16 v[28:43], v[190:193], v[110:113], v[28:43]
    v_add_u32 v44, 4294836224, v44
    ds_read_b64_tr_b16 v[206:207], v44 offset:0
    ds_read_b64_tr_b16 v[208:209], v44 offset:1024
    s_add_u32 m0, s62, 69632
    s_add_u32 s79, s78, 45056
    buffer_load_dwordx4 v2, s[32:35], s79 offen sc1 lds
    v_mfma_f32_32x32x16_bf16 v[174:189], v[194:197], v[110:113], v[174:189]
    v_add_u32 v45, 4294836224, v45
    ds_read_b64_tr_b16 v[210:211], v45 offset:0
    ds_read_b64_tr_b16 v[212:213], v45 offset:1024
    s_waitcnt vmcnt(17) lgkmcnt(4)
    v_mfma_f32_32x32x16_bf16 v[28:43], v[198:201], v[114:117], v[28:43]
    ds_read_b64_tr_b16 v[190:191], v44 offset:4096
    ds_read_b64_tr_b16 v[192:193], v44 offset:5120
    s_add_u32 m0, s62, 73728
    s_add_u32 s79, s78, 49152
    buffer_load_dwordx4 v2, s[32:35], s79 offen sc1 lds
    v_mfma_f32_32x32x16_bf16 v[174:189], v[202:205], v[114:117], v[174:189]
    ds_read_b64_tr_b16 v[194:195], v45 offset:4096
    ds_read_b64_tr_b16 v[196:197], v45 offset:5120
    s_waitcnt vmcnt(17) lgkmcnt(4)
    v_mfma_f32_32x32x16_bf16 v[28:43], v[206:209], v[118:121], v[28:43]
    ds_read_b64_tr_b16 v[198:199], v44 offset:8192
    ds_read_b64_tr_b16 v[200:201], v44 offset:9216
    v_mfma_f32_32x32x16_bf16 v[174:189], v[210:213], v[118:121], v[174:189]
    ds_read_b64_tr_b16 v[202:203], v45 offset:8192
    ds_read_b64_tr_b16 v[204:205], v45 offset:9216
    s_add_u32 m0, s62, 77824
    s_add_u32 s79, s78, 53248
    buffer_load_dwordx4 v2, s[32:35], s79 offen sc1 lds
    s_waitcnt vmcnt(16) lgkmcnt(4)
    v_mfma_f32_32x32x16_bf16 v[28:43], v[190:193], v[122:125], v[28:43]
    ds_read_b64_tr_b16 v[206:207], v44 offset:12288
    ds_read_b64_tr_b16 v[208:209], v44 offset:13312
    v_mfma_f32_32x32x16_bf16 v[174:189], v[194:197], v[122:125], v[174:189]
    ds_read_b64_tr_b16 v[210:211], v45 offset:12288
    ds_read_b64_tr_b16 v[212:213], v45 offset:13312
    s_barrier
    s_waitcnt vmcnt(14) lgkmcnt(4)
    v_mfma_f32_32x32x16_bf16 v[28:43], v[198:201], v[126:129], v[28:43]
    ds_read_b64_tr_b16 v[190:191], v44 offset:16384
    ds_read_b64_tr_b16 v[192:193], v44 offset:17408
    v_mfma_f32_32x32x16_bf16 v[174:189], v[202:205], v[126:129], v[174:189]
    ds_read_b64_tr_b16 v[194:195], v45 offset:16384
    ds_read_b64_tr_b16 v[196:197], v45 offset:17408
    s_waitcnt vmcnt(10) lgkmcnt(4)
    v_mfma_f32_32x32x16_bf16 v[28:43], v[206:209], v[130:133], v[28:43]
    ds_read_b64_tr_b16 v[198:199], v44 offset:20480
    ds_read_b64_tr_b16 v[200:201], v44 offset:21504
    v_mfma_f32_32x32x16_bf16 v[174:189], v[210:213], v[130:133], v[174:189]
    ds_read_b64_tr_b16 v[202:203], v45 offset:20480
    ds_read_b64_tr_b16 v[204:205], v45 offset:21504
    s_waitcnt vmcnt(8) lgkmcnt(4)
    v_mfma_f32_32x32x16_bf16 v[28:43], v[190:193], v[134:137], v[28:43]
    v_mfma_f32_32x32x16_bf16 v[174:189], v[194:197], v[134:137], v[174:189]
    s_waitcnt vmcnt(6) lgkmcnt(0)
    v_mfma_f32_32x32x16_bf16 v[28:43], v[198:201], v[138:141], v[28:43]
    v_mfma_f32_32x32x16_bf16 v[174:189], v[202:205], v[138:141], v[174:189]
    s_nop 11
    ds_write_b128 v214, v[174:177] offset:0
    ds_write_b128 v214, v[178:181] offset:1024
    ds_write_b128 v214, v[182:185] offset:2048
    ds_write_b128 v214, v[186:189] offset:3072
    v_pk_add_f32 v[8:9], v[8:9], v[28:29]
    v_pk_add_f32 v[10:11], v[10:11], v[30:31]
    v_pk_add_f32 v[12:13], v[12:13], v[32:33]
    v_pk_add_f32 v[14:15], v[14:15], v[34:35]
    v_pk_add_f32 v[16:17], v[16:17], v[36:37]
    v_pk_add_f32 v[18:19], v[18:19], v[38:39]
    v_pk_add_f32 v[20:21], v[20:21], v[40:41]
    v_pk_add_f32 v[22:23], v[22:23], v[42:43]
    s_waitcnt lgkmcnt(0)
    s_barrier
    ds_read_b128 v[174:177], v215 offset:0
    ds_read_b128 v[178:181], v215 offset:1024
    ds_read_b128 v[182:185], v215 offset:2048
    ds_read_b128 v[186:189], v215 offset:3072
    s_waitcnt lgkmcnt(3)
    v_pk_add_f32 v[8:9], v[8:9], v[174:175]
    v_pk_add_f32 v[10:11], v[10:11], v[176:177]
    v_cvt_pk_bf16_f32 v28, v8, v9
    v_cvt_pk_bf16_f32 v29, v10, v11
    v_pk_add_f32 v[36:37], v[8:9], v[10:11]
    v_pk_mul_f32 v[38:39], v[8:9], v[8:9]
    v_pk_fma_f32 v[38:39], v[10:11], v[10:11], v[38:39]
    s_waitcnt lgkmcnt(2)
    v_pk_add_f32 v[12:13], v[12:13], v[178:179]
    v_pk_add_f32 v[14:15], v[14:15], v[180:181]
    v_cvt_pk_bf16_f32 v30, v12, v13
    v_cvt_pk_bf16_f32 v31, v14, v15
    s_cmp_lg_u32 s61, 0
    s_cbranch_scc1 L_var11_wt
    buffer_store_dwordx4 v[28:31], v2, s[32:35], s88 offen offset:0
L_var11_end:
    v_pk_add_f32 v[36:37], v[36:37], v[12:13]
    v_pk_fma_f32 v[38:39], v[12:13], v[12:13], v[38:39]
    v_pk_add_f32 v[36:37], v[36:37], v[14:15]
    v_pk_fma_f32 v[38:39], v[14:15], v[14:15], v[38:39]
    s_waitcnt lgkmcnt(1)
    v_pk_add_f32 v[16:17], v[16:17], v[182:183]
    v_pk_add_f32 v[18:19], v[18:19], v[184:185]
    v_cvt_pk_bf16_f32 v32, v16, v17
    v_cvt_pk_bf16_f32 v33, v18, v19
    v_pk_add_f32 v[36:37], v[36:37], v[16:17]
    v_pk_fma_f32 v[38:39], v[16:17], v[16:17], v[38:39]
    v_pk_add_f32 v[36:37], v[36:37], v[18:19]
    v_pk_fma_f32 v[38:39], v[18:19], v[18:19], v[38:39]
    s_waitcnt lgkmcnt(0)
    v_pk_add_f32 v[20:21], v[20:21], v[186:187]
    v_pk_add_f32 v[22:23], v[22:23], v[188:189]
    v_cvt_pk_bf16_f32 v34, v20, v21
    v_cvt_pk_bf16_f32 v35, v22, v23
    s_cmp_lg_u32 s61, 0
    s_cbranch_scc1 L_var12_wt
    buffer_store_dwordx4 v[32:35], v2, s[32:35], s88 offen offset:1024
L_var12_end:
    v_pk_add_f32 v[36:37], v[36:37], v[20:21]
    v_pk_fma_f32 v[38:39], v[20:21], v[20:21], v[38:39]
    v_pk_add_f32 v[36:37], v[36:37], v[22:23]
    v_pk_fma_f32 v[38:39], v[22:23], v[22:23], v[38:39]
    v_add_f32 v36, v36, v37
    v_add_f32 v37, v38, v39
    v_mov_b32 v38, v36
    v_mov_b32 v39, v37
    v_mov_b32 v7, 2
    v_permlane32_swap_b32 v38, v36
    v_permlane32_swap_b32 v39, v37
    v_pk_add_f32 v[36:37], v[36:37], v[38:39]
    s_cmp_lg_u32 s61, 0
    s_cbranch_scc1 L_var13_wt
    buffer_store_dwordx2 v[36:37], v216, s[32:35], s90 offen
L_var13_end:
    s_waitcnt vmcnt(0)
    v_mov_b32 v7, 2
    s_mov_b64 exec, 1
    s_cmp_lg_u32 s61, 0
    s_cbranch_scc1 L_var14_wt
    buffer_store_dword v7, off, s[32:35], s92
L_var14_end:
    s_mov_b64 exec, -1
    s_branch L_k1b
L_idle0:
    s_waitcnt vmcnt(0)
    v_mov_b32 v7, 1
    s_mov_b64 exec, 1
    s_cmp_lg_u32 s61, 0
    s_cbranch_scc1 L_var15_wt
    buffer_store_dword v7, off, s[32:35], s90
L_var15_end:
    s_mov_b64 exec, -1
    s_sub_u32 s69, s58, 14
    s_lshl_b32 s69, s69, 2
    s_add_u32 s69, s69, s56
    s_lshl_b32 s69, s69, 13
    s_add_u32 s69, s69, s63
    v_lshlrev_b32 v28, 7, v1
    s_cmp_lg_u32 s61, 0
    s_cbranch_scc1 L_nopre2
    s_add_u32 s71, s69, 0x50000
    buffer_load_dword a0, v28, s[32:35], s71 offen
    s_add_u32 s71, s69, 0x60000
    buffer_load_dword a0, v28, s[32:35], s71 offen
L_nopre2:
    s_waitcnt vmcnt(0)
    s_barrier
    s_add_u32 m0, s62, 24576
    s_add_u32 s79, s78, 0
    buffer_load_dwordx4 v2, s[32:35], s79 offen sc1 lds
    s_add_u32 m0, s62, 28672
    s_add_u32 s79, s78, 4096
    buffer_load_dwordx4 v2, s[32:35], s79 offen sc1 lds
    s_add_u32 m0, s62, 32768
    s_add_u32 s79, s78, 8192
    buffer_load_dwordx4 v2, s[32:35], s79 offen sc1 lds
    s_add_u32 m0, s62, 36864
    s_add_u32 s79, s78, 12288
    buffer_load_dwordx4 v2, s[32:35], s79 offen sc1 lds
    s_add_u32 m0, s62, 40960
    s_add_u32 s79, s78, 16384
    buffer_load_dwordx4 v2, s[32:35], s79 offen sc1 lds
    s_add_u32 m0, s62, 45056
    s_add_u32 s79, s78, 20480
    buffer_load_dwordx4 v2, s[32:35], s79 offen sc1 lds
    s_add_u32 m0, s62, 49152
    s_add_u32 s79, s78, 24576
    buffer_load_dwordx4 v2, s[32:35], s79 offen sc1 lds
    s_add_u32 m0, s62, 53248
    s_add_u32 s79, s78, 28672
    buffer_load_dwordx4 v2, s[32:35], s79 offen sc1 lds
    s_add_u32 m0, s62, 57344
    s_add_u32 s79, s78, 32768
    buffer_load_dwordx4 v2, s[32:35], s79 offen sc1 lds
    s_add_u32 m0, s62, 61440
    s_add_u32 s79, s78, 36864
    buffer_load_dwordx4 v2, s[32:35], s79 offen sc1 lds
    s_add_u32 m0, s62, 65536
    s_add_u32 s79, s78, 40960
    buffer_load_dwordx4 v2, s[32:35], s79 offen sc1 lds
    s_add_u32 m0, s62, 69632
    s_add_u32 s79, s78, 45056
    buffer_load_dwordx4 v2, s[32:35], s79 offen sc1 lds
    s_add_u32 m0, s62, 73728
    s_add_u32 s79, s78, 49152
    buffer_load_dwordx4 v2, s[32:35], s79 offen sc1 lds
    s_add_u32 m0, s62, 77824
    s_add_u32 s79, s78, 53248
    buffer_load_dwordx4 v2, s[32:35], s79 offen sc1 lds
L_k1b:
    v_lshrrev_b32 v224, 4, v1
    v_bfe_u32 v225, v1, 2, 2
    v_and_b32 v226, 3, v1
    v_lshrrev_b32 v227, 1, v224
    v_lshl_add_u32 v214, v227, 2, v225
    v_lshlrev_b32 v214, 6, v214
    v_lshl_add_u32 v214, v226, 3, v214
    v_lshlrev_b32 v215, 10, v227
    v_and_b32 v227, 1, v224
    v_lshl_add_u32 v214, v227, 5, v214
    v_lshl_add_u32 v215, v227, 7, v215
    v_and_b32 v227, 15, v1
    v_lshl_add_u32 v215, v227, 2, v215
    v_lshl_add_u32 v224, v224, 3, v225
    v_bfe_u32 v225, v224, 1, 3
    v_xor_b32 v225, v225, v226
    v_lshlrev_b32 v224, 6, v224
    v_lshl_add_u32 v224, v225, 3, v224
    s_and_b32 s89, s56, 1
    s_lshl_b32 s89, s89, 5
    v_xor_b32 v244, s89, v224
    s_lshl_b32 s89, s76, 13
    s_add_u32 s89, s89, 57344
    v_add_u32 v244, s89, v244
    v_xor_b32 v245, 16, v244
    v_add_u32 v246, 73728, v224
    v_xor_b32 v247, 16, v246
    v_and_b32 v224, 31, v1
    v_lshrrev_b32 v225, 5, v1
    v_bfe_u32 v226, v224, 1, 3
    s_lshl_b32 s89, s56, 11
    s_add_u32 s89, s89, 57344
    v_lshlrev_b32 v224, 6, v224
    v_add_u32 v224, s89, v224
    v_xor_b32 v227, v225, v226
    v_lshl_add_u32 v232, v227, 3, v224
    v_xor_b32 v233, 16, v232
    v_xor_b32 v234, 32, v232
    v_xor_b32 v235, 48, v232
    s_and_b32 s89, s58, 1
    s_cmp_lg_u32 s89, 0
    s_mov_b32 s50, 0xeda95410
    s_cselect_b32 s89, 0xcb8632f7, s50
    s_cselect_b32 s50, s50, 0xf7cb8632
    v_mov_b32 v227, s89
    v_mov_b32 v236, s50
    v_cmp_ne_u32 vcc, 0, v225
    s_nop 1
    v_cndmask_b32 v225, v227, v236, vcc
    v_lshlrev_b32 v226, 1, v226
    v_bfe_u32 v236, v225, 0, 4
    v_xor_b32 v236, v236, v226
    v_lshl_add_u32 v236, v236, 2, v224
    v_bfe_u32 v237, v225, 4, 4
    v_xor_b32 v237, v237, v226
    v_lshl_add_u32 v237, v237, 2, v224
    v_bfe_u32 v238, v225, 8, 4
    v_xor_b32 v238, v238, v226
    v_lshl_add_u32 v238, v238, 2, v224
    v_bfe_u32 v239, v225, 12, 4
    v_xor_b32 v239, v239, v226
    v_lshl_add_u32 v239, v239, 2, v224
    v_bfe_u32 v240, v225, 16, 4
    v_xor_b32 v240, v240, v226
    v_lshl_add_u32 v240, v240, 2, v224
    v_bfe_u32 v241, v225, 20, 4
    v_xor_b32 v241, v241, v226
    v_lshl_add_u32 v241, v241, 2, v224
    v_bfe_u32 v242, v225, 24, 4
    v_xor_b32 v242, v242, v226
    v_lshl_add_u32 v242, v242, 2, v224
    v_bfe_u32 v243, v225, 28, 4
    v_xor_b32 v243, v243, v226
    v_lshl_add_u32 v243, v243, 2, v224
    s_lshl_b32 s89, s58, 13
    s_add_u32 s89, s89, 0x2030000
    v_lshrrev_b32 v172, 4, v1
    v_bfe_u32 v173, v1, 2, 2
    v_and_b32 v174, 3, v1
    v_and_b32 v175, 1, v172
    v_lshlrev_b32 v175, 1, v175
    v_lshrrev_b32 v213, 1, v174
    v_add_u32 v175, v175, v213
    v_and_b32 v213, 2, v173
    v_lshlrev_b32 v213, 1, v213
    v_xor_b32 v175, v175, v213
    v_lshlrev_b32 v175, 4, v175
    v_and_b32 v174, 1, v174
    v_lshl_add_u32 v175, v174, 3, v175
    v_lshrrev_b32 v172, 1, v172
    v_lshl_add_u32 v173, v172, 2, v173
    v_lshl_add_u32 v212, v173, 7, v175
    v_xor_b32 v213, 64, v212
    s_waitcnt vmcnt(0)
    s_barrier
    s_lshl_b32 s69, s56, 7
    s_add_u32 s69, s69, s63
    s_add_u32 s69, s69, 512
    v_min_u32 v248, 13, v1
    v_lshlrev_b32 v248, 2, v248
    s_mov_b32 s73, 0
L_poll_263:
    buffer_load_dword v249, v248, s[32:35], s69 offen sc1
    s_waitcnt vmcnt(0)
    v_cmp_le_u32 s[44:45], 2, v249
    s_add_u32 s73, s73, 1
    s_cmp_eq_u64 s[44:45], -1
    s_cbranch_scc1 L_poll_263_ok
    s_cmp_lt_u32 s73, 262144
    s_cbranch_scc1 L_poll_263
L_poll_263_ok:
    s_mul_i32 s70, s56, 28672
    s_add_u32 s70, s70, s63
    s_add_u32 s71, s70, 0x50000
    buffer_load_dwordx4 v[28:31], v2, s[32:35], s71 offen offset:0 sc1
    buffer_load_dwordx4 v[32:35], v2, s[32:35], s71 offen offset:1024 sc1
    buffer_load_dwordx4 v[36:39], v2, s[32:35], s71 offen offset:2048 sc1
    buffer_load_dwordx4 v[40:43], v2, s[32:35], s71 offen offset:3072 sc1
    s_add_u32 s71, s70, 0x51000
    buffer_load_dwordx4 v[44:47], v2, s[32:35], s71 offen offset:0 sc1
    buffer_load_dwordx4 v[48:51], v2, s[32:35], s71 offen offset:1024 sc1
    buffer_load_dwordx4 v[52:55], v2, s[32:35], s71 offen offset:2048 sc1
    buffer_load_dwordx4 v[56:59], v2, s[32:35], s71 offen offset:3072 sc1
    s_add_u32 s71, s70, 0x52000
    buffer_load_dwordx4 v[60:63], v2, s[32:35], s71 offen offset:0 sc1
    buffer_load_dwordx4 v[64:67], v2, s[32:35], s71 offen offset:1024 sc1
    ds_read_b64_tr_b16 v[172:173], v212 offset:24576
    ds_read_b64_tr_b16 v[174:175], v212 offset:25600
    ds_read_b64_tr_b16 v[176:177], v213 offset:24576
    ds_read_b64_tr_b16 v[178:179], v213 offset:25600
    ds_read_b64_tr_b16 v[180:181], v212 offset:26624
    ds_read_b64_tr_b16 v[182:183], v212 offset:27648
    s_waitcnt vmcnt(9) lgkmcnt(2)
    v_mfma_f32_32x32x16_bf16 v[140:155], v[172:175], v[28:31], 0
    ds_read_b64_tr_b16 v[184:185], v213 offset:26624
    ds_read_b64_tr_b16 v[186:187], v213 offset:27648
    buffer_load_dwordx4 v[68:71], v2, s[32:35], s71 offen offset:2048 sc1
    v_mfma_f32_32x32x16_bf16 v[156:171], v[176:179], v[28:31], 0
    ds_read_b64_tr_b16 v[188:189], v212 offset:28672
    ds_read_b64_tr_b16 v[190:191], v212 offset:29696
    s_waitcnt vmcnt(9) lgkmcnt(2)
    v_mfma_f32_32x32x16_bf16 v[140:155], v[180:183], v[32:35], v[140:155]
    ds_read_b64_tr_b16 v[172:173], v213 offset:28672
    ds_read_b64_tr_b16 v[174:175], v213 offset:29696
    buffer_load_dwordx4 v[72:75], v2, s[32:35], s71 offen offset:3072 sc1
    v_mfma_f32_32x32x16_bf16 v[156:171], v[184:187], v[32:35], v[156:171]
    ds_read_b64_tr_b16 v[176:177], v212 offset:30720
    ds_read_b64_tr_b16 v[178:179], v212 offset:31744
    s_waitcnt vmcnt(9) lgkmcnt(2)
    v_mfma_f32_32x32x16_bf16 v[140:155], v[188:191], v[36:39], v[140:155]
    ds_read_b64_tr_b16 v[180:181], v213 offset:30720
    ds_read_b64_tr_b16 v[182:183], v213 offset:31744
    s_add_u32 s71, s70, 0x53000
    buffer_load_dwordx4 v[76:79], v2, s[32:35], s71 offen offset:0 sc1
    v_mfma_f32_32x32x16_bf16 v[156:171], v[172:175], v[36:39], v[156:171]
    ds_read_b64_tr_b16 v[184:185], v212 offset:32768
    ds_read_b64_tr_b16 v[186:187], v212 offset:33792
    s_waitcnt vmcnt(9) lgkmcnt(2)
    v_mfma_f32_32x32x16_bf16 v[140:155], v[176:179], v[40:43], v[140:155]
    ds_read_b64_tr_b16 v[188:189], v213 offset:32768
    ds_read_b64_tr_b16 v[190:191], v213 offset:33792
    buffer_load_dwordx4 v[80:83], v2, s[32:35], s71 offen offset:1024 sc1
    v_mfma_f32_32x32x16_bf16 v[156:171], v[180:183], v[40:43], v[156:171]
    ds_read_b64_tr_b16 v[172:173], v212 offset:34816
    ds_read_b64_tr_b16 v[174:175], v212 offset:35840
    s_waitcnt vmcnt(9) lgkmcnt(2)
    v_mfma_f32_32x32x16_bf16 v[140:155], v[184:187], v[44:47], v[140:155]
    ds_read_b64_tr_b16 v[176:177], v213 offset:34816
    ds_read_b64_tr_b16 v[178:179], v213 offset:35840
    buffer_load_dwordx4 v[84:87], v2, s[32:35], s71 offen offset:2048 sc1
    s_lshl_b32 s69, s56, 12
    s_add_u32 s69, s69, s63
    s_add_u32 s69, s69, 0x5000
    buffer_load_dwordx4 v[192:195], v2, s[32:35], s69 offen offset:0 sc1
    buffer_load_dwordx4 v[196:199], v2, s[32:35], s69 offen offset:1024 sc1
    buffer_load_dwordx4 v[200:203], v2, s[32:35], s69 offen offset:2048 sc1
    buffer_load_dwordx4 v[204:207], v2, s[32:35], s69 offen offset:3072 sc1
    v_mfma_f32_32x32x16_bf16 v[156:171], v[188:191], v[44:47], v[156:171]
    ds_read_b64_tr_b16 v[180:181], v212 offset:36864
    ds_read_b64_tr_b16 v[182:183], v212 offset:37888
    s_waitcnt vmcnt(13) lgkmcnt(2)
    v_mfma_f32_32x32x16_bf16 v[140:155], v[172:175], v[48:51], v[140:155]
    ds_read_b64_tr_b16 v[184:185], v213 offset:36864
    ds_read_b64_tr_b16 v[186:187], v213 offset:37888
    buffer_load_dwordx4 v[88:91], v2, s[32:35], s71 offen offset:3072 sc1
    v_mfma_f32_32x32x16_bf16 v[156:171], v[176:179], v[48:51], v[156:171]
    ds_read_b64_tr_b16 v[188:189], v212 offset:38912
    ds_read_b64_tr_b16 v[190:191], v212 offset:39936
    s_waitcnt vmcnt(13) lgkmcnt(2)
    v_mfma_f32_32x32x16_bf16 v[140:155], v[180:183], v[52:55], v[140:155]
    ds_read_b64_tr_b16 v[172:173], v213 offset:38912
    ds_read_b64_tr_b16 v[174:175], v213 offset:39936
    s_add_u32 s71, s70, 0x54000
    buffer_load_dwordx4 v[92:95], v2, s[32:35], s71 offen offset:0 sc1
    v_mfma_f32_32x32x16_bf16 v[156:171], v[184:187], v[52:55], v[156:171]
    ds_read_b64_tr_b16 v[176:177], v212 offset:40960
    ds_read_b64_tr_b16 v[178:179], v212 offset:41984
    s_waitcnt vmcnt(13) lgkmcnt(2)
    v_mfma_f32_32x32x16_bf16 v[140:155], v[188:191], v[56:59], v[140:155]
    ds_read_b64_tr_b16 v[180:181], v213 offset:40960
    ds_read_b64_tr_b16 v[182:183], v213 offset:41984
    buffer_load_dwordx4 v[96:99], v2, s[32:35], s71 offen offset:1024 sc1
    v_mfma_f32_32x32x16_bf16 v[156:171], v[172:175], v[56:59], v[156:171]
    ds_read_b64_tr_b16 v[184:185], v212 offset:43008
    ds_read_b64_tr_b16 v[186:187], v212 offset:44032
    s_waitcnt vmcnt(13) lgkmcnt(2)
    v_mfma_f32_32x32x16_bf16 v[140:155], v[176:179], v[60:63], v[140:155]
    ds_read_b64_tr_b16 v[188:189], v213 offset:43008
    ds_read_b64_tr_b16 v[190:191], v213 offset:44032
    buffer_load_dwordx4 v[100:103], v2, s[32:35], s71 offen offset:2048 sc1
    v_mfma_f32_32x32x16_bf16 v[156:171], v[180:183], v[60:63], v[156:171]
    ds_read_b64_tr_b16 v[172:173], v212 offset:45056
    ds_read_b64_tr_b16 v[174:175], v212 offset:46080
    s_waitcnt vmcnt(13) lgkmcnt(2)
    v_mfma_f32_32x32x16_bf16 v[140:155], v[184:187], v[64:67], v[140:155]
    ds_read_b64_tr_b16 v[176:177], v213 offset:45056
    ds_read_b64_tr_b16 v[178:179], v213 offset:46080
    buffer_load_dwordx4 v[104:107], v2, s[32:35], s71 offen offset:3072 sc1
    v_mfma_f32_32x32x16_bf16 v[156:171], v[188:191], v[64:67], v[156:171]
    ds_read_b64_tr_b16 v[180:181], v212 offset:47104
    ds_read_b64_tr_b16 v[182:183], v212 offset:48128
    s_waitcnt vmcnt(13) lgkmcnt(2)
    v_mfma_f32_32x32x16_bf16 v[140:155], v[172:175], v[68:71], v[140:155]
    ds_read_b64_tr_b16 v[184:185], v213 offset:47104
    ds_read_b64_tr_b16 v[186:187], v213 offset:48128
    s_add_u32 s71, s70, 0x55000
    buffer_load_dwordx4 v[108:111], v2, s[32:35], s71 offen offset:0 sc1
    v_mfma_f32_32x32x16_bf16 v[156:171], v[176:179], v[68:71], v[156:171]
    ds_read_b64_tr_b16 v[188:189], v212 offset:49152
    ds_read_b64_tr_b16 v[190:191], v212 offset:50176
    s_waitcnt vmcnt(13) lgkmcnt(2)
    v_mfma_f32_32x32x16_bf16 v[140:155], v[180:183], v[72:75], v[140:155]
    ds_read_b64_tr_b16 v[172:173], v213 offset:49152
    ds_read_b64_tr_b16 v[174:175], v213 offset:50176
    buffer_load_dwordx4 v[112:115], v2, s[32:35], s71 offen offset:1024 sc1
    v_mfma_f32_32x32x16_bf16 v[156:171], v[184:187], v[72:75], v[156:171]
    ds_read_b64_tr_b16 v[176:177], v212 offset:51200
    ds_read_b64_tr_b16 v[178:179], v212 offset:52224
    s_waitcnt vmcnt(13) lgkmcnt(2)
    v_mfma_f32_32x32x16_bf16 v[140:155], v[188:191], v[76:79], v[140:155]
    ds_read_b64_tr_b16 v[180:181], v213 offset:51200
    ds_read_b64_tr_b16 v[182:183], v213 offset:52224
    buffer_load_dwordx4 v[116:119], v2, s[32:35], s71 offen offset:2048 sc1
    s_waitcnt vmcnt(8)
    v_add_f32 v192, v192, v194
    v_mfma_f32_32x32x16_bf16 v[156:171], v[172:175], v[76:79], v[156:171]
    ds_read_b64_tr_b16 v[184:185], v212 offset:53248
    ds_read_b64_tr_b16 v[186:187], v212 offset:54272
    v_add_f32 v193, v193, v195
    v_add_f32 v192, v192, v196
    s_waitcnt lgkmcnt(2)
    v_mfma_f32_32x32x16_bf16 v[140:155], v[176:179], v[80:83], v[140:155]
    ds_read_b64_tr_b16 v[188:189], v213 offset:53248
    ds_read_b64_tr_b16 v[190:191], v213 offset:54272
    buffer_load_dwordx4 v[120:123], v2, s[32:35], s71 offen offset:3072 sc1
    v_add_f32 v193, v193, v197
    v_add_f32 v192, v192, v198
    v_mfma_f32_32x32x16_bf16 v[156:171], v[180:183], v[80:83], v[156:171]
    ds_read_b64_tr_b16 v[172:173], v212 offset:55296
    ds_read_b64_tr_b16 v[174:175], v212 offset:56320
    v_add_f32 v193, v193, v199
    v_add_f32 v192, v192, v200
    s_waitcnt lgkmcnt(2)
    v_mfma_f32_32x32x16_bf16 v[140:155], v[184:187], v[84:87], v[140:155]
    ds_read_b64_tr_b16 v[176:177], v213 offset:55296
    ds_read_b64_tr_b16 v[178:179], v213 offset:56320
    s_add_u32 s71, s70, 0x56000
    buffer_load_dwordx4 v[124:127], v2, s[32:35], s71 offen offset:0 sc1
    v_add_f32 v193, v193, v201
    v_mfma_f32_32x32x16_bf16 v[156:171], v[188:191], v[84:87], v[156:171]
    ds_read_b64_tr_b16 v[180:181], v212 offset:57344
    ds_read_b64_tr_b16 v[182:183], v212 offset:58368
    v_add_f32 v192, v192, v202
    v_add_f32 v193, v193, v203
    s_waitcnt vmcnt(9) lgkmcnt(2)
    v_mfma_f32_32x32x16_bf16 v[140:155], v[172:175], v[88:91], v[140:155]
    ds_read_b64_tr_b16 v[184:185], v213 offset:57344
    ds_read_b64_tr_b16 v[186:187], v213 offset:58368
    buffer_load_dwordx4 v[128:131], v2, s[32:35], s71 offen offset:1024 sc1
    v_add_f32 v192, v192, v204
    v_add_f32 v193, v193, v205
    v_mfma_f32_32x32x16_bf16 v[156:171], v[176:179], v[88:91], v[156:171]
    ds_read_b64_tr_b16 v[188:189], v212 offset:59392
    ds_read_b64_tr_b16 v[190:191], v212 offset:60416
    v_mov_b32 v194, v192
    v_mov_b32 v195, v193
    s_waitcnt vmcnt(9) lgkmcnt(2)
    v_mfma_f32_32x32x16_bf16 v[140:155], v[180:183], v[92:95], v[140:155]
    ds_read_b64_tr_b16 v[172:173], v213 offset:59392
    ds_read_b64_tr_b16 v[174:175], v213 offset:60416
    buffer_load_dwordx4 v[132:135], v2, s[32:35], s71 offen offset:2048 sc1
    v_permlane32_swap_b32 v194, v192
    v_permlane32_swap_b32 v195, v193
    v_mfma_f32_32x32x16_bf16 v[156:171], v[184:187], v[92:95], v[156:171]
    ds_read_b64_tr_b16 v[176:177], v212 offset:61440
    ds_read_b64_tr_b16 v[178:179], v212 offset:62464
    v_add_f32 v192, v194, v192
    v_add_f32 v193, v195, v193
    s_waitcnt vmcnt(9) lgkmcnt(2)
    v_mfma_f32_32x32x16_bf16 v[140:155], v[188:191], v[96:99], v[140:155]
    ds_read_b64_tr_b16 v[180:181], v213 offset:61440
    ds_read_b64_tr_b16 v[182:183], v213 offset:62464
    buffer_load_dwordx4 v[136:139], v2, s[32:35], s71 offen offset:3072 sc1
    v_mul_f32 v192, 0x3b124925, v192
    v_mul_f32 v193, 0x3b124925, v193
    v_mfma_f32_32x32x16_bf16 v[156:171], v[172:175], v[96:99], v[156:171]
    ds_read_b64_tr_b16 v[184:185], v212 offset:63488
    ds_read_b64_tr_b16 v[186:187], v212 offset:64512
    v_cvt_pk_bf16_f32 v24, -v192, -v192
    v_fma_f32 v193, -v192, v192, v193
    s_waitcnt vmcnt(9) lgkmcnt(2)
    v_mfma_f32_32x32x16_bf16 v[140:155], v[176:179], v[100:103], v[140:155]
    ds_read_b64_tr_b16 v[188:189], v213 offset:63488
    ds_read_b64_tr_b16 v[190:191], v213 offset:64512
    s_add_u32 m0, s62, 81920
    s_add_u32 s79, s78, 57344
    buffer_load_dwordx4 v2, s[32:35], s79 offen sc1 lds
    v_mfma_f32_32x32x16_bf16 v[156:171], v[180:183], v[100:103], v[156:171]
    v_add_u32 v212, 65536, v212
    ds_read_b64_tr_b16 v[172:173], v212 offset:0
    ds_read_b64_tr_b16 v[174:175], v212 offset:1024
    v_max_f32 v193, 0, v193
    s_waitcnt vmcnt(9) lgkmcnt(2)
    v_mfma_f32_32x32x16_bf16 v[140:155], v[184:187], v[104:107], v[140:155]
    v_add_u32 v213, 65536, v213
    ds_read_b64_tr_b16 v[176:177], v213 offset:0
    ds_read_b64_tr_b16 v[178:179], v213 offset:1024
    s_add_u32 m0, s62, 86016
    s_add_u32 s79, s78, 61440
    buffer_load_dwordx4 v2, s[32:35], s79 offen sc1 lds
    v_mfma_f32_32x32x16_bf16 v[156:171], v[188:191], v[104:107], v[156:171]
    ds_read_b64_tr_b16 v[180:181], v212 offset:2048
    ds_read_b64_tr_b16 v[182:183], v212 offset:3072
    v_cvt_pk_bf16_f32 v193, v193, v193
    v_lshlrev_b32 v193, 16, v193
    s_waitcnt vmcnt(9) lgkmcnt(2)
    v_mfma_f32_32x32x16_bf16 v[140:155], v[172:175], v[108:111], v[140:155]
    ds_read_b64_tr_b16 v[184:185], v213 offset:2048
    ds_read_b64_tr_b16 v[186:187], v213 offset:3072
    s_add_u32 m0, s62, 90112
    s_add_u32 s79, s78, 65536
    buffer_load_dwordx4 v2, s[32:35], s79 offen sc1 lds
    v_mfma_f32_32x32x16_bf16 v[156:171], v[176:179], v[108:111], v[156:171]
    ds_read_b64_tr_b16 v[188:189], v212 offset:4096
    ds_read_b64_tr_b16 v[190:191], v212 offset:5120
    v_add_f32 v193, 0x3727c5ac, v193
    v_cvt_pk_bf16_f32 v193, v193, v193
    s_waitcnt vmcnt(9) lgkmcnt(2)
    v_mfma_f32_32x32x16_bf16 v[140:155], v[180:183], v[112:115], v[140:155]
    ds_read_b64_tr_b16 v[172:173], v213 offset:4096
    ds_read_b64_tr_b16 v[174:175], v213 offset:5120
    s_add_u32 m0, s62, 94208
    s_add_u32 s79, s78, 69632
    buffer_load_dwordx4 v2, s[32:35], s79 offen sc1 lds
    v_mfma_f32_32x32x16_bf16 v[156:171], v[184:187], v[112:115], v[156:171]
    ds_read_b64_tr_b16 v[176:177], v212 offset:6144
    ds_read_b64_tr_b16 v[178:179], v212 offset:7168
    v_lshlrev_b32 v193, 16, v193
    s_waitcnt vmcnt(9) lgkmcnt(2)
    v_mfma_f32_32x32x16_bf16 v[140:155], v[188:191], v[116:119], v[140:155]
    ds_read_b64_tr_b16 v[180:181], v213 offset:6144
    ds_read_b64_tr_b16 v[182:183], v213 offset:7168
    s_add_u32 m0, s62, 98304
    s_add_u32 s79, s78, 73728
    buffer_load_dwordx4 v2, s[32:35], s79 offen sc1 lds
    v_mfma_f32_32x32x16_bf16 v[156:171], v[172:175], v[116:119], v[156:171]
    ds_read_b64_tr_b16 v[184:185], v212 offset:8192
    ds_read_b64_tr_b16 v[186:187], v212 offset:9216
    v_sqrt_f32 v193, v193
    s_waitcnt vmcnt(9) lgkmcnt(2)
    v_mfma_f32_32x32x16_bf16 v[140:155], v[176:179], v[120:123], v[140:155]
    ds_read_b64_tr_b16 v[188:189], v213 offset:8192
    ds_read_b64_tr_b16 v[190:191], v213 offset:9216
    s_add_u32 m0, s62, 102400
    s_add_u32 s79, s78, 77824
    buffer_load_dwordx4 v2, s[32:35], s79 offen sc1 lds
    v_mfma_f32_32x32x16_bf16 v[156:171], v[180:183], v[120:123], v[156:171]
    ds_read_b64_tr_b16 v[172:173], v212 offset:10240
    ds_read_b64_tr_b16 v[174:175], v212 offset:11264
    v_cvt_pk_bf16_f32 v193, v193, v193
    v_lshlrev_b32 v193, 16, v193
    s_waitcnt vmcnt(9) lgkmcnt(2)
    v_mfma_f32_32x32x16_bf16 v[140:155], v[184:187], v[124:127], v[140:155]
    ds_read_b64_tr_b16 v[176:177], v213 offset:10240
    ds_read_b64_tr_b16 v[178:179], v213 offset:11264
    s_add_u32 m0, s62, 106496
    s_add_u32 s79, s78, 81920
    buffer_load_dwordx4 v2, s[32:35], s79 offen sc1 lds
    v_mfma_f32_32x32x16_bf16 v[156:171], v[188:191], v[124:127], v[156:171]
    ds_read_b64_tr_b16 v[180:181], v212 offset:12288
    ds_read_b64_tr_b16 v[182:183], v212 offset:13312
    v_rcp_f32 v208, v193
    s_waitcnt vmcnt(9) lgkmcnt(2)
    v_mfma_f32_32x32x16_bf16 v[140:155], v[172:175], v[128:131], v[140:155]
    ds_read_b64_tr_b16 v[184:185], v213 offset:12288
    ds_read_b64_tr_b16 v[186:187], v213 offset:13312
    s_add_u32 m0, s62, 0
    s_add_u32 s79, s66, 0
    buffer_load_dwordx4 v3, s[16:19], s79 offen lds
    v_mfma_f32_32x32x16_bf16 v[156:171], v[176:179], v[128:131], v[156:171]
    ds_read_b64_tr_b16 v[188:189], v212 offset:14336
    ds_read_b64_tr_b16 v[190:191], v212 offset:15360
    v_lshrrev_b32 v209, 16, v193
    v_mul_f32 v210, 0x3fb8aa3b, v208
    s_waitcnt vmcnt(9) lgkmcnt(2)
    v_mfma_f32_32x32x16_bf16 v[140:155], v[180:183], v[132:135], v[140:155]
    ds_read_b64_tr_b16 v[172:173], v213 offset:14336
    ds_read_b64_tr_b16 v[174:175], v213 offset:15360
    s_add_u32 m0, s62, 4096
    s_add_u32 s79, s66, 28672
    buffer_load_dwordx4 v3, s[16:19], s79 offen lds
    v_mfma_f32_32x32x16_bf16 v[156:171], v[184:187], v[132:135], v[156:171]
    s_add_u32 m0, s62, 8192
    s_add_u32 s79, s66, 57344
    buffer_load_dwordx4 v3, s[16:19], s79 offen lds
    s_waitcnt vmcnt(10) lgkmcnt(0)
    v_mfma_f32_32x32x16_bf16 v[140:155], v[188:191], v[136:139], v[140:155]
    s_add_u32 m0, s62, 12288
    s_add_u32 s79, s66, 86016
    buffer_load_dwordx4 v3, s[16:19], s79 offen lds
    v_mfma_f32_32x32x16_bf16 v[156:171], v[172:175], v[136:139], v[156:171]
    s_add_u32 m0, s62, 16384
    s_add_u32 s79, s66, 114688
    buffer_load_dwordx4 v3, s[16:19], s79 offen lds
    s_add_u32 m0, s62, 20480
    s_add_u32 s79, s66, 143360
    buffer_load_dwordx4 v3, s[16:19], s79 offen lds
    v_mfma_f32_32x32x16_bf16 v[140:155], a[10:13], v[24:27], v[140:155]
    v_mfma_f32_32x32x16_bf16 v[156:171], a[12:15], v[24:27], v[156:171]
    s_nop 10
    v_cvt_pk_bf16_f32 v172, v140, v141
    v_cvt_pk_bf16_f32 v173, v142, v143
    v_cvt_pk_bf16_f32 v174, v144, v145
    v_cvt_pk_bf16_f32 v175, v146, v147
    v_cvt_pk_bf16_f32 v176, v148, v149
    v_cvt_pk_bf16_f32 v177, v150, v151
    v_cvt_pk_bf16_f32 v178, v152, v153
    v_cvt_pk_bf16_f32 v179, v154, v155
    v_mfma_f32_32x32x16_bf16 v[216:231], a[2:5], v[172:175], 0
    s_nop 0
    v_mfma_f32_32x32x16_bf16 v[216:231], a[6:9], v[176:179], v[216:231]
    v_cvt_pk_bf16_f32 v180, v156, v157
    v_cvt_pk_bf16_f32 v181, v158, v159
    v_cvt_pk_bf16_f32 v182, v160, v161
    v_cvt_pk_bf16_f32 v183, v162, v163
    v_cvt_pk_bf16_f32 v184, v164, v165
    v_cvt_pk_bf16_f32 v185, v166, v167
    v_cvt_pk_bf16_f32 v186, v168, v169
    v_cvt_pk_bf16_f32 v187, v170, v171
    v_cndmask_b32 v180, v180, 0, s[40:41]
    v_cndmask_b32 v181, v181, v209, s[40:41]
    v_cndmask_b32 v186, v186, 0, s[42:43]
    v_cndmask_b32 v187, v187, v209, s[42:43]
    s_barrier
    ds_write_b32 v236, v180 offset:16384
    ds_write_b32 v237, v181 offset:16384
    ds_write_b32 v238, v182 offset:16384
    ds_write_b32 v239, v183 offset:16384
    ds_write_b32 v240, v184 offset:16384
    ds_write_b32 v241, v185 offset:16384
    ds_write_b32 v242, v186 offset:16384
    ds_write_b32 v243, v187 offset:16384
    v_max3_f32 v200, v216, v217, v218
    v_min3_f32 v201, v216, v217, v218
    v_max3_f32 v200, v200, v219, v220
    v_min3_f32 v201, v201, v219, v220
    v_max3_f32 v200, v200, v221, v222
    v_min3_f32 v201, v201, v221, v222
    v_max3_f32 v200, v200, v223, v224
    v_min3_f32 v201, v201, v223, v224
    v_max3_f32 v200, v200, v225, v226
    v_min3_f32 v201, v201, v225, v226
    v_max3_f32 v200, v200, v227, v228
    v_min3_f32 v201, v201, v227, v228
    v_max_f32 v200, v200, v229
    v_min_f32 v201, v201, v229
    v_mov_b32 v202, v200
    v_mov_b32 v203, v201
    v_mov_b32 v163, 0
    v_permlane32_swap_b32 v202, v200
    v_permlane32_swap_b32 v203, v201
    v_max_f32 v200, v202, v200
    v_min_f32 v201, v203, v201
    v_mul_f32 v204, -v210, v200
    v_mul_f32 v206, v210, v201
    v_pk_fma_f32 v[140:141], v[216:217], v[210:211], v[204:205] op_sel_hi:[1,0,0]
    v_pk_fma_f32 v[142:143], v[218:219], v[210:211], v[204:205] op_sel_hi:[1,0,0]
    v_pk_fma_f32 v[144:145], v[220:221], v[210:211], v[204:205] op_sel_hi:[1,0,0]
    v_pk_fma_f32 v[146:147], v[222:223], v[210:211], v[204:205] op_sel_hi:[1,0,0]
    v_pk_fma_f32 v[148:149], v[224:225], v[210:211], v[204:205] op_sel_hi:[1,0,0]
    v_pk_fma_f32 v[150:151], v[226:227], v[210:211], v[204:205] op_sel_hi:[1,0,0]
    v_pk_fma_f32 v[152:153], v[228:229], v[210:211], v[204:205] op_sel_hi:[1,0,0]
    v_pk_fma_f32 v[216:217], v[216:217], v[210:211], v[206:207] op_sel_hi:[1,0,0] neg_lo:[0,1,0] neg_hi:[0,1,0]
    v_pk_fma_f32 v[218:219], v[218:219], v[210:211], v[206:207] op_sel_hi:[1,0,0] neg_lo:[0,1,0] neg_hi:[0,1,0]
    v_pk_fma_f32 v[220:221], v[220:221], v[210:211], v[206:207] op_sel_hi:[1,0,0] neg_lo:[0,1,0] neg_hi:[0,1,0]
    v_pk_fma_f32 v[222:223], v[222:223], v[210:211], v[206:207] op_sel_hi:[1,0,0] neg_lo:[0,1,0] neg_hi:[0,1,0]
    v_pk_fma_f32 v[224:225], v[224:225], v[210:211], v[206:207] op_sel_hi:[1,0,0] neg_lo:[0,1,0] neg_hi:[0,1,0]
    v_pk_fma_f32 v[226:227], v[226:227], v[210:211], v[206:207] op_sel_hi:[1,0,0] neg_lo:[0,1,0] neg_hi:[0,1,0]
    v_pk_fma_f32 v[228:229], v[228:229], v[210:211], v[206:207] op_sel_hi:[1,0,0] neg_lo:[0,1,0] neg_hi:[0,1,0]
    v_exp_f32 v140, v140
    v_exp_f32 v141, v141
    v_exp_f32 v142, v142
    v_exp_f32 v143, v143
    v_exp_f32 v144, v144
    v_exp_f32 v145, v145
    v_exp_f32 v146, v146
    v_exp_f32 v147, v147
    v_exp_f32 v148, v148
    v_exp_f32 v149, v149
    v_exp_f32 v150, v150
    v_exp_f32 v151, v151
    v_exp_f32 v152, v152
    v_exp_f32 v153, v153
    v_exp_f32 v216, v216
    v_exp_f32 v217, v217
    v_exp_f32 v218, v218
    v_exp_f32 v219, v219
    v_exp_f32 v220, v220
    v_exp_f32 v221, v221
    v_exp_f32 v222, v222
    v_exp_f32 v223, v223
    v_exp_f32 v224, v224
    v_exp_f32 v225, v225
    v_exp_f32 v226, v226
    v_exp_f32 v227, v227
    v_exp_f32 v228, v228
    v_exp_f32 v229, v229
    v_pk_add_f32 v[200:201], v[140:141], v[142:143]
    v_pk_add_f32 v[202:203], v[216:217], v[218:219]
    v_pk_add_f32 v[200:201], v[200:201], v[144:145]
    v_pk_add_f32 v[202:203], v[202:203], v[220:221]
    v_pk_add_f32 v[200:201], v[200:201], v[146:147]
    v_pk_add_f32 v[202:203], v[202:203], v[222:223]
    v_pk_add_f32 v[200:201], v[200:201], v[148:149]
    v_pk_add_f32 v[202:203], v[202:203], v[224:225]
    v_pk_add_f32 v[200:201], v[200:201], v[150:151]
    v_pk_add_f32 v[202:203], v[202:203], v[226:227]
    v_pk_add_f32 v[200:201], v[200:201], v[152:153]
    v_pk_add_f32 v[202:203], v[202:203], v[228:229]
    v_add_f32 v200, v200, v201
    v_add_f32 v202, v202, v203
    v_mov_b32 v204, v200
    v_mov_b32 v206, v202
    v_mov_b32 v171, 0
    v_permlane32_swap_b32 v204, v200
    v_permlane32_swap_b32 v206, v202
    v_add_f32 v200, v200, v204
    v_add_f32 v202, v202, v206
    v_rcp_f32 v200, v200
    v_rcp_f32 v202, v202
    v_mul_f32 v200, v200, v208
    v_mul_f32 v202, v202, v208
    v_pk_mul_f32 v[140:141], v[140:141], v[200:201] op_sel_hi:[1,0]
    v_pk_mul_f32 v[142:143], v[142:143], v[200:201] op_sel_hi:[1,0]
    v_pk_mul_f32 v[144:145], v[144:145], v[200:201] op_sel_hi:[1,0]
    v_pk_mul_f32 v[146:147], v[146:147], v[200:201] op_sel_hi:[1,0]
    v_pk_mul_f32 v[148:149], v[148:149], v[200:201] op_sel_hi:[1,0]
    v_pk_mul_f32 v[150:151], v[150:151], v[200:201] op_sel_hi:[1,0]
    v_pk_mul_f32 v[152:153], v[152:153], v[200:201] op_sel_hi:[1,0]
    v_cvt_pk_bf16_f32 v156, v140, v141
    v_cvt_pk_bf16_f32 v157, v142, v143
    ds_write_b64 v232, v[156:157] offset:0
    v_cvt_pk_bf16_f32 v158, v144, v145
    v_cvt_pk_bf16_f32 v159, v146, v147
    ds_write_b64 v233, v[158:159] offset:0
    v_cvt_pk_bf16_f32 v160, v148, v149
    v_cvt_pk_bf16_f32 v161, v150, v151
    ds_write_b64 v234, v[160:161] offset:0
    v_cvt_pk_bf16_f32 v162, v152, v153
    ds_write_b64 v235, v[162:163] offset:0
    v_pk_mul_f32 v[216:217], v[216:217], v[202:203] op_sel_hi:[1,0]
    v_pk_mul_f32 v[218:219], v[218:219], v[202:203] op_sel_hi:[1,0]
    v_pk_mul_f32 v[220:221], v[220:221], v[202:203] op_sel_hi:[1,0]
    v_pk_mul_f32 v[222:223], v[222:223], v[202:203] op_sel_hi:[1,0]
    v_pk_mul_f32 v[224:225], v[224:225], v[202:203] op_sel_hi:[1,0]
    v_pk_mul_f32 v[226:227], v[226:227], v[202:203] op_sel_hi:[1,0]
    v_pk_mul_f32 v[228:229], v[228:229], v[202:203] op_sel_hi:[1,0]
    v_cvt_pk_bf16_f32 v164, v216, v217
    v_cvt_pk_bf16_f32 v165, v218, v219
    ds_write_b64 v232, v[164:165] offset:8192
    v_cvt_pk_bf16_f32 v166, v220, v221
    v_cvt_pk_bf16_f32 v167, v222, v223
    ds_write_b64 v233, v[166:167] offset:8192
    v_cvt_pk_bf16_f32 v168, v224, v225
    v_cvt_pk_bf16_f32 v169, v226, v227
    ds_write_b64 v234, v[168:169] offset:8192
    v_cvt_pk_bf16_f32 v170, v228, v229
    ds_write_b64 v235, v[170:171] offset:8192
    v_xor_b32 v232, 32, v246
    v_xor_b32 v233, 32, v247
    s_lshl_b32 s69, s56, 11
    s_add_u32 s69, s69, s89
    s_waitcnt lgkmcnt(0)
    s_barrier
    ds_read_b64_tr_b16 v[216:217], v244 offset:0
    ds_read_b64_tr_b16 v[218:219], v245 offset:256
    ds_read_b64_tr_b16 v[140:141], v246 offset:0
    ds_read_b64_tr_b16 v[142:143], v247 offset:256
    ds_read_b64_tr_b16 v[144:145], v232 offset:0
    ds_read_b64_tr_b16 v[146:147], v233 offset:256
    ds_read_b64_tr_b16 v[220:221], v244 offset:2048
    ds_read_b64_tr_b16 v[222:223], v245 offset:2304
    ds_read_b64_tr_b16 v[148:149], v246 offset:2048
    ds_read_b64_tr_b16 v[150:151], v247 offset:2304
    ds_read_b64_tr_b16 v[152:153], v232 offset:2048
    ds_read_b64_tr_b16 v[154:155], v233 offset:2304
    ds_read_b64_tr_b16 v[224:225], v244 offset:4096
    ds_read_b64_tr_b16 v[226:227], v245 offset:4352
    ds_read_b64_tr_b16 v[172:173], v246 offset:4096
    ds_read_b64_tr_b16 v[174:175], v247 offset:4352
    ds_read_b64_tr_b16 v[176:177], v232 offset:4096
    ds_read_b64_tr_b16 v[178:179], v233 offset:4352
    ds_read_b64_tr_b16 v[228:229], v244 offset:6144
    ds_read_b64_tr_b16 v[230:231], v245 offset:6400
    ds_read_b64_tr_b16 v[180:181], v246 offset:6144
    ds_read_b64_tr_b16 v[182:183], v247 offset:6400
    ds_read_b64_tr_b16 v[184:185], v232 offset:6144
    ds_read_b64_tr_b16 v[186:187], v233 offset:6400
    s_waitcnt lgkmcnt(15)
    v_mfma_f32_16x16x32_bf16 v[156:159], v[216:219], v[140:143], 0
    v_mfma_f32_16x16x32_bf16 v[160:163], v[216:219], v[144:147], 0
    s_waitcnt lgkmcnt(14)
    v_mfma_f32_16x16x32_bf16 v[156:159], v[220:223], v[148:151], v[156:159]
    s_waitcnt lgkmcnt(12)
    v_mfma_f32_16x16x32_bf16 v[160:163], v[220:223], v[152:155], v[160:163]
    s_waitcnt lgkmcnt(8)
    v_mfma_f32_16x16x32_bf16 v[156:159], v[224:227], v[172:175], v[156:159]
    s_waitcnt lgkmcnt(6)
    v_mfma_f32_16x16x32_bf16 v[160:163], v[224:227], v[176:179], v[160:163]
    s_waitcnt lgkmcnt(2)
    v_mfma_f32_16x16x32_bf16 v[156:159], v[228:231], v[180:183], v[156:159]
    s_waitcnt lgkmcnt(0)
    v_mfma_f32_16x16x32_bf16 v[160:163], v[228:231], v[184:187], v[160:163]
    s_bitcmp1_b32 s56, 0
    s_cselect_b32 s72, 0, -1
    s_nop 3
    v_cndmask_b32 v156, v156, 1.0, s[48:49]
    s_nop 0
    v_cndmask_b32 v160, v160, 1.0, s[54:55]
    buffer_atomic_add_f32 v156, v215, s[32:35], s69 offen offset:0
    buffer_atomic_add_f32 v160, v215, s[32:35], s69 offen offset:64
    v_cndmask_b32 v157, v157, 1.0, s[48:49]
    v_cndmask_b32 v161, v161, 1.0, s[54:55]
    buffer_atomic_add_f32 v157, v215, s[32:35], s69 offen offset:256
    buffer_atomic_add_f32 v161, v215, s[32:35], s69 offen offset:320
    s_mov_b32 exec_hi, s72
    v_cndmask_b32 v158, v158, 1.0, s[48:49]
    v_cndmask_b32 v162, v162, 1.0, s[54:55]
    buffer_atomic_add_f32 v158, v215, s[32:35], s69 offen offset:512
    buffer_atomic_add_f32 v162, v215, s[32:35], s69 offen offset:576
    v_cndmask_b32 v159, v159, 1.0, s[48:49]
    v_cndmask_b32 v163, v163, 1.0, s[54:55]
    buffer_atomic_add_f32 v159, v215, s[32:35], s69 offen offset:768
    buffer_atomic_add_f32 v163, v215, s[32:35], s69 offen offset:832
    s_mov_b64 exec, -1
    s_waitcnt vmcnt(14)
    s_barrier
    s_lshr_b32 s72, s2, 3
    s_lshl_b32 s72, s72, 2
    s_add_u32 s72, s72, s56
    s_mul_i32 s72, s72, 128
    s_add_u32 s72, s72, L_c_k2b1-interleave_layers__linear_kernel_hedgehog__glu_gated_geglu__prompt_kernel
    v_lshlrev_b32 v252, 7, v1
    v_add_u32 v252, s72, v252
    v_min_u32 v252, L_c_k41-interleave_layers__linear_kernel_hedgehog__glu_gated_geglu__prompt_kernel-4, v252
    s_mov_b64 exec, 1
    global_load_dword a0, v252, s[52:53]
    s_mov_b64 exec, -1
    v_add_u32 v214, 81920, v214
    ds_read_b64_tr_b16 v[172:173], v214 offset:0
    ds_read_b64_tr_b16 v[174:175], v214 offset:512
    ds_read_b64_tr_b16 v[176:177], v214 offset:1024
    ds_read_b64_tr_b16 v[178:179], v214 offset:1536
    ds_read_b64_tr_b16 v[180:181], v214 offset:2048
    ds_read_b64_tr_b16 v[182:183], v214 offset:2560
    s_waitcnt lgkmcnt(2)
    v_mfma_f32_32x32x16_bf16 v[140:155], v[172:175], v[28:31], 0
    ds_read_b64_tr_b16 v[184:185], v214 offset:3072
    ds_read_b64_tr_b16 v[186:187], v214 offset:3584
    s_add_u32 m0, s62, 24576
    s_add_u32 s79, s66, 172032
    buffer_load_dwordx4 v3, s[16:19], s79 offen lds
    v_mfma_f32_32x32x16_bf16 v[140:155], v[176:179], v[32:35], v[140:155]
    ds_read_b64_tr_b16 v[188:189], v214 offset:4096
    ds_read_b64_tr_b16 v[190:191], v214 offset:4608
    s_waitcnt lgkmcnt(2)
    v_mfma_f32_32x32x16_bf16 v[140:155], v[180:183], v[36:39], v[140:155]
    ds_read_b64_tr_b16 v[172:173], v214 offset:5120
    ds_read_b64_tr_b16 v[174:175], v214 offset:5632
    v_mfma_f32_32x32x16_bf16 v[140:155], v[184:187], v[40:43], v[140:155]
    ds_read_b64_tr_b16 v[176:177], v214 offset:6144
    ds_read_b64_tr_b16 v[178:179], v214 offset:6656
    s_add_u32 m0, s62, 28672
    s_add_u32 s79, s66, 200704
    buffer_load_dwordx4 v3, s[16:19], s79 offen lds
    s_waitcnt lgkmcnt(2)
    v_mfma_f32_32x32x16_bf16 v[140:155], v[188:191], v[44:47], v[140:155]
    ds_read_b64_tr_b16 v[180:181], v214 offset:7168
    ds_read_b64_tr_b16 v[182:183], v214 offset:7680
    v_mfma_f32_32x32x16_bf16 v[140:155], v[172:175], v[48:51], v[140:155]
    ds_read_b64_tr_b16 v[184:185], v214 offset:8192
    ds_read_b64_tr_b16 v[186:187], v214 offset:8704
    s_waitcnt lgkmcnt(2)
    v_mfma_f32_32x32x16_bf16 v[140:155], v[176:179], v[52:55], v[140:155]
    ds_read_b64_tr_b16 v[188:189], v214 offset:9216
    ds_read_b64_tr_b16 v[190:191], v214 offset:9728
    v_mfma_f32_32x32x16_bf16 v[140:155], v[180:183], v[56:59], v[140:155]
    ds_read_b64_tr_b16 v[172:173], v214 offset:10240
    ds_read_b64_tr_b16 v[174:175], v214 offset:10752
    s_add_u32 m0, s62, 32768
    s_add_u32 s79, s66, 229376
    buffer_load_dwordx4 v3, s[16:19], s79 offen lds
    s_waitcnt lgkmcnt(2)
    v_mfma_f32_32x32x16_bf16 v[140:155], v[184:187], v[60:63], v[140:155]
    ds_read_b64_tr_b16 v[176:177], v214 offset:11264
    ds_read_b64_tr_b16 v[178:179], v214 offset:11776
    v_mfma_f32_32x32x16_bf16 v[140:155], v[188:191], v[64:67], v[140:155]
    ds_read_b64_tr_b16 v[180:181], v214 offset:12288
    ds_read_b64_tr_b16 v[182:183], v214 offset:12800
    s_waitcnt lgkmcnt(2)
    v_mfma_f32_32x32x16_bf16 v[140:155], v[172:175], v[68:71], v[140:155]
    ds_read_b64_tr_b16 v[184:185], v214 offset:13312
    ds_read_b64_tr_b16 v[186:187], v214 offset:13824
    s_add_u32 m0, s62, 36864
    s_add_u32 s79, s66, 258048
    buffer_load_dwordx4 v3, s[16:19], s79 offen lds
    v_mfma_f32_32x32x16_bf16 v[140:155], v[176:179], v[72:75], v[140:155]
    ds_read_b64_tr_b16 v[188:189], v214 offset:14336
    ds_read_b64_tr_b16 v[190:191], v214 offset:14848
    s_waitcnt lgkmcnt(2)
    v_mfma_f32_32x32x16_bf16 v[140:155], v[180:183], v[76:79], v[140:155]
    ds_read_b64_tr_b16 v[172:173], v214 offset:15360
    ds_read_b64_tr_b16 v[174:175], v214 offset:15872
    v_mfma_f32_32x32x16_bf16 v[140:155], v[184:187], v[80:83], v[140:155]
    ds_read_b64_tr_b16 v[176:177], v214 offset:16384
    ds_read_b64_tr_b16 v[178:179], v214 offset:16896
    s_waitcnt lgkmcnt(2)
    v_mfma_f32_32x32x16_bf16 v[140:155], v[188:191], v[84:87], v[140:155]
    ds_read_b64_tr_b16 v[180:181], v214 offset:17408
    ds_read_b64_tr_b16 v[182:183], v214 offset:17920
    s_add_u32 m0, s62, 40960
    s_add_u32 s79, s66, 286720
    buffer_load_dwordx4 v3, s[16:19], s79 offen lds
    v_mfma_f32_32x32x16_bf16 v[140:155], v[172:175], v[88:91], v[140:155]
    ds_read_b64_tr_b16 v[184:185], v214 offset:18432
    ds_read_b64_tr_b16 v[186:187], v214 offset:18944
    s_waitcnt lgkmcnt(2)
    v_mfma_f32_32x32x16_bf16 v[140:155], v[176:179], v[92:95], v[140:155]
    ds_read_b64_tr_b16 v[188:189], v214 offset:19456
    ds_read_b64_tr_b16 v[190:191], v214 offset:19968
    v_mfma_f32_32x32x16_bf16 v[140:155], v[180:183], v[96:99], v[140:155]
    ds_read_b64_tr_b16 v[172:173], v214 offset:20480
    ds_read_b64_tr_b16 v[174:175], v214 offset:20992
    s_add_u32 m0, s62, 45056
    s_add_u32 s79, s66, 315392
    buffer_load_dwordx4 v3, s[16:19], s79 offen lds
    s_waitcnt lgkmcnt(2)
    v_mfma_f32_32x32x16_bf16 v[140:155], v[184:187], v[100:103], v[140:155]
    ds_read_b64_tr_b16 v[176:177], v214 offset:21504
    ds_read_b64_tr_b16 v[178:179], v214 offset:22016
    v_mfma_f32_32x32x16_bf16 v[140:155], v[188:191], v[104:107], v[140:155]
    ds_read_b64_tr_b16 v[180:181], v214 offset:22528
    ds_read_b64_tr_b16 v[182:183], v214 offset:23040
    s_waitcnt lgkmcnt(2)
    v_mfma_f32_32x32x16_bf16 v[140:155], v[172:175], v[108:111], v[140:155]
    ds_read_b64_tr_b16 v[184:185], v214 offset:23552
    ds_read_b64_tr_b16 v[186:187], v214 offset:24064
    v_mfma_f32_32x32x16_bf16 v[140:155], v[176:179], v[112:115], v[140:155]
    ds_read_b64_tr_b16 v[188:189], v214 offset:24576
    ds_read_b64_tr_b16 v[190:191], v214 offset:25088
    s_add_u32 m0, s62, 49152
    s_add_u32 s79, s66, 344064
    buffer_load_dwordx4 v3, s[16:19], s79 offen lds
    s_waitcnt lgkmcnt(2)
    v_mfma_f32_32x32x16_bf16 v[140:155], v[180:183], v[116:119], v[140:155]
    ds_read_b64_tr_b16 v[172:173], v214 offset:25600
    ds_read_b64_tr_b16 v[174:175], v214 offset:26112
    v_mfma_f32_32x32x16_bf16 v[140:155], v[184:187], v[120:123], v[140:155]
    ds_read_b64_tr_b16 v[176:177], v214 offset:26624
    ds_read_b64_tr_b16 v[178:179], v214 offset:27136
    s_waitcnt lgkmcnt(2)
    v_mfma_f32_32x32x16_bf16 v[140:155], v[188:191], v[124:127], v[140:155]
    ds_read_b64_tr_b16 v[180:181], v214 offset:27648
    ds_read_b64_tr_b16 v[182:183], v214 offset:28160
    s_add_u32 m0, s62, 53248
    s_add_u32 s79, s66, 372736
    buffer_load_dwordx4 v3, s[16:19], s79 offen lds
    v_mfma_f32_32x32x16_bf16 v[140:155], v[172:175], v[128:131], v[140:155]
    s_waitcnt lgkmcnt(0)
    v_mfma_f32_32x32x16_bf16 v[140:155], v[176:179], v[132:135], v[140:155]
    v_mfma_f32_32x32x16_bf16 v[140:155], v[180:183], v[136:139], v[140:155]
    v_mfma_f32_32x32x16_bf16 v[140:155], a[14:17], v[24:27], v[140:155]
    s_barrier
    s_nop 10
    v_cvt_pk_bf16_f32 v172, v140, v141
    v_cvt_pk_bf16_f32 v173, v142, v143
    v_cvt_pk_bf16_f32 v174, v144, v145
    v_cvt_pk_bf16_f32 v175, v146, v147
    v_cvt_pk_bf16_f32 v176, v148, v149
    v_cvt_pk_bf16_f32 v177, v150, v151
    v_cvt_pk_bf16_f32 v178, v152, v153
    v_cvt_pk_bf16_f32 v179, v154, v155
    v_mfma_f32_32x32x16_bf16 v[216:231], a[2:5], v[172:175], 0
    s_nop 0
    v_mfma_f32_32x32x16_bf16 v[216:231], a[6:9], v[176:179], v[216:231]
    v_lshlrev_b32 v194, 2, v1
    v_and_b32 v195, 3, v1
    v_lshlrev_b32 v195, 11, v195
    s_lshl_b32 s70, s56, 4
    s_add_u32 s70, s70, s58
    s_lshl_b32 s70, s70, 11
    s_add_u32 s70, s70, s63
    s_add_u32 s70, s70, 0x10000
    s_lshl_b32 s90, s56, 7
    s_add_u32 s90, s90, s63
    s_mul_i32 s72, s58, 4
    s_add_u32 s90, s90, s72
    s_add_u32 s90, s90, 0
    s_add_u32 s71, s89, 4096
    v_max3_f32 v200, v216, v217, v218
    v_min3_f32 v201, v216, v217, v218
    v_max3_f32 v200, v200, v219, v220
    v_min3_f32 v201, v201, v219, v220
    v_max3_f32 v200, v200, v221, v222
    v_min3_f32 v201, v201, v221, v222
    v_max3_f32 v200, v200, v223, v224
    v_min3_f32 v201, v201, v223, v224
    v_max3_f32 v200, v200, v225, v226
    v_min3_f32 v201, v201, v225, v226
    v_max3_f32 v200, v200, v227, v228
    v_min3_f32 v201, v201, v227, v228
    v_max_f32 v200, v200, v229
    v_min_f32 v201, v201, v229
    v_mov_b32 v202, v200
    v_mov_b32 v203, v201
    v_mov_b32 v163, 0
    v_permlane32_swap_b32 v202, v200
    v_permlane32_swap_b32 v203, v201
    v_max_f32 v200, v202, v200
    v_min_f32 v201, v203, v201
    v_mul_f32 v204, -v210, v200
    v_mul_f32 v206, v210, v201
    v_pk_fma_f32 v[140:141], v[216:217], v[210:211], v[204:205] op_sel_hi:[1,0,0]
    v_pk_fma_f32 v[142:143], v[218:219], v[210:211], v[204:205] op_sel_hi:[1,0,0]
    v_pk_fma_f32 v[144:145], v[220:221], v[210:211], v[204:205] op_sel_hi:[1,0,0]
    v_pk_fma_f32 v[146:147], v[222:223], v[210:211], v[204:205] op_sel_hi:[1,0,0]
    v_pk_fma_f32 v[148:149], v[224:225], v[210:211], v[204:205] op_sel_hi:[1,0,0]
    v_pk_fma_f32 v[150:151], v[226:227], v[210:211], v[204:205] op_sel_hi:[1,0,0]
    v_pk_fma_f32 v[152:153], v[228:229], v[210:211], v[204:205] op_sel_hi:[1,0,0]
    v_pk_fma_f32 v[216:217], v[216:217], v[210:211], v[206:207] op_sel_hi:[1,0,0] neg_lo:[0,1,0] neg_hi:[0,1,0]
    v_pk_fma_f32 v[218:219], v[218:219], v[210:211], v[206:207] op_sel_hi:[1,0,0] neg_lo:[0,1,0] neg_hi:[0,1,0]
    v_pk_fma_f32 v[220:221], v[220:221], v[210:211], v[206:207] op_sel_hi:[1,0,0] neg_lo:[0,1,0] neg_hi:[0,1,0]
    v_pk_fma_f32 v[222:223], v[222:223], v[210:211], v[206:207] op_sel_hi:[1,0,0] neg_lo:[0,1,0] neg_hi:[0,1,0]
    v_pk_fma_f32 v[224:225], v[224:225], v[210:211], v[206:207] op_sel_hi:[1,0,0] neg_lo:[0,1,0] neg_hi:[0,1,0]
    v_pk_fma_f32 v[226:227], v[226:227], v[210:211], v[206:207] op_sel_hi:[1,0,0] neg_lo:[0,1,0] neg_hi:[0,1,0]
    v_pk_fma_f32 v[228:229], v[228:229], v[210:211], v[206:207] op_sel_hi:[1,0,0] neg_lo:[0,1,0] neg_hi:[0,1,0]
    v_exp_f32 v140, v140
    v_exp_f32 v141, v141
    v_exp_f32 v142, v142
    v_exp_f32 v143, v143
    v_exp_f32 v144, v144
    v_exp_f32 v145, v145
    v_exp_f32 v146, v146
    v_exp_f32 v147, v147
    v_exp_f32 v148, v148
    v_exp_f32 v149, v149
    v_exp_f32 v150, v150
    v_exp_f32 v151, v151
    v_exp_f32 v152, v152
    v_exp_f32 v153, v153
    v_exp_f32 v216, v216
    v_exp_f32 v217, v217
    v_exp_f32 v218, v218
    v_exp_f32 v219, v219
    v_exp_f32 v220, v220
    v_exp_f32 v221, v221
    v_exp_f32 v222, v222
    v_exp_f32 v223, v223
    v_exp_f32 v224, v224
    v_exp_f32 v225, v225
    v_exp_f32 v226, v226
    v_exp_f32 v227, v227
    v_exp_f32 v228, v228
    v_exp_f32 v229, v229
    v_pk_add_f32 v[200:201], v[140:141], v[142:143]
    v_pk_add_f32 v[202:203], v[216:217], v[218:219]
    v_pk_add_f32 v[200:201], v[200:201], v[144:145]
    v_pk_add_f32 v[202:203], v[202:203], v[220:221]
    v_pk_add_f32 v[200:201], v[200:201], v[146:147]
    v_pk_add_f32 v[202:203], v[202:203], v[222:223]
    v_pk_add_f32 v[200:201], v[200:201], v[148:149]
    v_pk_add_f32 v[202:203], v[202:203], v[224:225]
    v_pk_add_f32 v[200:201], v[200:201], v[150:151]
    v_pk_add_f32 v[202:203], v[202:203], v[226:227]
    v_pk_add_f32 v[200:201], v[200:201], v[152:153]
    v_pk_add_f32 v[202:203], v[202:203], v[228:229]
    v_add_f32 v200, v200, v201
    v_add_f32 v202, v202, v203
    v_mov_b32 v204, v200
    v_mov_b32 v206, v202
    v_mov_b32 v171, 0
    v_permlane32_swap_b32 v204, v200
    v_permlane32_swap_b32 v206, v202
    v_add_f32 v200, v200, v204
    v_add_f32 v202, v202, v206
    v_rcp_f32 v200, v200
    v_rcp_f32 v202, v202
    v_pk_mul_f32 v[140:141], v[140:141], v[200:201] op_sel_hi:[1,0]
    v_pk_mul_f32 v[142:143], v[142:143], v[200:201] op_sel_hi:[1,0]
    v_pk_mul_f32 v[144:145], v[144:145], v[200:201] op_sel_hi:[1,0]
    v_pk_mul_f32 v[146:147], v[146:147], v[200:201] op_sel_hi:[1,0]
    v_pk_mul_f32 v[148:149], v[148:149], v[200:201] op_sel_hi:[1,0]
    v_pk_mul_f32 v[150:151], v[150:151], v[200:201] op_sel_hi:[1,0]
    v_pk_mul_f32 v[152:153], v[152:153], v[200:201] op_sel_hi:[1,0]
    v_cvt_pk_bf16_f32 v156, v140, v141
    v_cvt_pk_bf16_f32 v157, v142, v143
    v_cvt_pk_bf16_f32 v158, v144, v145
    v_cvt_pk_bf16_f32 v159, v146, v147
    v_cvt_pk_bf16_f32 v160, v148, v149
    v_cvt_pk_bf16_f32 v161, v150, v151
    v_cvt_pk_bf16_f32 v162, v152, v153
    v_pk_mul_f32 v[216:217], v[216:217], v[202:203] op_sel_hi:[1,0]
    v_pk_mul_f32 v[218:219], v[218:219], v[202:203] op_sel_hi:[1,0]
    v_pk_mul_f32 v[220:221], v[220:221], v[202:203] op_sel_hi:[1,0]
    v_pk_mul_f32 v[222:223], v[222:223], v[202:203] op_sel_hi:[1,0]
    v_pk_mul_f32 v[224:225], v[224:225], v[202:203] op_sel_hi:[1,0]
    v_pk_mul_f32 v[226:227], v[226:227], v[202:203] op_sel_hi:[1,0]
    v_pk_mul_f32 v[228:229], v[228:229], v[202:203] op_sel_hi:[1,0]
    v_cvt_pk_bf16_f32 v164, v216, v217
    v_cvt_pk_bf16_f32 v165, v218, v219
    v_cvt_pk_bf16_f32 v166, v220, v221
    v_cvt_pk_bf16_f32 v167, v222, v223
    v_cvt_pk_bf16_f32 v168, v224, v225
    v_cvt_pk_bf16_f32 v169, v226, v227
    v_cvt_pk_bf16_f32 v170, v228, v229
    s_mov_b32 s73, 0
    s_mov_b32 s72, 0x41800000
    s_waitcnt vmcnt(0)
    s_branch L_kv_348_go
L_kv_348:
    buffer_load_dword v197, v195, s[32:35], s89 offen offset:892 sc1
    s_waitcnt vmcnt(0)
    v_cmp_eq_u32 s[44:45], s72, v197
    s_add_u32 s73, s73, 1
    s_cmp_eq_u64 s[44:45], -1
    s_cbranch_scc1 L_kv_348_go
    s_sleep 1
    s_cmp_lt_u32 s73, 262144
    s_cbranch_scc1 L_kv_348
L_kv_348_go:
    buffer_load_dword v28, v194, s[32:35], s89 offen offset:0 sc1
    buffer_load_dword v29, v194, s[32:35], s89 offen offset:256 sc1
    buffer_load_dword v30, v194, s[32:35], s89 offen offset:512 sc1
    buffer_load_dword v31, v194, s[32:35], s89 offen offset:768 sc1
    buffer_load_dword v32, v194, s[32:35], s89 offen offset:1024 sc1
    buffer_load_dword v33, v194, s[32:35], s89 offen offset:1280 sc1
    buffer_load_dword v34, v194, s[32:35], s89 offen offset:1536 sc1
    buffer_load_dword v35, v194, s[32:35], s89 offen offset:1792 sc1
    buffer_load_dword v36, v194, s[32:35], s89 offen offset:2048 sc1
    buffer_load_dword v37, v194, s[32:35], s89 offen offset:2304 sc1
    buffer_load_dword v38, v194, s[32:35], s89 offen offset:2560 sc1
    buffer_load_dword v39, v194, s[32:35], s89 offen offset:2816 sc1
    buffer_load_dword v40, v194, s[32:35], s89 offen offset:3072 sc1
    buffer_load_dword v41, v194, s[32:35], s89 offen offset:3328 sc1
    buffer_load_dword v44, v194, s[32:35], s71 offen offset:0 sc1
    buffer_load_dword v45, v194, s[32:35], s71 offen offset:256 sc1
    buffer_load_dword v46, v194, s[32:35], s71 offen offset:512 sc1
    buffer_load_dword v47, v194, s[32:35], s71 offen offset:768 sc1
    buffer_load_dword v48, v194, s[32:35], s71 offen offset:1024 sc1
    buffer_load_dword v49, v194, s[32:35], s71 offen offset:1280 sc1
    buffer_load_dword v50, v194, s[32:35], s71 offen offset:1536 sc1
    buffer_load_dword v51, v194, s[32:35], s71 offen offset:1792 sc1
    buffer_load_dword v52, v194, s[32:35], s71 offen offset:2048 sc1
    buffer_load_dword v53, v194, s[32:35], s71 offen offset:2304 sc1
    buffer_load_dword v54, v194, s[32:35], s71 offen offset:2560 sc1
    buffer_load_dword v55, v194, s[32:35], s71 offen offset:2816 sc1
    buffer_load_dword v56, v194, s[32:35], s71 offen offset:3072 sc1
    buffer_load_dword v57, v194, s[32:35], s71 offen offset:3328 sc1
    v_mov_b32 v67, 0
    v_mov_b32 v75, 0
    s_waitcnt vmcnt(20)
    v_cvt_pk_bf16_f32 v60, v28, v29
    v_cvt_pk_bf16_f32 v61, v30, v31
    v_cvt_pk_bf16_f32 v62, v32, v33
    v_cvt_pk_bf16_f32 v63, v34, v35
    s_nop 1
    v_mfma_f32_32x32x16_bf16 v[216:231], v[60:63], v[156:159], 0
    v_min_f32 v197, v28, v29
    v_min3_f32 v197, v197, v30, v31
    v_min3_f32 v197, v197, v32, v33
    v_min3_f32 v197, v197, v34, v35
    s_waitcnt vmcnt(14)
    v_cvt_pk_bf16_f32 v64, v36, v37
    v_cvt_pk_bf16_f32 v65, v38, v39
    v_cvt_pk_bf16_f32 v66, v40, v41
    s_nop 1
    v_mfma_f32_32x32x16_bf16 v[216:231], v[64:67], v[160:163], v[216:231]
    v_min3_f32 v197, v197, v36, v37
    v_min3_f32 v197, v197, v38, v39
    v_min3_f32 v197, v197, v40, v41
    s_waitcnt vmcnt(6)
    v_cvt_pk_bf16_f32 v68, v44, v45
    v_cvt_pk_bf16_f32 v69, v46, v47
    v_cvt_pk_bf16_f32 v70, v48, v49
    v_cvt_pk_bf16_f32 v71, v50, v51
    s_nop 1
    v_mfma_f32_32x32x16_bf16 v[216:231], v[68:71], v[164:167], v[216:231]
    v_min3_f32 v197, v197, v44, v45
    v_min3_f32 v197, v197, v46, v47
    v_min3_f32 v197, v197, v48, v49
    v_min3_f32 v197, v197, v50, v51
    s_waitcnt vmcnt(0)
    v_cvt_pk_bf16_f32 v72, v52, v53
    v_cvt_pk_bf16_f32 v73, v54, v55
    v_cvt_pk_bf16_f32 v74, v56, v57
    s_nop 1
    v_mfma_f32_32x32x16_bf16 v[216:231], v[72:75], v[168:171], v[216:231]
    v_min3_f32 v197, v197, v52, v53
    v_min3_f32 v197, v197, v54, v55
    v_min3_f32 v197, v197, v56, v57
    v_cmp_ne_u32 s[44:45], s72, v197
    s_add_u32 s73, s73, 1
    s_or_b32 s44, s44, s45
    s_and_b32 s44, s44, 0x80004000
    s_cselect_b32 s79, s73, 262144
    s_cmp_lt_u32 s79, 262144
    s_cbranch_scc1 L_kv_348
    s_nop 1
    v_mov_b32 v194, v230
    v_mov_b32 v196, v230
    s_nop 1
    v_permlane32_swap_b32 v194, v196
    v_add_f32 v196, 0x358637bd, v196
    v_rcp_f32 v196, v196
    s_nop 0
    v_pk_mul_f32 v[216:217], v[216:217], v[196:197] op_sel_hi:[1,0]
    v_pk_mul_f32 v[218:219], v[218:219], v[196:197] op_sel_hi:[1,0]
    v_pk_mul_f32 v[220:221], v[220:221], v[196:197] op_sel_hi:[1,0]
    v_pk_mul_f32 v[222:223], v[222:223], v[196:197] op_sel_hi:[1,0]
    v_pk_mul_f32 v[224:225], v[224:225], v[196:197] op_sel_hi:[1,0]
    v_pk_mul_f32 v[226:227], v[226:227], v[196:197] op_sel_hi:[1,0]
    v_pk_mul_f32 v[228:229], v[228:229], v[196:197] op_sel_hi:[1,0]
    v_pk_mul_f32 v[230:231], v[230:231], v[196:197] op_sel_hi:[1,0]
    v_cvt_pk_bf16_f32 v172, v216, v217
    v_cvt_pk_bf16_f32 v173, v218, v219
    v_cvt_pk_bf16_f32 v174, v220, v221
    v_cvt_pk_bf16_f32 v175, v222, v223
    v_cvt_pk_bf16_f32 v176, v224, v225
    v_cvt_pk_bf16_f32 v177, v226, v227
    v_cvt_pk_bf16_f32 v178, v228, v229
    v_cvt_pk_bf16_f32 v179, v230, v231
    v_cndmask_b32 v175, v175, 0, s[38:39]
    v_cndmask_b32 v179, v179, 0, s[38:39]
    s_cmp_lg_u32 s61, 0
    s_cbranch_scc1 L_var16_wt
    buffer_store_dwordx4 v[172:175], v2, s[32:35], s70 offen offset:0
    buffer_store_dwordx4 v[176:179], v2, s[32:35], s70 offen offset:1024
L_var16_end:
    s_cmp_ge_u32 s58, 14
    s_cbranch_scc1 L_idle1
L_c_k2b1:
    v_lshrrev_b32 v148, 4, v1
    v_bfe_u32 v149, v1, 2, 2
    v_and_b32 v150, 3, v1
    v_and_b32 v151, 1, v148
    v_lshlrev_b32 v151, 1, v151
    v_lshrrev_b32 v153, 1, v150
    v_add_u32 v151, v151, v153
    v_and_b32 v153, 2, v149
    v_lshlrev_b32 v153, 1, v153
    v_xor_b32 v151, v151, v153
    v_lshlrev_b32 v151, 4, v151
    v_and_b32 v150, 1, v150
    v_lshl_add_u32 v151, v150, 3, v151
    v_lshrrev_b32 v148, 1, v148
    v_lshl_add_u32 v149, v148, 2, v149
    v_lshl_add_u32 v152, v149, 7, v151
    v_xor_b32 v153, 64, v152
    s_mul_i32 s69, s76, 28672
    s_lshl_b32 s71, s76, 6
    v_xor_b32 v152, s71, v152
    v_add_u32 v152, s69, v152
    v_xor_b32 v153, s71, v153
    v_add_u32 v153, s69, v153
    v_and_b32 v148, 40, v1
    v_cmp_eq_u32 vcc, 40, v148
    v_add_u32 v148, -256, v152
    v_add_u32 v149, -256, v153
    v_cndmask_b32 v154, v153, v148, vcc
    v_cndmask_b32 v155, v152, v149, vcc
    s_lshl_b32 s88, s56, 12
    s_add_u32 s88, s88, 0
    v_add_u32 v148, s88, v2
    s_xor_b32 s88, s56, 2
    s_lshl_b32 s88, s88, 12
    s_add_u32 s88, s88, 0
    v_add_u32 v149, s88, v2
    s_mul_i32 s88, s75, 28672
    s_lshl_b32 s91, s60, 12
    s_add_u32 s88, s88, s91
    s_lshl_b32 s91, s76, 11
    s_add_u32 s88, s88, s91
    s_add_u32 s88, s88, s63
    s_add_u32 s88, s88, 0x30000
    s_lshl_b32 s89, s60, 1
    s_add_u32 s89, s89, s76
    s_lshl_b32 s91, s75, 7
    s_add_u32 s91, s91, s63
    s_mul_i32 s72, s89, 4
    s_add_u32 s91, s91, s72
    s_add_u32 s91, s91, 512
    s_cmp_ge_u32 s89, 7
    s_cselect_b32 s72, 7, 0
    s_sub_u32 s89, s89, s72
    s_mul_i32 s72, s72, 73
    s_add_u32 s72, s72, 1
    s_and_b32 s72, s72, 512
    s_lshr_b32 s79, s89, 1
    s_lshl_b32 s79, s79, 10
    s_add_u32 s72, s72, s79
    s_and_b32 s89, s89, 1
    s_lshl_b32 s89, s89, 3
    s_add_u32 s89, s89, s72
    s_lshl_b32 s72, s75, 12
    s_add_u32 s89, s89, s72
    s_add_u32 s89, s89, s63
    s_add_u32 s89, s89, 0x9000
    v_and_b32 v150, 31, v1
    v_lshlrev_b32 v150, 4, v150
    s_lshl_b32 s70, s75, 15
    s_lshl_b32 s71, s76, 14
    s_add_u32 s70, s70, s71
    s_add_u32 s70, s70, s63
    s_waitcnt vmcnt(0)
    v_mov_b32 v7, 2
    s_mov_b64 exec, 1
    s_cmp_lg_u32 s61, 0
    s_cbranch_scc1 L_var17_wt
    buffer_store_dword v7, off, s[32:35], s90
L_var17_end:
    s_mov_b64 exec, -1
    s_barrier
    s_lshl_b32 s69, s75, 7
    s_add_u32 s69, s69, s63
    s_mul_i32 s72, s76, 32
    s_add_u32 s69, s69, s72
    s_add_u32 s69, s69, 0
    v_min_u32 v156, 7, v1
    v_lshlrev_b32 v156, 2, v156
    s_mov_b32 s73, 0
L_poll_349:
    buffer_load_dword v157, v156, s[32:35], s69 offen sc1
    s_waitcnt vmcnt(0)
    v_cmp_le_u32 s[44:45], 2, v157
    s_add_u32 s73, s73, 1
    s_cmp_eq_u64 s[44:45], -1
    s_cbranch_scc1 L_poll_349_ok
    s_cmp_lt_u32 s73, 262144
    s_cbranch_scc1 L_poll_349
L_poll_349_ok:
    s_add_u32 s71, s70, 0x10000
    buffer_load_dwordx4 v[28:31], v2, s[32:35], s71 offen offset:0 sc1
    buffer_load_dwordx4 v[32:35], v2, s[32:35], s71 offen offset:1024 sc1
    buffer_load_dwordx4 v[36:39], v2, s[32:35], s71 offen offset:2048 sc1
    buffer_load_dwordx4 v[40:43], v2, s[32:35], s71 offen offset:3072 sc1
    s_add_u32 s71, s70, 0x11000
    buffer_load_dwordx4 v[44:47], v2, s[32:35], s71 offen offset:0 sc1
    buffer_load_dwordx4 v[48:51], v2, s[32:35], s71 offen offset:1024 sc1
    buffer_load_dwordx4 v[52:55], v2, s[32:35], s71 offen offset:2048 sc1
    buffer_load_dwordx4 v[56:59], v2, s[32:35], s71 offen offset:3072 sc1
    ds_read_b64_tr_b16 v[124:125], v152 offset:0
    ds_read_b64_tr_b16 v[126:127], v152 offset:1024
    ds_read_b64_tr_b16 v[128:129], v153 offset:0
    ds_read_b64_tr_b16 v[130:131], v153 offset:1024
    ds_read_b64_tr_b16 v[132:133], v153 offset:1792
    ds_read_b64_tr_b16 v[134:135], v154 offset:2816
    ds_read_b64_tr_b16 v[136:137], v152 offset:1792
    ds_read_b64_tr_b16 v[138:139], v155 offset:2816
    s_waitcnt vmcnt(7) lgkmcnt(4)
    v_mfma_f32_32x32x16_bf16 v[92:107], v[124:127], v[28:31], 0
    ds_read_b64_tr_b16 v[140:141], v152 offset:3584
    ds_read_b64_tr_b16 v[142:143], v152 offset:4608
    s_add_u32 s71, s70, 0x12000
    buffer_load_dwordx4 v[60:63], v2, s[32:35], s71 offen offset:0 sc1
    v_mfma_f32_32x32x16_bf16 v[108:123], v[128:131], v[28:31], 0
    ds_read_b64_tr_b16 v[144:145], v153 offset:3584
    ds_read_b64_tr_b16 v[146:147], v153 offset:4608
    buffer_load_dwordx4 v[64:67], v2, s[32:35], s71 offen offset:1024 sc1
    s_waitcnt vmcnt(8) lgkmcnt(4)
    v_mfma_f32_32x32x16_bf16 v[92:107], v[132:135], v[32:35], v[92:107]
    ds_read_b64_tr_b16 v[124:125], v153 offset:5376
    ds_read_b64_tr_b16 v[126:127], v154 offset:6400
    buffer_load_dwordx4 v[68:71], v2, s[32:35], s71 offen offset:2048 sc1
    v_mfma_f32_32x32x16_bf16 v[108:123], v[136:139], v[32:35], v[108:123]
    ds_read_b64_tr_b16 v[128:129], v152 offset:5376
    ds_read_b64_tr_b16 v[130:131], v155 offset:6400
    buffer_load_dwordx4 v[72:75], v2, s[32:35], s71 offen offset:3072 sc1
    s_waitcnt vmcnt(9) lgkmcnt(4)
    v_mfma_f32_32x32x16_bf16 v[92:107], v[140:143], v[36:39], v[92:107]
    ds_read_b64_tr_b16 v[132:133], v152 offset:7168
    ds_read_b64_tr_b16 v[134:135], v152 offset:8192
    s_add_u32 s71, s70, 0x13000
    buffer_load_dwordx4 v[76:79], v2, s[32:35], s71 offen offset:0 sc1
    v_mfma_f32_32x32x16_bf16 v[108:123], v[144:147], v[36:39], v[108:123]
    ds_read_b64_tr_b16 v[136:137], v153 offset:7168
    ds_read_b64_tr_b16 v[138:139], v153 offset:8192
    buffer_load_dwordx4 v[80:83], v2, s[32:35], s71 offen offset:1024 sc1
    s_waitcnt vmcnt(10) lgkmcnt(4)
    v_mfma_f32_32x32x16_bf16 v[92:107], v[124:127], v[40:43], v[92:107]
    ds_read_b64_tr_b16 v[140:141], v153 offset:8960
    ds_read_b64_tr_b16 v[142:143], v154 offset:9984
    buffer_load_dwordx4 v[84:87], v2, s[32:35], s71 offen offset:2048 sc1
    v_mfma_f32_32x32x16_bf16 v[108:123], v[128:131], v[40:43], v[108:123]
    ds_read_b64_tr_b16 v[144:145], v152 offset:8960
    ds_read_b64_tr_b16 v[146:147], v155 offset:9984
    buffer_load_dwordx4 v[88:91], v2, s[32:35], s71 offen offset:3072 sc1
    s_waitcnt vmcnt(11) lgkmcnt(4)
    v_mfma_f32_32x32x16_bf16 v[92:107], v[132:135], v[44:47], v[92:107]
    ds_read_b64_tr_b16 v[124:125], v152 offset:10752
    ds_read_b64_tr_b16 v[126:127], v152 offset:11776
    v_mfma_f32_32x32x16_bf16 v[108:123], v[136:139], v[44:47], v[108:123]
    ds_read_b64_tr_b16 v[128:129], v153 offset:10752
    ds_read_b64_tr_b16 v[130:131], v153 offset:11776
    s_waitcnt vmcnt(10) lgkmcnt(4)
    v_mfma_f32_32x32x16_bf16 v[92:107], v[140:143], v[48:51], v[92:107]
    ds_read_b64_tr_b16 v[132:133], v153 offset:12544
    ds_read_b64_tr_b16 v[134:135], v154 offset:13568
    v_mfma_f32_32x32x16_bf16 v[108:123], v[144:147], v[48:51], v[108:123]
    ds_read_b64_tr_b16 v[136:137], v152 offset:12544
    ds_read_b64_tr_b16 v[138:139], v155 offset:13568
    s_waitcnt vmcnt(9) lgkmcnt(4)
    v_mfma_f32_32x32x16_bf16 v[92:107], v[124:127], v[52:55], v[92:107]
    ds_read_b64_tr_b16 v[140:141], v152 offset:14336
    ds_read_b64_tr_b16 v[142:143], v152 offset:15360
    v_mfma_f32_32x32x16_bf16 v[108:123], v[128:131], v[52:55], v[108:123]
    ds_read_b64_tr_b16 v[144:145], v153 offset:14336
    ds_read_b64_tr_b16 v[146:147], v153 offset:15360
    s_waitcnt vmcnt(8) lgkmcnt(4)
    v_mfma_f32_32x32x16_bf16 v[92:107], v[132:135], v[56:59], v[92:107]
    ds_read_b64_tr_b16 v[124:125], v153 offset:16128
    ds_read_b64_tr_b16 v[126:127], v154 offset:17152
    v_mfma_f32_32x32x16_bf16 v[108:123], v[136:139], v[56:59], v[108:123]
    ds_read_b64_tr_b16 v[128:129], v152 offset:16128
    ds_read_b64_tr_b16 v[130:131], v155 offset:17152
    s_waitcnt vmcnt(7) lgkmcnt(4)
    v_mfma_f32_32x32x16_bf16 v[92:107], v[140:143], v[60:63], v[92:107]
    ds_read_b64_tr_b16 v[132:133], v152 offset:17920
    ds_read_b64_tr_b16 v[134:135], v152 offset:18944
    v_mfma_f32_32x32x16_bf16 v[108:123], v[144:147], v[60:63], v[108:123]
    ds_read_b64_tr_b16 v[136:137], v153 offset:17920
    ds_read_b64_tr_b16 v[138:139], v153 offset:18944
    s_waitcnt vmcnt(6) lgkmcnt(4)
    v_mfma_f32_32x32x16_bf16 v[92:107], v[124:127], v[64:67], v[92:107]
    ds_read_b64_tr_b16 v[140:141], v153 offset:19712
    ds_read_b64_tr_b16 v[142:143], v154 offset:20736
    v_mfma_f32_32x32x16_bf16 v[108:123], v[128:131], v[64:67], v[108:123]
    ds_read_b64_tr_b16 v[144:145], v152 offset:19712
    ds_read_b64_tr_b16 v[146:147], v155 offset:20736
    s_waitcnt vmcnt(5) lgkmcnt(4)
    v_mfma_f32_32x32x16_bf16 v[92:107], v[132:135], v[68:71], v[92:107]
    ds_read_b64_tr_b16 v[124:125], v152 offset:21504
    ds_read_b64_tr_b16 v[126:127], v152 offset:22528
    v_mfma_f32_32x32x16_bf16 v[108:123], v[136:139], v[68:71], v[108:123]
    ds_read_b64_tr_b16 v[128:129], v153 offset:21504
    ds_read_b64_tr_b16 v[130:131], v153 offset:22528
    s_waitcnt vmcnt(4) lgkmcnt(4)
    v_mfma_f32_32x32x16_bf16 v[92:107], v[140:143], v[72:75], v[92:107]
    ds_read_b64_tr_b16 v[132:133], v153 offset:23296
    ds_read_b64_tr_b16 v[134:135], v154 offset:24320
    v_mfma_f32_32x32x16_bf16 v[108:123], v[144:147], v[72:75], v[108:123]
    ds_read_b64_tr_b16 v[136:137], v152 offset:23296
    ds_read_b64_tr_b16 v[138:139], v155 offset:24320
    s_waitcnt vmcnt(3) lgkmcnt(4)
    v_mfma_f32_32x32x16_bf16 v[92:107], v[124:127], v[76:79], v[92:107]
    ds_read_b64_tr_b16 v[140:141], v152 offset:25088
    ds_read_b64_tr_b16 v[142:143], v152 offset:26112
    v_mfma_f32_32x32x16_bf16 v[108:123], v[128:131], v[76:79], v[108:123]
    ds_read_b64_tr_b16 v[144:145], v153 offset:25088
    ds_read_b64_tr_b16 v[146:147], v153 offset:26112
    s_barrier
    s_waitcnt vmcnt(2) lgkmcnt(4)
    v_mfma_f32_32x32x16_bf16 v[92:107], v[132:135], v[80:83], v[92:107]
    ds_read_b64_tr_b16 v[124:125], v153 offset:26880
    ds_read_b64_tr_b16 v[126:127], v154 offset:27904
    v_mfma_f32_32x32x16_bf16 v[108:123], v[136:139], v[80:83], v[108:123]
    ds_read_b64_tr_b16 v[128:129], v152 offset:26880
    ds_read_b64_tr_b16 v[130:131], v155 offset:27904
    s_waitcnt vmcnt(1) lgkmcnt(4)
    v_mfma_f32_32x32x16_bf16 v[92:107], v[140:143], v[84:87], v[92:107]
    v_mfma_f32_32x32x16_bf16 v[108:123], v[144:147], v[84:87], v[108:123]
    s_waitcnt vmcnt(0) lgkmcnt(0)
    v_mfma_f32_32x32x16_bf16 v[92:107], v[124:127], v[88:91], v[92:107]
    v_mfma_f32_32x32x16_bf16 v[108:123], v[128:131], v[88:91], v[108:123]
    s_nop 11
    ds_write_b128 v148, v[108:111] offset:0
    ds_write_b128 v148, v[112:115] offset:1024
    ds_write_b128 v148, v[116:119] offset:2048
    ds_write_b128 v148, v[120:123] offset:3072
    v_pk_add_f32 v[8:9], v[8:9], v[92:93]
    v_pk_add_f32 v[10:11], v[10:11], v[94:95]
    v_pk_add_f32 v[12:13], v[12:13], v[96:97]
    v_pk_add_f32 v[14:15], v[14:15], v[98:99]
    v_pk_add_f32 v[16:17], v[16:17], v[100:101]
    v_pk_add_f32 v[18:19], v[18:19], v[102:103]
    v_pk_add_f32 v[20:21], v[20:21], v[104:105]
    v_pk_add_f32 v[22:23], v[22:23], v[106:107]
    s_waitcnt lgkmcnt(0)
    s_barrier
    ds_read_b128 v[108:111], v149 offset:0
    ds_read_b128 v[112:115], v149 offset:1024
    ds_read_b128 v[116:119], v149 offset:2048
    ds_read_b128 v[120:123], v149 offset:3072
    s_waitcnt lgkmcnt(3)
    v_pk_add_f32 v[8:9], v[8:9], v[108:109]
    v_pk_add_f32 v[10:11], v[10:11], v[110:111]
    v_cvt_pk_bf16_f32 v92, v8, v9
    v_cvt_pk_bf16_f32 v93, v10, v11
    v_pk_add_f32 v[100:101], v[8:9], v[10:11]
    v_pk_mul_f32 v[102:103], v[8:9], v[8:9]
    v_pk_fma_f32 v[102:103], v[10:11], v[10:11], v[102:103]
    s_waitcnt lgkmcnt(2)
    v_pk_add_f32 v[12:13], v[12:13], v[112:113]
    v_pk_add_f32 v[14:15], v[14:15], v[114:115]
    v_cvt_pk_bf16_f32 v94, v12, v13
    v_cvt_pk_bf16_f32 v95, v14, v15
    s_cmp_lg_u32 s61, 0
    s_cbranch_scc1 L_var18_wt
    buffer_store_dwordx4 v[92:95], v2, s[32:35], s88 offen offset:0
L_var18_end:
    v_pk_add_f32 v[100:101], v[100:101], v[12:13]
    v_pk_fma_f32 v[102:103], v[12:13], v[12:13], v[102:103]
    v_pk_add_f32 v[100:101], v[100:101], v[14:15]
    v_pk_fma_f32 v[102:103], v[14:15], v[14:15], v[102:103]
    s_waitcnt lgkmcnt(1)
    v_pk_add_f32 v[16:17], v[16:17], v[116:117]
    v_pk_add_f32 v[18:19], v[18:19], v[118:119]
    v_cvt_pk_bf16_f32 v96, v16, v17
    v_cvt_pk_bf16_f32 v97, v18, v19
    v_pk_add_f32 v[100:101], v[100:101], v[16:17]
    v_pk_fma_f32 v[102:103], v[16:17], v[16:17], v[102:103]
    v_pk_add_f32 v[100:101], v[100:101], v[18:19]
    v_pk_fma_f32 v[102:103], v[18:19], v[18:19], v[102:103]
    s_waitcnt lgkmcnt(0)
    v_pk_add_f32 v[20:21], v[20:21], v[120:121]
    v_pk_add_f32 v[22:23], v[22:23], v[122:123]
    v_cvt_pk_bf16_f32 v98, v20, v21
    v_cvt_pk_bf16_f32 v99, v22, v23
    s_cmp_lg_u32 s61, 0
    s_cbranch_scc1 L_var19_wt
    buffer_store_dwordx4 v[96:99], v2, s[32:35], s88 offen offset:1024
L_var19_end:
    v_pk_add_f32 v[100:101], v[100:101], v[20:21]
    v_pk_fma_f32 v[102:103], v[20:21], v[20:21], v[102:103]
    v_pk_add_f32 v[100:101], v[100:101], v[22:23]
    v_pk_fma_f32 v[102:103], v[22:23], v[22:23], v[102:103]
    v_add_f32 v100, v100, v101
    v_add_f32 v101, v102, v103
    v_mov_b32 v102, v100
    v_mov_b32 v103, v101
    v_mov_b32 v7, 3
    v_permlane32_swap_b32 v102, v100
    v_permlane32_swap_b32 v103, v101
    v_pk_add_f32 v[100:101], v[100:101], v[102:103]
    s_cmp_lg_u32 s61, 0
    s_cbranch_scc1 L_var20_wt
    buffer_store_dwordx2 v[100:101], v150, s[32:35], s89 offen
L_var20_end:
L_c_k31:
    v_mov_b32 v222, v2
    v_lshlrev_b32 v223, 3, v1
    v_add_u32 v223, 159744, v223
    s_add_u32 s90, s63, s62
    s_add_u32 s90, s90, 0x30000
    s_lshl_b32 s88, s58, 13
    s_add_u32 s88, s88, s62
    s_add_u32 s88, s88, s63
    s_lshl_b32 s89, s58, 2
    s_add_u32 s89, s89, s56
    s_lshl_b32 s89, s89, 2
    s_add_u32 s89, s89, s63
    s_add_u32 s89, s89, 1024
    s_and_b32 s69, s58, 1
    s_mul_i32 s71, s69, 57344
    s_sub_u32 s94, s90, s71
    s_add_u32 s90, s90, s71
    s_mul_i32 s71, s69, 229376
    s_sub_u32 s92, s88, s71
    s_add_u32 s88, s88, s71
    s_mul_i32 s71, s69, 512
    s_sub_u32 s93, s89, s71
    s_add_u32 s89, s89, s71
    s_lshl_b32 s69, s69, 10
    v_xor_b32 v224, s69, v223
    v_xor_b32 v225, 1024, v224
    s_lshl_b32 s95, s75, 8
    s_add_u32 s95, s95, s63
    s_mul_i32 s72, s76, 112
    s_add_u32 s95, s95, s72
    s_add_u32 s95, s95, 1024
    v_min_u32 v226, 27, v1
    v_lshlrev_b32 v226, 2, v226
    s_lshl_b32 s96, s75, 8
    s_add_u32 s96, s96, s63
    s_mul_i32 s72, s76, 112
    s_add_u32 s96, s96, s72
    s_add_u32 s96, s96, 1024
    v_min_u32 v228, 11, v1
    v_lshlrev_b32 v228, 2, v228
    v_and_b32 v229, 48, v228
    v_add_u32 v228, v228, v229
    s_lshl_b32 s69, s87, 4
    s_add_u32 s96, s96, s69
    s_mul_i32 s97, s75, 114688
    s_mul_i32 s71, s76, 57344
    s_add_u32 s97, s97, s71
    s_add_u32 s97, s97, s63
    s_mul_i32 s71, s87, 49152
    s_sub_u32 s99, s97, s71
    s_lshl_b32 s71, s87, 13
    s_add_u32 s97, s97, s71
    v_and_b32 v230, 15, v1
    v_min_u32 v230, 13, v230
    v_lshrrev_b32 v231, 4, v1
    v_lshlrev_b32 v231, 5, v231
    v_add_lshl_u32 v230, v230, v231, 2
    s_add_u32 s69, s63, 512
    s_waitcnt vmcnt(0)
    v_mov_b32 v7, 3
    s_mov_b64 exec, 1
    s_cmp_lg_u32 s61, 0
    s_cbranch_scc1 L_var21_wt
    buffer_store_dword v7, off, s[32:35], s91
L_var21_end:
    s_mov_b64 exec, -1
    s_lshr_b32 s72, s2, 3
    s_lshl_b32 s72, s72, 2
    s_add_u32 s72, s72, s56
    s_mul_i32 s72, s72, 256
    s_add_u32 s72, s72, L_c_k31+4096-interleave_layers__linear_kernel_hedgehog__glu_gated_geglu__prompt_kernel
    v_lshlrev_b32 v234, 7, v1
    v_add_u32 v234, s72, v234
    v_min_u32 v234, L_codeend-interleave_layers__linear_kernel_hedgehog__glu_gated_geglu__prompt_kernel-4, v234
    s_mov_b64 exec, 3
    global_load_dword a0, v234, s[52:53]
    s_mov_b64 exec, -1
    s_barrier
    s_mov_b32 s73, 0
L_poll_384:
    buffer_load_dword v231, v230, s[32:35], s69 offen sc1
    s_waitcnt vmcnt(0)
    v_cmp_le_u32 s[44:45], 3, v231
    s_add_u32 s73, s73, 1
    s_cmp_eq_u64 s[44:45], -1
    s_cbranch_scc1 L_poll_384_ok
    s_cmp_lt_u32 s73, 262144
    s_cbranch_scc1 L_poll_384
L_poll_384_ok:
    s_add_u32 m0, s62, 0
    s_add_u32 s79, s90, 0
    buffer_load_dwordx4 v2, s[32:35], s79 offen sc1 lds
    s_add_u32 m0, s62, 4096
    s_add_u32 s79, s90, 4096
    buffer_load_dwordx4 v2, s[32:35], s79 offen sc1 lds
    s_add_u32 m0, s62, 8192
    s_add_u32 s79, s90, 8192
    buffer_load_dwordx4 v2, s[32:35], s79 offen sc1 lds
    s_add_u32 m0, s62, 12288
    s_add_u32 s79, s90, 12288
    buffer_load_dwordx4 v2, s[32:35], s79 offen sc1 lds
    s_add_u32 m0, s62, 16384
    s_add_u32 s79, s90, 16384
    buffer_load_dwordx4 v2, s[32:35], s79 offen sc1 lds
    s_add_u32 m0, s62, 20480
    s_add_u32 s79, s90, 20480
    buffer_load_dwordx4 v2, s[32:35], s79 offen sc1 lds
    s_add_u32 m0, s62, 24576
    s_add_u32 s79, s90, 24576
    buffer_load_dwordx4 v2, s[32:35], s79 offen sc1 lds
    s_waitcnt vmcnt(6)
    s_barrier
    ds_read_b128 v[156:159], v222 offset:0
    ds_read_b128 v[160:163], v222 offset:1024
    ds_read_b128 v[164:167], v222 offset:2048
    ds_read_b128 v[168:171], v222 offset:3072
    s_waitcnt lgkmcnt(3)
    v_mfma_f32_32x32x16_bf16 v[28:43], a[24:27], v[156:159], 0
    s_lshl_b32 s69, s56, 12
    s_add_u32 s69, s69, s63
    s_add_u32 s69, s69, 0x9000
    buffer_load_dwordx4 v[180:183], v2, s[32:35], s69 offen offset:0 sc1
    v_mfma_f32_32x32x16_bf16 v[44:59], a[28:31], v[156:159], 0
    buffer_load_dwordx4 v[184:187], v2, s[32:35], s69 offen offset:1024 sc1
    buffer_load_dwordx4 v[188:191], v2, s[32:35], s69 offen offset:2048 sc1
    s_waitcnt lgkmcnt(2)
    v_mfma_f32_32x32x16_bf16 v[28:43], a[32:35], v[160:163], v[28:43]
    buffer_load_dwordx4 v[192:195], v2, s[32:35], s69 offen offset:3072 sc1
    v_mfma_f32_32x32x16_bf16 v[44:59], a[36:39], v[160:163], v[44:59]
    s_waitcnt lgkmcnt(1)
    v_mfma_f32_32x32x16_bf16 v[28:43], a[40:43], v[164:167], v[28:43]
    v_mfma_f32_32x32x16_bf16 v[44:59], a[44:47], v[164:167], v[44:59]
    s_waitcnt lgkmcnt(0)
    v_mfma_f32_32x32x16_bf16 v[28:43], a[48:51], v[168:171], v[28:43]
    v_mfma_f32_32x32x16_bf16 v[44:59], a[52:55], v[168:171], v[44:59]
    s_waitcnt vmcnt(7)
    s_barrier
    ds_read_b128 v[172:175], v222 offset:4096
    ds_read_b128 v[176:179], v222 offset:5120
    ds_read_b128 v[156:159], v222 offset:6144
    ds_read_b128 v[160:163], v222 offset:7168
    s_waitcnt lgkmcnt(3)
    v_mfma_f32_32x32x16_bf16 v[28:43], a[56:59], v[172:175], v[28:43]
    s_add_u32 m0, s62, 28672
    s_add_u32 s79, s90, 28672
    buffer_load_dwordx4 v2, s[32:35], s79 offen sc1 lds
    v_mfma_f32_32x32x16_bf16 v[44:59], a[60:63], v[172:175], v[44:59]
    ds_read_b128 v[164:167], v222 offset:8192
    s_waitcnt lgkmcnt(3)
    v_mfma_f32_32x32x16_bf16 v[28:43], a[64:67], v[176:179], v[28:43]
    s_add_u32 m0, s62, 32768
    s_add_u32 s79, s90, 32768
    buffer_load_dwordx4 v2, s[32:35], s79 offen sc1 lds
    v_mfma_f32_32x32x16_bf16 v[44:59], a[68:71], v[176:179], v[44:59]
    ds_read_b128 v[168:171], v222 offset:9216
    s_waitcnt lgkmcnt(3)
    v_mfma_f32_32x32x16_bf16 v[28:43], a[72:75], v[156:159], v[28:43]
    s_add_u32 m0, s62, 36864
    s_add_u32 s79, s90, 36864
    buffer_load_dwordx4 v2, s[32:35], s79 offen sc1 lds
    v_mfma_f32_32x32x16_bf16 v[44:59], a[76:79], v[156:159], v[44:59]
    ds_read_b128 v[172:175], v222 offset:10240
    s_waitcnt lgkmcnt(3)
    v_mfma_f32_32x32x16_bf16 v[28:43], a[80:83], v[160:163], v[28:43]
    s_add_u32 m0, s62, 40960
    s_add_u32 s79, s90, 40960
    buffer_load_dwordx4 v2, s[32:35], s79 offen sc1 lds
    v_mfma_f32_32x32x16_bf16 v[44:59], a[84:87], v[160:163], v[44:59]
    s_waitcnt vmcnt(8)
    s_barrier
    ds_read_b128 v[176:179], v222 offset:11264
    s_waitcnt lgkmcnt(3)
    v_mfma_f32_32x32x16_bf16 v[28:43], a[88:91], v[164:167], v[28:43]
    s_add_u32 m0, s62, 45056
    s_add_u32 s79, s90, 45056
    buffer_load_dwordx4 v2, s[32:35], s79 offen sc1 lds
    v_mfma_f32_32x32x16_bf16 v[44:59], a[92:95], v[164:167], v[44:59]
    ds_read_b128 v[156:159], v222 offset:12288
    s_waitcnt lgkmcnt(3)
    v_mfma_f32_32x32x16_bf16 v[28:43], a[96:99], v[168:171], v[28:43]
    s_add_u32 m0, s62, 49152
    s_add_u32 s79, s90, 49152
    buffer_load_dwordx4 v2, s[32:35], s79 offen sc1 lds
    s_waitcnt vmcnt(6)
    v_add_f32 v180, v180, v182
    v_mfma_f32_32x32x16_bf16 v[44:59], a[100:103], v[168:171], v[44:59]
    ds_read_b128 v[160:163], v222 offset:13312
    v_add_f32 v181, v181, v183
    v_add_f32 v180, v180, v184
    s_waitcnt lgkmcnt(3)
    v_mfma_f32_32x32x16_bf16 v[28:43], a[104:107], v[172:175], v[28:43]
    s_add_u32 m0, s62, 53248
    s_add_u32 s79, s90, 53248
    buffer_load_dwordx4 v2, s[32:35], s79 offen sc1 lds
    v_add_f32 v181, v181, v185
    v_add_f32 v180, v180, v186
    v_mfma_f32_32x32x16_bf16 v[44:59], a[108:111], v[172:175], v[44:59]
    ds_read_b128 v[164:167], v222 offset:14336
    v_add_f32 v181, v181, v187
    v_add_f32 v180, v180, v188
    s_waitcnt lgkmcnt(3)
    v_mfma_f32_32x32x16_bf16 v[28:43], a[112:115], v[176:179], v[28:43]
    s_add_u32 m0, s62, 57344
    s_add_u32 s79, s94, 57344
    buffer_load_dwordx4 v2, s[32:35], s79 offen sc1 lds
    v_add_f32 v181, v181, v189
    v_add_f32 v180, v180, v190
    v_mfma_f32_32x32x16_bf16 v[44:59], a[116:119], v[176:179], v[44:59]
    ds_read_b128 v[168:171], v222 offset:15360
    v_add_f32 v181, v181, v191
    v_add_f32 v180, v180, v192
    s_waitcnt lgkmcnt(3)
    v_mfma_f32_32x32x16_bf16 v[28:43], a[120:123], v[156:159], v[28:43]
    v_add_f32 v181, v181, v193
    v_mov_b32 v182, v180
    v_mfma_f32_32x32x16_bf16 v[44:59], a[124:127], v[156:159], v[44:59]
    ds_read_b128 v[172:175], v222 offset:16384
    v_mov_b32 v183, v181
    v_permlane32_swap_b32 v182, v180
    s_waitcnt lgkmcnt(3)
    v_mfma_f32_32x32x16_bf16 v[28:43], a[128:131], v[160:163], v[28:43]
    s_add_u32 m0, s62, 61440
    s_add_u32 s79, s94, 61440
    buffer_load_dwordx4 v2, s[32:35], s79 offen sc1 lds
    v_permlane32_swap_b32 v183, v181
    v_add_f32 v180, v182, v180
    v_mfma_f32_32x32x16_bf16 v[44:59], a[132:135], v[160:163], v[44:59]
    ds_read_b128 v[176:179], v222 offset:17408
    v_add_f32 v181, v183, v181
    v_mul_f32 v180, 0x3b124925, v180
    s_waitcnt lgkmcnt(3)
    v_mfma_f32_32x32x16_bf16 v[28:43], a[136:139], v[164:167], v[28:43]
    v_mul_f32 v181, 0x3b124925, v181
    v_cvt_pk_bf16_f32 v24, -v180, -v180
    v_mfma_f32_32x32x16_bf16 v[44:59], a[140:143], v[164:167], v[44:59]
    ds_read_b128 v[156:159], v222 offset:18432
    v_fma_f32 v181, -v180, v180, v181
    v_max_f32 v181, 0, v181
    s_waitcnt lgkmcnt(3)
    v_mfma_f32_32x32x16_bf16 v[28:43], a[144:147], v[168:171], v[28:43]
    s_add_u32 m0, s62, 65536
    s_add_u32 s79, s94, 65536
    buffer_load_dwordx4 v2, s[32:35], s79 offen sc1 lds
    v_cvt_pk_bf16_f32 v181, v181, v181
    v_lshlrev_b32 v181, 16, v181
    v_mfma_f32_32x32x16_bf16 v[44:59], a[148:151], v[168:171], v[44:59]
    ds_read_b128 v[160:163], v222 offset:19456
    v_add_f32 v181, 0x3727c5ac, v181
    v_cvt_pk_bf16_f32 v181, v181, v181
    s_waitcnt lgkmcnt(3)
    v_mfma_f32_32x32x16_bf16 v[28:43], a[152:155], v[172:175], v[28:43]
    v_lshlrev_b32 v181, 16, v181
    v_sqrt_f32 v181, v181
    v_mfma_f32_32x32x16_bf16 v[44:59], a[156:159], v[172:175], v[44:59]
    ds_read_b128 v[164:167], v222 offset:20480
    v_cvt_pk_bf16_f32 v181, v181, v181
    v_lshlrev_b32 v181, 16, v181
    s_waitcnt lgkmcnt(3)
    v_mfma_f32_32x32x16_bf16 v[28:43], a[160:163], v[176:179], v[28:43]
    s_add_u32 m0, s62, 69632
    s_add_u32 s79, s94, 69632
    buffer_load_dwordx4 v2, s[32:35], s79 offen sc1 lds
    v_rcp_f32 v196, v181
    v_mfma_f32_32x32x16_bf16 v[44:59], a[164:167], v[176:179], v[44:59]
    ds_read_b128 v[168:171], v222 offset:21504
    v_mov_b32 v180, v24
    v_lshlrev_b32 v182, 9, s56
    v_add_u32 v182, v182, v223
    s_waitcnt lgkmcnt(3)
    v_mfma_f32_32x32x16_bf16 v[28:43], a[168:171], v[156:159], v[28:43]
    ds_write_b64 v182, v[180:181]
    v_mfma_f32_32x32x16_bf16 v[44:59], a[172:175], v[156:159], v[44:59]
    ds_read_b128 v[172:175], v222 offset:22528
    s_waitcnt lgkmcnt(4)
    v_mfma_f32_32x32x16_bf16 v[28:43], a[176:179], v[160:163], v[28:43]
    s_add_u32 m0, s62, 73728
    s_add_u32 s79, s94, 73728
    buffer_load_dwordx4 v2, s[32:35], s79 offen sc1 lds
    v_mfma_f32_32x32x16_bf16 v[44:59], a[180:183], v[160:163], v[44:59]
    ds_read_b128 v[176:179], v222 offset:23552
    s_waitcnt lgkmcnt(4)
    v_mfma_f32_32x32x16_bf16 v[28:43], a[184:187], v[164:167], v[28:43]
    v_mfma_f32_32x32x16_bf16 v[44:59], a[188:191], v[164:167], v[44:59]
    ds_read_b128 v[156:159], v222 offset:24576
    s_waitcnt lgkmcnt(4)
    v_mfma_f32_32x32x16_bf16 v[28:43], a[192:195], v[168:171], v[28:43]
    s_add_u32 m0, s62, 77824
    s_add_u32 s79, s94, 77824
    buffer_load_dwordx4 v2, s[32:35], s79 offen sc1 lds
    v_mfma_f32_32x32x16_bf16 v[44:59], a[196:199], v[168:171], v[44:59]
    ds_read_b128 v[160:163], v222 offset:25600
    s_waitcnt lgkmcnt(3)
    v_mfma_f32_32x32x16_bf16 v[28:43], a[200:203], v[172:175], v[28:43]
    v_mfma_f32_32x32x16_bf16 v[44:59], a[204:207], v[172:175], v[44:59]
    ds_read_b128 v[164:167], v222 offset:26624
    s_waitcnt lgkmcnt(3)
    v_mfma_f32_32x32x16_bf16 v[28:43], a[208:211], v[176:179], v[28:43]
    s_add_u32 m0, s62, 81920
    s_add_u32 s79, s94, 81920
    buffer_load_dwordx4 v2, s[32:35], s79 offen sc1 lds
    v_mfma_f32_32x32x16_bf16 v[44:59], a[212:215], v[176:179], v[44:59]
    s_waitcnt vmcnt(7)
    s_barrier
    ds_read_b128 v[168:171], v222 offset:27648
    s_waitcnt lgkmcnt(3)
    v_mfma_f32_32x32x16_bf16 v[28:43], a[216:219], v[156:159], v[28:43]
    ds_read_b64 v[206:207], v224 offset:0
    ds_read_b64 v[208:209], v224 offset:512
    ds_read_b64 v[210:211], v225 offset:0
    ds_read_b64 v[212:213], v225 offset:512
    s_waitcnt lgkmcnt(0)
    v_mfma_f32_32x32x16_bf16 v[44:59], a[220:223], v[156:159], v[44:59]
    ds_read_b128 v[172:175], v222 offset:28672
    v_rcp_f32 v199, v207
    v_mul_f32 v207, v207, v207
    v_mul_f32 v198, 0xc0135761, v199
    v_mfma_f32_32x32x16_bf16 v[28:43], a[224:227], v[160:163], v[28:43]
    s_add_u32 m0, s62, 86016
    s_add_u32 s79, s94, 86016
    buffer_load_dwordx4 v2, s[32:35], s79 offen sc1 lds
    v_mul_f32 v199, v199, v199
    v_mul_f32 v199, v198, v199
    v_mfma_f32_32x32x16_bf16 v[44:59], a[228:231], v[160:163], v[44:59]
    ds_read_b128 v[176:179], v222 offset:29696
    v_mul_f32 v199, 0x3d372713, v199
    v_rcp_f32 v201, v209
    v_mul_f32 v209, v209, v209
    v_mfma_f32_32x32x16_bf16 v[28:43], a[232:235], v[164:167], v[28:43]
    v_mul_f32 v200, 0xc0135761, v201
    v_mul_f32 v201, v201, v201
    v_mul_f32 v201, v200, v201
    v_mul_f32 v201, 0x3d372713, v201
    v_rcp_f32 v203, v211
    v_mfma_f32_32x32x16_bf16 v[44:59], a[236:239], v[164:167], v[44:59]
    ds_read_b128 v[156:159], v222 offset:30720
    v_mul_f32 v211, v211, v211
    v_mul_f32 v202, 0xc0135761, v203
    v_mul_f32 v203, v203, v203
    v_mul_f32 v203, v202, v203
    v_mfma_f32_32x32x16_bf16 v[28:43], a[240:243], v[168:171], v[28:43]
    s_add_u32 m0, s62, 90112
    s_add_u32 s79, s94, 90112
    buffer_load_dwordx4 v2, s[32:35], s79 offen sc1 lds
    v_mul_f32 v203, 0x3d372713, v203
    v_mfma_f32_32x32x16_bf16 v[44:59], a[244:247], v[168:171], v[44:59]
    s_barrier
    v_mov_b32 v24, v206
    v_rcp_f32 v205, v213
    v_mul_f32 v213, v213, v213
    v_mfma_f32_32x32x16_bf16 v[28:43], a[18:21], v[24:27], v[28:43]
    v_mul_f32 v204, 0xc0135761, v205
    v_mul_f32 v205, v205, v205
    v_mul_f32 v205, v204, v205
    v_mul_f32 v205, 0x3d372713, v205
    v_mfma_f32_32x32x16_bf16 v[44:59], a[20:23], v[24:27], v[44:59]
    ds_read_b128 v[160:163], v222 offset:31744
    s_waitcnt lgkmcnt(3)
    v_mfma_f32_32x32x16_bf16 v[60:75], a[24:27], v[172:175], 0
    s_add_u32 m0, s62, 94208
    s_add_u32 s79, s94, 94208
    buffer_load_dwordx4 v2, s[32:35], s79 offen sc1 lds
    s_nop 0
    v_mul_f32 v180, v28, v28
    v_mul_f32 v181, v29, v29
    v_mfma_f32_32x32x16_bf16 v[76:91], a[28:31], v[172:175], 0
    ds_read_b128 v[164:167], v222 offset:32768
    v_mul_f32 v182, v30, v30
    v_mul_f32 v183, v31, v31
    v_fma_f32 v180, v180, v199, v198
    v_fma_f32 v181, v181, v199, v198
    s_waitcnt lgkmcnt(3)
    v_mfma_f32_32x32x16_bf16 v[60:75], a[32:35], v[176:179], v[60:75]
    v_fma_f32 v182, v182, v199, v198
    v_fma_f32 v183, v183, v199, v198
    v_mul_f32 v180, v180, v28
    v_mul_f32 v181, v181, v29
    v_mul_f32 v182, v182, v30
    v_mul_f32 v183, v183, v31
    v_mfma_f32_32x32x16_bf16 v[76:91], a[36:39], v[176:179], v[76:91]
    ds_read_b128 v[168:171], v222 offset:33792
    v_exp_f32 v180, v180
    v_exp_f32 v181, v181
    s_waitcnt lgkmcnt(3)
    v_mfma_f32_32x32x16_bf16 v[60:75], a[40:43], v[156:159], v[60:75]
    s_add_u32 m0, s62, 98304
    s_add_u32 s79, s94, 98304
    buffer_load_dwordx4 v2, s[32:35], s79 offen sc1 lds
    v_exp_f32 v182, v182
    v_mfma_f32_32x32x16_bf16 v[76:91], a[44:47], v[156:159], v[76:91]
    ds_read_b128 v[172:175], v222 offset:34816
    v_exp_f32 v183, v183
    v_mul_f32 v28, v28, v36
    v_mul_f32 v29, v29, v37
    s_waitcnt lgkmcnt(3)
    v_mfma_f32_32x32x16_bf16 v[60:75], a[48:51], v[160:163], v[60:75]
    v_mul_f32 v30, v30, v38
    v_mul_f32 v31, v31, v39
    v_fma_f32 v180, v180, v207, v207
    v_fma_f32 v181, v181, v207, v207
    v_fma_f32 v182, v182, v207, v207
    v_fma_f32 v183, v183, v207, v207
    v_mfma_f32_32x32x16_bf16 v[76:91], a[52:55], v[160:163], v[76:91]
    ds_read_b128 v[176:179], v222 offset:35840
    v_rcp_f32 v180, v180
    v_rcp_f32 v181, v181
    s_waitcnt lgkmcnt(3)
    v_mfma_f32_32x32x16_bf16 v[60:75], a[56:59], v[164:167], v[60:75]
    s_add_u32 m0, s62, 102400
    s_add_u32 s79, s94, 102400
    buffer_load_dwordx4 v2, s[32:35], s79 offen sc1 lds
    v_rcp_f32 v182, v182
    v_mfma_f32_32x32x16_bf16 v[76:91], a[60:63], v[164:167], v[76:91]
    ds_read_b128 v[156:159], v222 offset:36864
    v_rcp_f32 v183, v183
    v_mul_f32 v28, v28, v180
    v_mul_f32 v29, v29, v181
    s_waitcnt lgkmcnt(3)
    v_mfma_f32_32x32x16_bf16 v[60:75], a[64:67], v[168:171], v[60:75]
    v_mul_f32 v30, v30, v182
    v_mul_f32 v31, v31, v183
    v_cvt_pk_bf16_f32 v214, v28, v29
    v_cvt_pk_bf16_f32 v215, v30, v31
    v_mul_f32 v180, v32, v32
    v_mul_f32 v181, v33, v33
    v_mfma_f32_32x32x16_bf16 v[76:91], a[68:71], v[168:171], v[76:91]
    ds_read_b128 v[160:163], v222 offset:37888
    v_mul_f32 v182, v34, v34
    v_mul_f32 v183, v35, v35
    v_fma_f32 v180, v180, v199, v198
    v_fma_f32 v181, v181, v199, v198
    s_waitcnt lgkmcnt(3)
    v_mfma_f32_32x32x16_bf16 v[60:75], a[72:75], v[172:175], v[60:75]
    s_add_u32 m0, s62, 106496
    s_add_u32 s79, s94, 106496
    buffer_load_dwordx4 v2, s[32:35], s79 offen sc1 lds
    v_fma_f32 v182, v182, v199, v198
    v_fma_f32 v183, v183, v199, v198
    v_mfma_f32_32x32x16_bf16 v[76:91], a[76:79], v[172:175], v[76:91]
    ds_read_b128 v[164:167], v222 offset:38912
    v_mul_f32 v180, v180, v32
    v_mul_f32 v181, v181, v33
    v_mul_f32 v182, v182, v34
    v_mul_f32 v183, v183, v35
    s_waitcnt lgkmcnt(3)
    v_mfma_f32_32x32x16_bf16 v[60:75], a[80:83], v[176:179], v[60:75]
    v_exp_f32 v180, v180
    v_exp_f32 v181, v181
    v_exp_f32 v182, v182
    v_mfma_f32_32x32x16_bf16 v[76:91], a[84:87], v[176:179], v[76:91]
    ds_read_b128 v[168:171], v222 offset:39936
    v_exp_f32 v183, v183
    v_mul_f32 v32, v32, v40
    v_mul_f32 v33, v33, v41
    s_waitcnt lgkmcnt(3)
    v_mfma_f32_32x32x16_bf16 v[60:75], a[88:91], v[156:159], v[60:75]
    s_add_u32 m0, s62, 110592
    s_add_u32 s79, s94, 110592
    buffer_load_dwordx4 v2, s[32:35], s79 offen sc1 lds
    v_mul_f32 v34, v34, v42
    v_mul_f32 v35, v35, v43
    v_mfma_f32_32x32x16_bf16 v[76:91], a[92:95], v[156:159], v[76:91]
    ds_read_b128 v[172:175], v222 offset:40960
    v_fma_f32 v180, v180, v207, v207
    v_fma_f32 v181, v181, v207, v207
    v_fma_f32 v182, v182, v207, v207
    v_fma_f32 v183, v183, v207, v207
    s_waitcnt lgkmcnt(3)
    v_mfma_f32_32x32x16_bf16 v[60:75], a[96:99], v[160:163], v[60:75]
    v_rcp_f32 v180, v180
    v_rcp_f32 v181, v181
    v_rcp_f32 v182, v182
    v_mfma_f32_32x32x16_bf16 v[76:91], a[100:103], v[160:163], v[76:91]
    ds_read_b128 v[176:179], v222 offset:41984
    v_rcp_f32 v183, v183
    v_mul_f32 v32, v32, v180
    v_mul_f32 v33, v33, v181
    s_waitcnt lgkmcnt(3)
    v_mfma_f32_32x32x16_bf16 v[60:75], a[104:107], v[164:167], v[60:75]
    s_add_u32 m0, s62, 114688
    s_add_u32 s79, s68, 0
    buffer_load_dwordx4 v3, s[24:27], s79 offen lds
    v_mul_f32 v34, v34, v182
    v_mul_f32 v35, v35, v183
    v_mfma_f32_32x32x16_bf16 v[76:91], a[108:111], v[164:167], v[76:91]
    ds_read_b128 v[156:159], v222 offset:43008
    v_cvt_pk_bf16_f32 v216, v32, v33
    v_cvt_pk_bf16_f32 v217, v34, v35
    s_waitcnt lgkmcnt(3)
    v_mfma_f32_32x32x16_bf16 v[60:75], a[112:115], v[168:171], v[60:75]
    s_add_u32 s71, s88, 0x70000
    s_cmp_lg_u32 s61, 0
    s_cbranch_scc1 L_var22_wt
    buffer_store_dwordx4 v[214:217], v2, s[32:35], s71 offen
L_var22_end:
    v_mul_f32 v180, v44, v44
    v_mfma_f32_32x32x16_bf16 v[76:91], a[116:119], v[168:171], v[76:91]
    ds_read_b128 v[160:163], v222 offset:44032
    s_add_u32 m0, s62, 118784
    s_add_u32 s79, s68, 14336
    buffer_load_dwordx4 v3, s[24:27], s79 offen lds
    s_waitcnt lgkmcnt(3)
    v_mfma_f32_32x32x16_bf16 v[60:75], a[120:123], v[172:175], v[60:75]
    v_mul_f32 v181, v45, v45
    v_mul_f32 v182, v46, v46
    v_mul_f32 v183, v47, v47
    v_fma_f32 v180, v180, v199, v198
    v_fma_f32 v181, v181, v199, v198
    v_fma_f32 v182, v182, v199, v198
    v_mfma_f32_32x32x16_bf16 v[76:91], a[124:127], v[172:175], v[76:91]
    ds_read_b128 v[164:167], v222 offset:45056
    v_fma_f32 v183, v183, v199, v198
    v_mul_f32 v180, v180, v44
    v_mul_f32 v181, v181, v45
    v_mul_f32 v182, v182, v46
    s_waitcnt lgkmcnt(3)
    v_mfma_f32_32x32x16_bf16 v[60:75], a[128:131], v[176:179], v[60:75]
    s_add_u32 m0, s62, 122880
    s_add_u32 s79, s68, 28672
    buffer_load_dwordx4 v3, s[24:27], s79 offen lds
    v_mul_f32 v183, v183, v47
    v_mfma_f32_32x32x16_bf16 v[76:91], a[132:135], v[176:179], v[76:91]
    ds_read_b128 v[168:171], v222 offset:46080
    v_exp_f32 v180, v180
    v_exp_f32 v181, v181
    s_waitcnt lgkmcnt(3)
    v_mfma_f32_32x32x16_bf16 v[60:75], a[136:139], v[156:159], v[60:75]
    v_exp_f32 v182, v182
    v_exp_f32 v183, v183
    v_mul_f32 v44, v44, v52
    v_mul_f32 v45, v45, v53
    v_mfma_f32_32x32x16_bf16 v[76:91], a[140:143], v[156:159], v[76:91]
    ds_read_b128 v[172:175], v222 offset:47104
    s_add_u32 m0, s62, 126976
    s_add_u32 s79, s68, 43008
    buffer_load_dwordx4 v3, s[24:27], s79 offen lds
    s_waitcnt lgkmcnt(3)
    v_mfma_f32_32x32x16_bf16 v[60:75], a[144:147], v[160:163], v[60:75]
    v_mul_f32 v46, v46, v54
    v_mul_f32 v47, v47, v55
    v_fma_f32 v180, v180, v207, v207
    v_fma_f32 v181, v181, v207, v207
    v_fma_f32 v182, v182, v207, v207
    v_fma_f32 v183, v183, v207, v207
    v_mfma_f32_32x32x16_bf16 v[76:91], a[148:151], v[160:163], v[76:91]
    ds_read_b128 v[176:179], v222 offset:48128
    v_rcp_f32 v180, v180
    v_rcp_f32 v181, v181
    s_waitcnt lgkmcnt(3)
    v_mfma_f32_32x32x16_bf16 v[60:75], a[152:155], v[164:167], v[60:75]
    s_add_u32 m0, s62, 131072
    s_add_u32 s79, s68, 57344
    buffer_load_dwordx4 v3, s[24:27], s79 offen lds
    v_rcp_f32 v182, v182
    v_mfma_f32_32x32x16_bf16 v[76:91], a[156:159], v[164:167], v[76:91]
    ds_read_b128 v[156:159], v222 offset:49152
    v_rcp_f32 v183, v183
    v_mul_f32 v44, v44, v180
    v_mul_f32 v45, v45, v181
    s_waitcnt lgkmcnt(3)
    v_mfma_f32_32x32x16_bf16 v[60:75], a[160:163], v[168:171], v[60:75]
    v_mul_f32 v46, v46, v182
    v_mul_f32 v47, v47, v183
    v_cvt_pk_bf16_f32 v218, v44, v45
    v_cvt_pk_bf16_f32 v219, v46, v47
    v_mul_f32 v180, v48, v48
    v_mul_f32 v181, v49, v49
    v_mfma_f32_32x32x16_bf16 v[76:91], a[164:167], v[168:171], v[76:91]
    s_waitcnt vmcnt(13)
    s_barrier
    ds_read_b128 v[160:163], v222 offset:50176
    v_mul_f32 v182, v50, v50
    v_mul_f32 v183, v51, v51
    s_waitcnt lgkmcnt(3)
    v_mfma_f32_32x32x16_bf16 v[60:75], a[168:171], v[172:175], v[60:75]
    s_add_u32 m0, s62, 135168
    s_add_u32 s79, s68, 71680
    buffer_load_dwordx4 v3, s[24:27], s79 offen lds
    v_fma_f32 v180, v180, v199, v198
    v_fma_f32 v181, v181, v199, v198
    v_mfma_f32_32x32x16_bf16 v[76:91], a[172:175], v[172:175], v[76:91]
    ds_read_b128 v[164:167], v222 offset:51200
    v_fma_f32 v182, v182, v199, v198
    v_fma_f32 v183, v183, v199, v198
    v_mul_f32 v180, v180, v48
    v_mul_f32 v181, v181, v49
    s_waitcnt lgkmcnt(3)
    v_mfma_f32_32x32x16_bf16 v[60:75], a[176:179], v[176:179], v[60:75]
    s_add_u32 m0, s62, 139264
    s_add_u32 s79, s68, 86016
    buffer_load_dwordx4 v3, s[24:27], s79 offen lds
    v_mul_f32 v182, v182, v50
    v_mul_f32 v183, v183, v51
    v_mfma_f32_32x32x16_bf16 v[76:91], a[180:183], v[176:179], v[76:91]
    ds_read_b128 v[168:171], v222 offset:52224
    v_exp_f32 v180, v180
    v_exp_f32 v181, v181
    s_waitcnt lgkmcnt(3)
    v_mfma_f32_32x32x16_bf16 v[60:75], a[184:187], v[156:159], v[60:75]
    v_exp_f32 v182, v182
    v_exp_f32 v183, v183
    v_mul_f32 v48, v48, v56
    v_mul_f32 v49, v49, v57
    v_mfma_f32_32x32x16_bf16 v[76:91], a[188:191], v[156:159], v[76:91]
    ds_read_b128 v[172:175], v222 offset:53248
    s_add_u32 m0, s62, 143360
    s_add_u32 s79, s68, 100352
    buffer_load_dwordx4 v3, s[24:27], s79 offen lds
    s_waitcnt lgkmcnt(3)
    v_mfma_f32_32x32x16_bf16 v[60:75], a[192:195], v[160:163], v[60:75]
    v_mul_f32 v50, v50, v58
    v_mul_f32 v51, v51, v59
    v_fma_f32 v180, v180, v207, v207
    v_fma_f32 v181, v181, v207, v207
    v_fma_f32 v182, v182, v207, v207
    v_fma_f32 v183, v183, v207, v207
    v_mfma_f32_32x32x16_bf16 v[76:91], a[196:199], v[160:163], v[76:91]
    ds_read_b128 v[176:179], v222 offset:54272
    v_rcp_f32 v180, v180
    v_rcp_f32 v181, v181
    s_waitcnt lgkmcnt(3)
    v_mfma_f32_32x32x16_bf16 v[60:75], a[200:203], v[164:167], v[60:75]
    s_add_u32 m0, s62, 147456
    s_add_u32 s79, s68, 229376
    buffer_load_dwordx4 v3, s[24:27], s79 offen lds
    v_rcp_f32 v182, v182
    v_mfma_f32_32x32x16_bf16 v[76:91], a[204:207], v[164:167], v[76:91]
    ds_read_b128 v[156:159], v222 offset:55296
    v_rcp_f32 v183, v183
    v_mul_f32 v48, v48, v180
    v_mul_f32 v49, v49, v181
    s_waitcnt lgkmcnt(3)
    v_mfma_f32_32x32x16_bf16 v[60:75], a[208:211], v[168:171], v[60:75]
    v_mul_f32 v50, v50, v182
    v_mul_f32 v51, v51, v183
    v_cvt_pk_bf16_f32 v220, v48, v49
    v_cvt_pk_bf16_f32 v221, v50, v51
    v_mfma_f32_32x32x16_bf16 v[76:91], a[212:215], v[168:171], v[76:91]
    ds_read_b128 v[160:163], v222 offset:56320
    s_add_u32 m0, s62, 151552
    s_add_u32 s79, s68, 243712
    buffer_load_dwordx4 v3, s[24:27], s79 offen lds
    s_waitcnt lgkmcnt(3)
    v_mfma_f32_32x32x16_bf16 v[60:75], a[216:219], v[172:175], v[60:75]
    s_add_u32 s71, s88, 0x71000
    s_cmp_lg_u32 s61, 0
    s_cbranch_scc1 L_var23_wt
    buffer_store_dwordx4 v[218:221], v2, s[32:35], s71 offen
L_var23_end:
    v_mfma_f32_32x32x16_bf16 v[76:91], a[220:223], v[172:175], v[76:91]
    ds_read_b128 v[164:167], v222 offset:57344
    s_waitcnt lgkmcnt(3)
    v_mfma_f32_32x32x16_bf16 v[60:75], a[224:227], v[176:179], v[60:75]
    s_add_u32 m0, s62, 155648
    s_add_u32 s79, s68, 258048
    buffer_load_dwordx4 v3, s[24:27], s79 offen lds
    v_mfma_f32_32x32x16_bf16 v[76:91], a[228:231], v[176:179], v[76:91]
    ds_read_b128 v[168:171], v222 offset:58368
    s_waitcnt lgkmcnt(3)
    v_mfma_f32_32x32x16_bf16 v[60:75], a[232:235], v[156:159], v[60:75]
    v_mfma_f32_32x32x16_bf16 v[76:91], a[236:239], v[156:159], v[76:91]
    ds_read_b128 v[172:175], v222 offset:59392
    s_add_u32 m0, s62, 0
    s_add_u32 s79, s68, 272384
    buffer_load_dwordx4 v3, s[24:27], s79 offen lds
    s_waitcnt lgkmcnt(3)
    v_mfma_f32_32x32x16_bf16 v[60:75], a[240:243], v[160:163], v[60:75]
    v_mfma_f32_32x32x16_bf16 v[76:91], a[244:247], v[160:163], v[76:91]
    s_barrier
    v_mov_b32 v24, v208
    s_nop 1
    v_mfma_f32_32x32x16_bf16 v[60:75], a[18:21], v[24:27], v[60:75]
    v_mfma_f32_32x32x16_bf16 v[76:91], a[20:23], v[24:27], v[76:91]
    ds_read_b128 v[176:179], v222 offset:60416
    s_waitcnt lgkmcnt(3)
    v_mfma_f32_32x32x16_bf16 v[92:107], a[24:27], v[164:167], 0
    s_add_u32 m0, s62, 4096
    s_add_u32 s79, s68, 286720
    buffer_load_dwordx4 v3, s[24:27], s79 offen lds
    s_nop 4
    v_mul_f32 v180, v60, v60
    v_mul_f32 v181, v61, v61
    v_mfma_f32_32x32x16_bf16 v[108:123], a[28:31], v[164:167], 0
    ds_read_b128 v[156:159], v222 offset:61440
    v_mul_f32 v182, v62, v62
    v_mul_f32 v183, v63, v63
    v_fma_f32 v180, v180, v201, v200
    v_fma_f32 v181, v181, v201, v200
    s_waitcnt lgkmcnt(3)
    v_mfma_f32_32x32x16_bf16 v[92:107], a[32:35], v[168:171], v[92:107]
    v_fma_f32 v182, v182, v201, v200
    v_fma_f32 v183, v183, v201, v200
    v_mul_f32 v180, v180, v60
    v_mul_f32 v181, v181, v61
    v_mul_f32 v182, v182, v62
    v_mul_f32 v183, v183, v63
    v_mfma_f32_32x32x16_bf16 v[108:123], a[36:39], v[168:171], v[108:123]
    ds_read_b128 v[160:163], v222 offset:62464
    s_add_u32 m0, s62, 8192
    s_add_u32 s79, s68, 301056
    buffer_load_dwordx4 v3, s[24:27], s79 offen lds
    s_waitcnt lgkmcnt(3)
    v_mfma_f32_32x32x16_bf16 v[92:107], a[40:43], v[172:175], v[92:107]
    v_exp_f32 v180, v180
    v_exp_f32 v181, v181
    v_exp_f32 v182, v182
    v_mfma_f32_32x32x16_bf16 v[108:123], a[44:47], v[172:175], v[108:123]
    ds_read_b128 v[164:167], v222 offset:63488
    v_exp_f32 v183, v183
    v_mul_f32 v60, v60, v68
    v_mul_f32 v61, v61, v69
    s_waitcnt lgkmcnt(3)
    v_mfma_f32_32x32x16_bf16 v[92:107], a[48:51], v[176:179], v[92:107]
    s_add_u32 m0, s62, 12288
    s_add_u32 s79, s68, 315392
    buffer_load_dwordx4 v3, s[24:27], s79 offen lds
    v_mul_f32 v62, v62, v70
    v_mul_f32 v63, v63, v71
    v_mfma_f32_32x32x16_bf16 v[108:123], a[52:55], v[176:179], v[108:123]
    ds_read_b128 v[168:171], v222 offset:64512
    v_fma_f32 v180, v180, v209, v209
    v_fma_f32 v181, v181, v209, v209
    v_fma_f32 v182, v182, v209, v209
    v_fma_f32 v183, v183, v209, v209
    s_waitcnt lgkmcnt(3)
    v_mfma_f32_32x32x16_bf16 v[92:107], a[56:59], v[156:159], v[92:107]
    v_rcp_f32 v180, v180
    v_rcp_f32 v181, v181
    v_rcp_f32 v182, v182
    v_mfma_f32_32x32x16_bf16 v[108:123], a[60:63], v[156:159], v[108:123]
    v_add_u32 v222, 65536, v222
    ds_read_b128 v[172:175], v222 offset:0
    s_add_u32 m0, s62, 16384
    s_add_u32 s79, s68, 329728
    buffer_load_dwordx4 v3, s[24:27], s79 offen lds
    s_waitcnt lgkmcnt(3)
    v_mfma_f32_32x32x16_bf16 v[92:107], a[64:67], v[160:163], v[92:107]
    v_rcp_f32 v183, v183
    v_mul_f32 v60, v60, v180
    v_mul_f32 v61, v61, v181
    v_mul_f32 v62, v62, v182
    v_mul_f32 v63, v63, v183
    v_mfma_f32_32x32x16_bf16 v[108:123], a[68:71], v[160:163], v[108:123]
    ds_read_b128 v[176:179], v222 offset:1024
    v_cvt_pk_bf16_f32 v214, v60, v61
    v_cvt_pk_bf16_f32 v215, v62, v63
    v_mul_f32 v180, v64, v64
    v_mul_f32 v181, v65, v65
    s_waitcnt lgkmcnt(3)
    v_mfma_f32_32x32x16_bf16 v[92:107], a[72:75], v[164:167], v[92:107]
    s_add_u32 m0, s62, 20480
    s_add_u32 s79, s68, 458752
    buffer_load_dwordx4 v3, s[24:27], s79 offen lds
    v_mul_f32 v182, v66, v66
    v_mul_f32 v183, v67, v67
    v_mfma_f32_32x32x16_bf16 v[108:123], a[76:79], v[164:167], v[108:123]
    ds_read_b128 v[156:159], v222 offset:2048
    v_fma_f32 v180, v180, v201, v200
    v_fma_f32 v181, v181, v201, v200
    v_fma_f32 v182, v182, v201, v200
    v_fma_f32 v183, v183, v201, v200
    s_waitcnt lgkmcnt(3)
    v_mfma_f32_32x32x16_bf16 v[92:107], a[80:83], v[168:171], v[92:107]
    v_mul_f32 v180, v180, v64
    v_mul_f32 v181, v181, v65
    v_mul_f32 v182, v182, v66
    v_mul_f32 v183, v183, v67
    v_exp_f32 v180, v180
    v_mfma_f32_32x32x16_bf16 v[108:123], a[84:87], v[168:171], v[108:123]
    ds_read_b128 v[160:163], v222 offset:3072
    s_add_u32 m0, s62, 24576
    s_add_u32 s79, s68, 473088
    buffer_load_dwordx4 v3, s[24:27], s79 offen lds
    s_waitcnt lgkmcnt(3)
    v_mfma_f32_32x32x16_bf16 v[92:107], a[88:91], v[172:175], v[92:107]
    v_exp_f32 v181, v181
    v_exp_f32 v182, v182
    v_exp_f32 v183, v183
    v_mfma_f32_32x32x16_bf16 v[108:123], a[92:95], v[172:175], v[108:123]
    ds_read_b128 v[164:167], v222 offset:4096
    v_mul_f32 v64, v64, v72
    v_mul_f32 v65, v65, v73
    v_mul_f32 v66, v66, v74
    v_mul_f32 v67, v67, v75
    s_waitcnt lgkmcnt(3)
    v_mfma_f32_32x32x16_bf16 v[92:107], a[96:99], v[176:179], v[92:107]
    s_add_u32 m0, s62, 28672
    s_add_u32 s79, s68, 487424
    buffer_load_dwordx4 v3, s[24:27], s79 offen lds
    v_fma_f32 v180, v180, v209, v209
    v_fma_f32 v181, v181, v209, v209
    v_mfma_f32_32x32x16_bf16 v[108:123], a[100:103], v[176:179], v[108:123]
    ds_read_b128 v[168:171], v222 offset:5120
    v_fma_f32 v182, v182, v209, v209
    v_fma_f32 v183, v183, v209, v209
    v_rcp_f32 v180, v180
    s_waitcnt lgkmcnt(3)
    v_mfma_f32_32x32x16_bf16 v[92:107], a[104:107], v[156:159], v[92:107]
    v_rcp_f32 v181, v181
    v_rcp_f32 v182, v182
    v_rcp_f32 v183, v183
    v_mfma_f32_32x32x16_bf16 v[108:123], a[108:111], v[156:159], v[108:123]
    ds_read_b128 v[172:175], v222 offset:6144
    s_add_u32 m0, s62, 32768
    s_add_u32 s79, s68, 501760
    buffer_load_dwordx4 v3, s[24:27], s79 offen lds
    s_waitcnt lgkmcnt(3)
    v_mfma_f32_32x32x16_bf16 v[92:107], a[112:115], v[160:163], v[92:107]
    v_mul_f32 v64, v64, v180
    v_mul_f32 v65, v65, v181
    v_mul_f32 v66, v66, v182
    v_mul_f32 v67, v67, v183
    v_cvt_pk_bf16_f32 v216, v64, v65
    v_cvt_pk_bf16_f32 v217, v66, v67
    v_mfma_f32_32x32x16_bf16 v[108:123], a[116:119], v[160:163], v[108:123]
    ds_read_b128 v[176:179], v222 offset:7168
    s_add_u32 s71, s88, 0x8c000
    s_cmp_lg_u32 s61, 0
    s_cbranch_scc1 L_var24_wt
    buffer_store_dwordx4 v[214:217], v2, s[32:35], s71 offen
L_var24_end:
    s_waitcnt lgkmcnt(3)
    v_mfma_f32_32x32x16_bf16 v[92:107], a[120:123], v[164:167], v[92:107]
    s_add_u32 m0, s62, 36864
    s_add_u32 s79, s68, 516096
    buffer_load_dwordx4 v3, s[24:27], s79 offen lds
    v_mul_f32 v180, v76, v76
    v_mul_f32 v181, v77, v77
    v_mfma_f32_32x32x16_bf16 v[108:123], a[124:127], v[164:167], v[108:123]
    ds_read_b128 v[156:159], v222 offset:8192
    v_mul_f32 v182, v78, v78
    v_mul_f32 v183, v79, v79
    v_fma_f32 v180, v180, v201, v200
    v_fma_f32 v181, v181, v201, v200
    s_waitcnt lgkmcnt(3)
    v_mfma_f32_32x32x16_bf16 v[92:107], a[128:131], v[168:171], v[92:107]
    v_fma_f32 v182, v182, v201, v200
    v_fma_f32 v183, v183, v201, v200
    v_mul_f32 v180, v180, v76
    v_mul_f32 v181, v181, v77
    v_mul_f32 v182, v182, v78
    v_mul_f32 v183, v183, v79
    v_mfma_f32_32x32x16_bf16 v[108:123], a[132:135], v[168:171], v[108:123]
    ds_read_b128 v[160:163], v222 offset:9216
    s_add_u32 m0, s62, 40960
    s_add_u32 s79, s68, 530432
    buffer_load_dwordx4 v3, s[24:27], s79 offen lds
    s_waitcnt lgkmcnt(3)
    v_mfma_f32_32x32x16_bf16 v[92:107], a[136:139], v[172:175], v[92:107]
    v_exp_f32 v180, v180
    v_exp_f32 v181, v181
    v_exp_f32 v182, v182
    v_mfma_f32_32x32x16_bf16 v[108:123], a[140:143], v[172:175], v[108:123]
    ds_read_b128 v[164:167], v222 offset:10240
    v_exp_f32 v183, v183
    v_mul_f32 v76, v76, v84
    v_mul_f32 v77, v77, v85
    s_waitcnt lgkmcnt(3)
    v_mfma_f32_32x32x16_bf16 v[92:107], a[144:147], v[176:179], v[92:107]
    s_add_u32 m0, s62, 45056
    s_add_u32 s79, s68, 544768
    buffer_load_dwordx4 v3, s[24:27], s79 offen lds
    v_mul_f32 v78, v78, v86
    v_mul_f32 v79, v79, v87
    v_mfma_f32_32x32x16_bf16 v[108:123], a[148:151], v[176:179], v[108:123]
    ds_read_b128 v[168:171], v222 offset:11264
    v_fma_f32 v180, v180, v209, v209
    v_fma_f32 v181, v181, v209, v209
    v_fma_f32 v182, v182, v209, v209
    v_fma_f32 v183, v183, v209, v209
    s_waitcnt lgkmcnt(3)
    v_mfma_f32_32x32x16_bf16 v[92:107], a[152:155], v[156:159], v[92:107]
    v_rcp_f32 v180, v180
    v_rcp_f32 v181, v181
    v_rcp_f32 v182, v182
    v_mfma_f32_32x32x16_bf16 v[108:123], a[156:159], v[156:159], v[108:123]
    ds_read_b128 v[172:175], v222 offset:12288
    s_add_u32 m0, s62, 49152
    s_add_u32 s79, s68, 559104
    buffer_load_dwordx4 v3, s[24:27], s79 offen lds
    s_waitcnt lgkmcnt(3)
    v_mfma_f32_32x32x16_bf16 v[92:107], a[160:163], v[160:163], v[92:107]
    v_rcp_f32 v183, v183
    v_mul_f32 v76, v76, v180
    v_mul_f32 v77, v77, v181
    v_mul_f32 v78, v78, v182
    v_mul_f32 v79, v79, v183
    v_mfma_f32_32x32x16_bf16 v[108:123], a[164:167], v[160:163], v[108:123]
    s_waitcnt vmcnt(27)
    s_barrier
    ds_read_b128 v[176:179], v222 offset:13312
    v_cvt_pk_bf16_f32 v218, v76, v77
    v_cvt_pk_bf16_f32 v219, v78, v79
    s_waitcnt lgkmcnt(3)
    v_mfma_f32_32x32x16_bf16 v[92:107], a[168:171], v[164:167], v[92:107]
    s_add_u32 m0, s62, 53248
    s_add_u32 s79, s86, 688128
    buffer_load_dwordx4 v3, s[24:27], s79 offen lds
    v_mul_f32 v180, v80, v80
    v_mul_f32 v181, v81, v81
    v_mfma_f32_32x32x16_bf16 v[108:123], a[172:175], v[164:167], v[108:123]
    ds_read_b128 v[156:159], v222 offset:14336
    v_mul_f32 v182, v82, v82
    v_mul_f32 v183, v83, v83
    v_fma_f32 v180, v180, v201, v200
    v_fma_f32 v181, v181, v201, v200
    s_waitcnt lgkmcnt(3)
    v_mfma_f32_32x32x16_bf16 v[92:107], a[176:179], v[168:171], v[92:107]
    v_fma_f32 v182, v182, v201, v200
    v_fma_f32 v183, v183, v201, v200
    v_mul_f32 v180, v180, v80
    v_mul_f32 v181, v181, v81
    v_mul_f32 v182, v182, v82
    v_mul_f32 v183, v183, v83
    v_mfma_f32_32x32x16_bf16 v[108:123], a[180:183], v[168:171], v[108:123]
    ds_read_b128 v[160:163], v222 offset:15360
    v_exp_f32 v180, v180
    v_exp_f32 v181, v181
    s_waitcnt lgkmcnt(3)
    v_mfma_f32_32x32x16_bf16 v[92:107], a[184:187], v[172:175], v[92:107]
    v_exp_f32 v182, v182
    v_exp_f32 v183, v183
    v_mul_f32 v80, v80, v88
    v_mul_f32 v81, v81, v89
    v_mfma_f32_32x32x16_bf16 v[108:123], a[188:191], v[172:175], v[108:123]
    ds_read_b128 v[164:167], v222 offset:16384
    v_mul_f32 v82, v82, v90
    v_mul_f32 v83, v83, v91
    v_fma_f32 v180, v180, v209, v209
    v_fma_f32 v181, v181, v209, v209
    s_waitcnt lgkmcnt(3)
    v_mfma_f32_32x32x16_bf16 v[92:107], a[192:195], v[176:179], v[92:107]
    v_fma_f32 v182, v182, v209, v209
    v_fma_f32 v183, v183, v209, v209
    v_rcp_f32 v180, v180
    v_rcp_f32 v181, v181
    v_mfma_f32_32x32x16_bf16 v[108:123], a[196:199], v[176:179], v[108:123]
    ds_read_b128 v[168:171], v222 offset:17408
    v_rcp_f32 v182, v182
    v_rcp_f32 v183, v183
    s_waitcnt lgkmcnt(3)
    v_mfma_f32_32x32x16_bf16 v[92:107], a[200:203], v[156:159], v[92:107]
    v_mul_f32 v80, v80, v180
    v_mul_f32 v81, v81, v181
    v_mul_f32 v82, v82, v182
    v_mul_f32 v83, v83, v183
    v_cvt_pk_bf16_f32 v220, v80, v81
    v_cvt_pk_bf16_f32 v221, v82, v83
    v_mfma_f32_32x32x16_bf16 v[108:123], a[204:207], v[156:159], v[108:123]
    ds_read_b128 v[172:175], v222 offset:18432
    s_add_u32 s71, s88, 0x8d000
    s_cmp_lg_u32 s61, 0
    s_cbranch_scc1 L_var25_wt
    buffer_store_dwordx4 v[218:221], v2, s[32:35], s71 offen
L_var25_end:
    s_waitcnt lgkmcnt(3)
    v_mfma_f32_32x32x16_bf16 v[92:107], a[208:211], v[160:163], v[92:107]
    v_mfma_f32_32x32x16_bf16 v[108:123], a[212:215], v[160:163], v[108:123]
    ds_read_b128 v[176:179], v222 offset:19456
    s_waitcnt lgkmcnt(3)
    v_mfma_f32_32x32x16_bf16 v[92:107], a[216:219], v[164:167], v[92:107]
    v_mfma_f32_32x32x16_bf16 v[108:123], a[220:223], v[164:167], v[108:123]
    ds_read_b128 v[156:159], v222 offset:20480
    s_waitcnt lgkmcnt(3)
    v_mfma_f32_32x32x16_bf16 v[92:107], a[224:227], v[168:171], v[92:107]
    v_mfma_f32_32x32x16_bf16 v[108:123], a[228:231], v[168:171], v[108:123]
    ds_read_b128 v[160:163], v222 offset:21504
    s_waitcnt lgkmcnt(3)
    v_mfma_f32_32x32x16_bf16 v[92:107], a[232:235], v[172:175], v[92:107]
    v_mfma_f32_32x32x16_bf16 v[108:123], a[236:239], v[172:175], v[108:123]
    ds_read_b128 v[164:167], v222 offset:22528
    s_waitcnt lgkmcnt(3)
    v_mfma_f32_32x32x16_bf16 v[92:107], a[240:243], v[176:179], v[92:107]
    v_mfma_f32_32x32x16_bf16 v[108:123], a[244:247], v[176:179], v[108:123]
    s_barrier
    v_mov_b32 v24, v210
    s_nop 1
    v_mfma_f32_32x32x16_bf16 v[92:107], a[18:21], v[24:27], v[92:107]
    v_mfma_f32_32x32x16_bf16 v[108:123], a[20:23], v[24:27], v[108:123]
    ds_read_b128 v[168:171], v222 offset:23552
    s_waitcnt vmcnt(0) lgkmcnt(3)
    v_mfma_f32_32x32x16_bf16 v[124:139], a[24:27], v[156:159], 0
    v_mov_b32 v7, 2
    s_mov_b64 exec, 1
    s_cmp_lg_u32 s61, 0
    s_cbranch_scc1 L_var26_wt
    buffer_store_dword v7, off, s[32:35], s89
L_var26_end:
    s_mov_b64 exec, -1
    s_add_u32 s91, s89, 256
    v_mov_b32 v7, 2
    s_mov_b64 exec, 1
    s_cmp_lg_u32 s61, 0
    s_cbranch_scc1 L_var27_wt
    buffer_store_dword v7, off, s[32:35], s91
L_var27_end:
    s_mov_b64 exec, -1
    v_mfma_f32_32x32x16_bf16 v[140:155], a[28:31], v[156:159], 0
    ds_read_b128 v[172:175], v222 offset:24576
    s_add_u32 m0, s62, 57344
    s_add_u32 s79, s86, 702464
    buffer_load_dwordx4 v3, s[24:27], s79 offen lds
    s_waitcnt lgkmcnt(3)
    v_mfma_f32_32x32x16_bf16 v[124:139], a[32:35], v[160:163], v[124:139]
    v_mul_f32 v180, v92, v92
    v_mul_f32 v181, v93, v93
    v_mul_f32 v182, v94, v94
    v_mul_f32 v183, v95, v95
    v_fma_f32 v180, v180, v203, v202
    v_fma_f32 v181, v181, v203, v202
    v_mfma_f32_32x32x16_bf16 v[140:155], a[36:39], v[160:163], v[140:155]
    ds_read_b128 v[176:179], v222 offset:25600
    s_add_u32 m0, s62, 61440
    s_add_u32 s79, s86, 716800
    buffer_load_dwordx4 v3, s[24:27], s79 offen lds
    s_waitcnt lgkmcnt(3)
    v_mfma_f32_32x32x16_bf16 v[124:139], a[40:43], v[164:167], v[124:139]
    v_fma_f32 v182, v182, v203, v202
    v_fma_f32 v183, v183, v203, v202
    v_mul_f32 v180, v180, v92
    v_mul_f32 v181, v181, v93
    v_mul_f32 v182, v182, v94
    v_mul_f32 v183, v183, v95
    v_mfma_f32_32x32x16_bf16 v[140:155], a[44:47], v[164:167], v[140:155]
    ds_read_b128 v[156:159], v222 offset:26624
    v_exp_f32 v180, v180
    v_exp_f32 v181, v181
    s_waitcnt lgkmcnt(3)
    v_mfma_f32_32x32x16_bf16 v[124:139], a[48:51], v[168:171], v[124:139]
    s_add_u32 m0, s62, 65536
    s_add_u32 s79, s86, 731136
    buffer_load_dwordx4 v3, s[24:27], s79 offen lds
    v_exp_f32 v182, v182
    v_mfma_f32_32x32x16_bf16 v[140:155], a[52:55], v[168:171], v[140:155]
    ds_read_b128 v[160:163], v222 offset:27648
    v_exp_f32 v183, v183
    v_mul_f32 v92, v92, v100
    v_mul_f32 v93, v93, v101
    s_waitcnt lgkmcnt(3)
    v_mfma_f32_32x32x16_bf16 v[124:139], a[56:59], v[172:175], v[124:139]
    v_mul_f32 v94, v94, v102
    v_mul_f32 v95, v95, v103
    v_fma_f32 v180, v180, v211, v211
    v_fma_f32 v181, v181, v211, v211
    v_fma_f32 v182, v182, v211, v211
    v_fma_f32 v183, v183, v211, v211
    v_mfma_f32_32x32x16_bf16 v[140:155], a[60:63], v[172:175], v[140:155]
    ds_read_b128 v[164:167], v222 offset:28672
    s_add_u32 m0, s62, 69632
    s_add_u32 s79, s86, 745472
    buffer_load_dwordx4 v3, s[24:27], s79 offen lds
    s_waitcnt lgkmcnt(3)
    v_mfma_f32_32x32x16_bf16 v[124:139], a[64:67], v[176:179], v[124:139]
    v_rcp_f32 v180, v180
    v_rcp_f32 v181, v181
    v_rcp_f32 v182, v182
    v_mfma_f32_32x32x16_bf16 v[140:155], a[68:71], v[176:179], v[140:155]
    ds_read_b128 v[168:171], v222 offset:29696
    buffer_load_dword v229, v228, s[32:35], s96 offen sc1
    v_rcp_f32 v183, v183
    s_waitcnt lgkmcnt(3)
    v_mfma_f32_32x32x16_bf16 v[124:139], a[72:75], v[156:159], v[124:139]
    s_add_u32 m0, s62, 73728
    s_add_u32 s79, s86, 759808
    buffer_load_dwordx4 v3, s[24:27], s79 offen lds
    v_mul_f32 v92, v92, v180
    v_mul_f32 v93, v93, v181
    v_mfma_f32_32x32x16_bf16 v[140:155], a[76:79], v[156:159], v[140:155]
    ds_read_b128 v[172:175], v222 offset:30720
    v_mul_f32 v94, v94, v182
    v_mul_f32 v95, v95, v183
    v_cvt_pk_bf16_f32 v214, v92, v93
    v_cvt_pk_bf16_f32 v215, v94, v95
    s_waitcnt lgkmcnt(3)
    v_mfma_f32_32x32x16_bf16 v[124:139], a[80:83], v[160:163], v[124:139]
    v_mul_f32 v180, v96, v96
    v_mul_f32 v181, v97, v97
    v_mul_f32 v182, v98, v98
    v_mul_f32 v183, v99, v99
    v_fma_f32 v180, v180, v203, v202
    v_fma_f32 v181, v181, v203, v202
    v_mfma_f32_32x32x16_bf16 v[140:155], a[84:87], v[160:163], v[140:155]
    ds_read_b128 v[176:179], v222 offset:31744
    s_add_u32 m0, s62, 77824
    s_add_u32 s79, s86, 774144
    buffer_load_dwordx4 v3, s[24:27], s79 offen lds
    s_waitcnt lgkmcnt(3)
    v_mfma_f32_32x32x16_bf16 v[124:139], a[88:91], v[164:167], v[124:139]
    v_fma_f32 v182, v182, v203, v202
    v_fma_f32 v183, v183, v203, v202
    v_mul_f32 v180, v180, v96
    v_mul_f32 v181, v181, v97
    v_mul_f32 v182, v182, v98
    v_mul_f32 v183, v183, v99
    v_mfma_f32_32x32x16_bf16 v[140:155], a[92:95], v[164:167], v[140:155]
    ds_read_b128 v[156:159], v222 offset:32768
    v_exp_f32 v180, v180
    v_exp_f32 v181, v181
    s_waitcnt lgkmcnt(3)
    v_mfma_f32_32x32x16_bf16 v[124:139], a[96:99], v[168:171], v[124:139]
    s_add_u32 m0, s62, 81920
    s_add_u32 s79, s86, 788480
    buffer_load_dwordx4 v3, s[24:27], s79 offen lds
    v_exp_f32 v182, v182
    v_mfma_f32_32x32x16_bf16 v[140:155], a[100:103], v[168:171], v[140:155]
    ds_read_b128 v[160:163], v222 offset:33792
    v_exp_f32 v183, v183
    v_mul_f32 v96, v96, v104
    v_mul_f32 v97, v97, v105
    s_waitcnt lgkmcnt(3)
    v_mfma_f32_32x32x16_bf16 v[124:139], a[104:107], v[172:175], v[124:139]
    v_mul_f32 v98, v98, v106
    v_mul_f32 v99, v99, v107
    v_fma_f32 v180, v180, v211, v211
    v_fma_f32 v181, v181, v211, v211
    v_fma_f32 v182, v182, v211, v211
    v_fma_f32 v183, v183, v211, v211
    v_mfma_f32_32x32x16_bf16 v[140:155], a[108:111], v[172:175], v[140:155]
    ds_read_b128 v[164:167], v222 offset:34816
    v_rcp_f32 v180, v180
    v_rcp_f32 v181, v181
    s_waitcnt lgkmcnt(3)
    v_mfma_f32_32x32x16_bf16 v[124:139], a[112:115], v[176:179], v[124:139]
    v_rcp_f32 v182, v182
    v_rcp_f32 v183, v183
    v_mul_f32 v96, v96, v180
    v_mul_f32 v97, v97, v181
    v_mfma_f32_32x32x16_bf16 v[140:155], a[116:119], v[176:179], v[140:155]
    s_barrier
    ds_read_b128 v[168:171], v222 offset:35840
    s_waitcnt vmcnt(3)
    s_mov_b32 s73, 0
L_peek_386:
    v_cmp_le_u32 s[44:45], 2, v229
    s_add_u32 s73, s73, 1
    s_cmp_eq_u64 s[44:45], -1
    s_cbranch_scc1 L_peek_386_ok
    s_cmp_ge_u32 s73, 262144
    s_cbranch_scc1 L_peek_386_ok
    buffer_load_dword v229, v228, s[32:35], s96 offen sc1
    s_waitcnt vmcnt(0)
    s_branch L_peek_386
L_peek_386_ok:
    s_waitcnt lgkmcnt(3)
    v_mfma_f32_32x32x16_bf16 v[124:139], a[120:123], v[156:159], v[124:139]
    s_add_u32 s98, s97, 0x70000
    buffer_load_dwordx4 v[28:31], v2, s[32:35], s98 offen offset:0 sc1
    s_add_u32 m0, s62, 86016
    s_add_u32 s79, s68, 114688
    buffer_load_dwordx4 v3, s[24:27], s79 offen lds
    v_mfma_f32_32x32x16_bf16 v[140:155], a[124:127], v[156:159], v[140:155]
    ds_read_b128 v[172:175], v222 offset:36864
    buffer_load_dwordx4 v[32:35], v2, s[32:35], s98 offen offset:1024 sc1
    v_mul_f32 v98, v98, v182
    v_mul_f32 v99, v99, v183
    s_waitcnt lgkmcnt(3)
    v_mfma_f32_32x32x16_bf16 v[124:139], a[128:131], v[160:163], v[124:139]
    v_cvt_pk_bf16_f32 v216, v96, v97
    v_cvt_pk_bf16_f32 v217, v98, v99
    s_add_u32 s71, s92, 0xa8000
    s_cmp_lg_u32 s61, 0
    s_cbranch_scc1 L_var28_wt
    buffer_store_dwordx4 v[214:217], v2, s[32:35], s71 offen
L_var28_end:
    v_mfma_f32_32x32x16_bf16 v[140:155], a[132:135], v[160:163], v[140:155]
    ds_read_b128 v[176:179], v222 offset:37888
    buffer_load_dwordx4 v[36:39], v2, s[32:35], s98 offen offset:2048 sc1
    v_mul_f32 v180, v108, v108
    v_mul_f32 v181, v109, v109
    s_waitcnt lgkmcnt(3)
    v_mfma_f32_32x32x16_bf16 v[124:139], a[136:139], v[164:167], v[124:139]
    s_add_u32 m0, s62, 90112
    s_add_u32 s79, s68, 129024
    buffer_load_dwordx4 v3, s[24:27], s79 offen lds
    v_mul_f32 v182, v110, v110
    v_mul_f32 v183, v111, v111
    v_mfma_f32_32x32x16_bf16 v[140:155], a[140:143], v[164:167], v[140:155]
    ds_read_b128 v[156:159], v222 offset:38912
    buffer_load_dwordx4 v[40:43], v2, s[32:35], s98 offen offset:3072 sc1
    v_fma_f32 v180, v180, v203, v202
    v_fma_f32 v181, v181, v203, v202
    s_waitcnt lgkmcnt(3)
    v_mfma_f32_32x32x16_bf16 v[124:139], a[144:147], v[168:171], v[124:139]
    s_add_u32 m0, s62, 94208
    s_add_u32 s79, s68, 143360
    buffer_load_dwordx4 v3, s[24:27], s79 offen lds
    v_fma_f32 v182, v182, v203, v202
    v_fma_f32 v183, v183, v203, v202
    v_mfma_f32_32x32x16_bf16 v[140:155], a[148:151], v[168:171], v[140:155]
    ds_read_b128 v[160:163], v222 offset:39936
    s_add_u32 s98, s97, 0x71000
    buffer_load_dwordx4 v[44:47], v2, s[32:35], s98 offen offset:0 sc1
    v_mul_f32 v180, v180, v108
    s_waitcnt lgkmcnt(3)
    v_mfma_f32_32x32x16_bf16 v[124:139], a[152:155], v[172:175], v[124:139]
    v_mul_f32 v181, v181, v109
    v_mul_f32 v182, v182, v110
    v_mul_f32 v183, v183, v111
    v_exp_f32 v180, v180
    v_mfma_f32_32x32x16_bf16 v[140:155], a[156:159], v[172:175], v[140:155]
    ds_read_b128 v[164:167], v222 offset:40960
    buffer_load_dwordx4 v[48:51], v2, s[32:35], s98 offen offset:1024 sc1
    v_exp_f32 v181, v181
    s_waitcnt lgkmcnt(3)
    v_mfma_f32_32x32x16_bf16 v[124:139], a[160:163], v[176:179], v[124:139]
    buffer_load_dwordx4 v[52:55], v2, s[32:35], s98 offen offset:2048 sc1
    v_exp_f32 v182, v182
    v_exp_f32 v183, v183
    v_mfma_f32_32x32x16_bf16 v[140:155], a[164:167], v[176:179], v[140:155]
    ds_read_b128 v[168:171], v222 offset:41984
    v_mul_f32 v108, v108, v116
    v_mul_f32 v109, v109, v117
    v_mul_f32 v110, v110, v118
    v_mul_f32 v111, v111, v119
    s_waitcnt lgkmcnt(3)
    v_mfma_f32_32x32x16_bf16 v[124:139], a[168:171], v[156:159], v[124:139]
    buffer_load_dwordx4 v[56:59], v2, s[32:35], s98 offen offset:3072 sc1
    v_fma_f32 v180, v180, v211, v211
    v_fma_f32 v181, v181, v211, v211
    v_fma_f32 v182, v182, v211, v211
    v_fma_f32 v183, v183, v211, v211
    v_mfma_f32_32x32x16_bf16 v[140:155], a[172:175], v[156:159], v[140:155]
    ds_read_b128 v[172:175], v222 offset:43008
    v_rcp_f32 v180, v180
    v_rcp_f32 v181, v181
    s_waitcnt lgkmcnt(3)
    v_mfma_f32_32x32x16_bf16 v[124:139], a[176:179], v[160:163], v[124:139]
    s_add_u32 s98, s97, 0x74000
    buffer_load_dwordx4 v[60:63], v2, s[32:35], s98 offen offset:0 sc1
    v_rcp_f32 v182, v182
    v_mfma_f32_32x32x16_bf16 v[140:155], a[180:183], v[160:163], v[140:155]
    ds_read_b128 v[176:179], v222 offset:44032
    v_rcp_f32 v183, v183
    v_mul_f32 v108, v108, v180
    v_mul_f32 v109, v109, v181
    s_waitcnt lgkmcnt(3)
    v_mfma_f32_32x32x16_bf16 v[124:139], a[184:187], v[164:167], v[124:139]
    buffer_load_dwordx4 v[64:67], v2, s[32:35], s98 offen offset:1024 sc1
    v_mul_f32 v110, v110, v182
    v_mul_f32 v111, v111, v183
    v_cvt_pk_bf16_f32 v218, v108, v109
    v_cvt_pk_bf16_f32 v219, v110, v111
    v_mfma_f32_32x32x16_bf16 v[140:155], a[188:191], v[164:167], v[140:155]
    ds_read_b128 v[156:159], v222 offset:45056
    v_mul_f32 v180, v112, v112
    v_mul_f32 v181, v113, v113
    v_mul_f32 v182, v114, v114
    v_mul_f32 v183, v115, v115
    s_waitcnt lgkmcnt(3)
    v_mfma_f32_32x32x16_bf16 v[124:139], a[192:195], v[168:171], v[124:139]
    buffer_load_dwordx4 v[68:71], v2, s[32:35], s98 offen offset:2048 sc1
    v_fma_f32 v180, v180, v203, v202
    v_fma_f32 v181, v181, v203, v202
    v_fma_f32 v182, v182, v203, v202
    v_fma_f32 v183, v183, v203, v202
    v_mfma_f32_32x32x16_bf16 v[140:155], a[196:199], v[168:171], v[140:155]
    ds_read_b128 v[160:163], v222 offset:46080
    buffer_load_dwordx4 v[72:75], v2, s[32:35], s98 offen offset:3072 sc1
    v_mul_f32 v180, v180, v112
    v_mul_f32 v181, v181, v113
    s_waitcnt lgkmcnt(3)
    v_mfma_f32_32x32x16_bf16 v[124:139], a[200:203], v[172:175], v[124:139]
    v_mul_f32 v182, v182, v114
    v_mul_f32 v183, v183, v115
    v_exp_f32 v180, v180
    v_exp_f32 v181, v181
    v_mfma_f32_32x32x16_bf16 v[140:155], a[204:207], v[172:175], v[140:155]
    ds_read_b128 v[164:167], v222 offset:47104
    s_add_u32 s98, s97, 0x75000
    buffer_load_dwordx4 v[76:79], v2, s[32:35], s98 offen offset:0 sc1
    s_waitcnt lgkmcnt(3)
    v_mfma_f32_32x32x16_bf16 v[124:139], a[208:211], v[176:179], v[124:139]
    v_exp_f32 v182, v182
    v_exp_f32 v183, v183
    v_mul_f32 v112, v112, v120
    v_mul_f32 v113, v113, v121
    v_mfma_f32_32x32x16_bf16 v[140:155], a[212:215], v[176:179], v[140:155]
    s_barrier
    ds_read_b128 v[168:171], v222 offset:48128
    buffer_load_dwordx4 v[80:83], v2, s[32:35], s98 offen offset:1024 sc1
    v_mul_f32 v114, v114, v122
    s_waitcnt lgkmcnt(3)
    v_mfma_f32_32x32x16_bf16 v[124:139], a[216:219], v[156:159], v[124:139]
    s_add_u32 m0, s62, 98304
    s_add_u32 s79, s68, 157696
    buffer_load_dwordx4 v3, s[24:27], s79 offen lds
    v_mul_f32 v115, v115, v123
    v_fma_f32 v180, v180, v211, v211
    v_mfma_f32_32x32x16_bf16 v[140:155], a[220:223], v[156:159], v[140:155]
    v_fma_f32 v181, v181, v211, v211
    v_fma_f32 v182, v182, v211, v211
    v_fma_f32 v183, v183, v211, v211
    v_rcp_f32 v180, v180
    s_waitcnt lgkmcnt(2)
    v_mfma_f32_32x32x16_bf16 v[124:139], a[224:227], v[160:163], v[124:139]
    v_rcp_f32 v181, v181
    v_rcp_f32 v182, v182
    v_rcp_f32 v183, v183
    v_mfma_f32_32x32x16_bf16 v[140:155], a[228:231], v[160:163], v[140:155]
    s_add_u32 m0, s62, 102400
    s_add_u32 s79, s68, 172032
    buffer_load_dwordx4 v3, s[24:27], s79 offen lds
    v_mul_f32 v112, v112, v180
    s_waitcnt lgkmcnt(1)
    v_mfma_f32_32x32x16_bf16 v[124:139], a[232:235], v[164:167], v[124:139]
    v_mul_f32 v113, v113, v181
    v_mul_f32 v114, v114, v182
    v_mul_f32 v115, v115, v183
    v_cvt_pk_bf16_f32 v220, v112, v113
    v_cvt_pk_bf16_f32 v221, v114, v115
    v_mfma_f32_32x32x16_bf16 v[140:155], a[236:239], v[164:167], v[140:155]
    s_add_u32 s71, s92, 0xa9000
    s_cmp_lg_u32 s61, 0
    s_cbranch_scc1 L_var29_wt
    buffer_store_dwordx4 v[218:221], v2, s[32:35], s71 offen
L_var29_end:
    s_waitcnt lgkmcnt(0)
    v_mfma_f32_32x32x16_bf16 v[124:139], a[240:243], v[168:171], v[124:139]
    s_add_u32 m0, s62, 106496
    s_add_u32 s79, s68, 186368
    buffer_load_dwordx4 v3, s[24:27], s79 offen lds
    v_mfma_f32_32x32x16_bf16 v[140:155], a[244:247], v[168:171], v[140:155]
    v_mov_b32 v24, v212
    s_nop 1
    v_mfma_f32_32x32x16_bf16 v[124:139], a[18:21], v[24:27], v[124:139]
    v_mfma_f32_32x32x16_bf16 v[140:155], a[20:23], v[24:27], v[140:155]
    buffer_load_dwordx4 v[84:87], v2, s[32:35], s98 offen offset:2048 sc1
    s_nop 9
    v_pk_mul_f32 v[180:181], v[124:125], v[124:125]
    v_pk_mul_f32 v[182:183], v[126:127], v[126:127]
    v_pk_mul_f32 v[184:185], v[128:129], v[128:129]
    v_pk_mul_f32 v[186:187], v[130:131], v[130:131]
    v_pk_fma_f32 v[180:181], v[180:181], v[204:205], v[204:205] op_sel:[0,1,0] op_sel_hi:[1,1,0]
    v_pk_fma_f32 v[182:183], v[182:183], v[204:205], v[204:205] op_sel:[0,1,0] op_sel_hi:[1,1,0]
    v_pk_fma_f32 v[184:185], v[184:185], v[204:205], v[204:205] op_sel:[0,1,0] op_sel_hi:[1,1,0]
    v_pk_fma_f32 v[186:187], v[186:187], v[204:205], v[204:205] op_sel:[0,1,0] op_sel_hi:[1,1,0]
    buffer_load_dwordx4 v[88:91], v2, s[32:35], s98 offen offset:3072 sc1
    v_pk_mul_f32 v[180:181], v[180:181], v[124:125]
    v_pk_mul_f32 v[182:183], v[182:183], v[126:127]
    v_pk_mul_f32 v[184:185], v[184:185], v[128:129]
    v_pk_mul_f32 v[186:187], v[186:187], v[130:131]
    v_exp_f32 v180, v180
    v_exp_f32 v181, v181
    v_exp_f32 v182, v182
    v_exp_f32 v183, v183
    s_add_u32 s98, s97, 0x78000
    buffer_load_dwordx4 a[24:27], v2, s[32:35], s98 offen offset:0 sc1
    v_exp_f32 v184, v184
    v_exp_f32 v185, v185
    v_exp_f32 v186, v186
    v_exp_f32 v187, v187
    v_pk_mul_f32 v[124:125], v[124:125], v[132:133]
    v_pk_mul_f32 v[126:127], v[126:127], v[134:135]
    v_pk_mul_f32 v[128:129], v[128:129], v[136:137]
    v_pk_mul_f32 v[130:131], v[130:131], v[138:139]
    buffer_load_dwordx4 a[28:31], v2, s[32:35], s98 offen offset:1024 sc1
    v_pk_fma_f32 v[180:181], v[180:181], v[212:213], v[212:213] op_sel:[0,1,1] op_sel_hi:[1,1,1]
    v_pk_fma_f32 v[182:183], v[182:183], v[212:213], v[212:213] op_sel:[0,1,1] op_sel_hi:[1,1,1]
    v_pk_fma_f32 v[184:185], v[184:185], v[212:213], v[212:213] op_sel:[0,1,1] op_sel_hi:[1,1,1]
    v_pk_fma_f32 v[186:187], v[186:187], v[212:213], v[212:213] op_sel:[0,1,1] op_sel_hi:[1,1,1]
    v_rcp_f32 v180, v180
    v_rcp_f32 v181, v181
    v_rcp_f32 v182, v182
    v_rcp_f32 v183, v183
    buffer_load_dwordx4 a[32:35], v2, s[32:35], s98 offen offset:2048 sc1
    v_rcp_f32 v184, v184
    v_rcp_f32 v185, v185
    v_rcp_f32 v186, v186
    v_rcp_f32 v187, v187
    v_pk_mul_f32 v[124:125], v[124:125], v[180:181]
    v_pk_mul_f32 v[126:127], v[126:127], v[182:183]
    v_pk_mul_f32 v[128:129], v[128:129], v[184:185]
    v_pk_mul_f32 v[130:131], v[130:131], v[186:187]
    buffer_load_dwordx4 a[36:39], v2, s[32:35], s98 offen offset:3072 sc1
    v_cvt_pk_bf16_f32 v214, v124, v125
    v_cvt_pk_bf16_f32 v215, v126, v127
    v_cvt_pk_bf16_f32 v216, v128, v129
    v_cvt_pk_bf16_f32 v217, v130, v131
    s_add_u32 s71, s92, 0xc4000
    s_cmp_lg_u32 s61, 0
    s_cbranch_scc1 L_var30_wt
    buffer_store_dwordx4 v[214:217], v2, s[32:35], s71 offen
L_var30_end:
    v_pk_mul_f32 v[188:189], v[140:141], v[140:141]
    v_pk_mul_f32 v[190:191], v[142:143], v[142:143]
    s_add_u32 s98, s97, 0x79000
    buffer_load_dwordx4 a[40:43], v2, s[32:35], s98 offen offset:0 sc1
    v_pk_mul_f32 v[192:193], v[144:145], v[144:145]
    v_pk_mul_f32 v[194:195], v[146:147], v[146:147]
    v_pk_fma_f32 v[188:189], v[188:189], v[204:205], v[204:205] op_sel:[0,1,0] op_sel_hi:[1,1,0]
    v_pk_fma_f32 v[190:191], v[190:191], v[204:205], v[204:205] op_sel:[0,1,0] op_sel_hi:[1,1,0]
    v_pk_fma_f32 v[192:193], v[192:193], v[204:205], v[204:205] op_sel:[0,1,0] op_sel_hi:[1,1,0]
    v_pk_fma_f32 v[194:195], v[194:195], v[204:205], v[204:205] op_sel:[0,1,0] op_sel_hi:[1,1,0]
    v_pk_mul_f32 v[188:189], v[188:189], v[140:141]
    v_pk_mul_f32 v[190:191], v[190:191], v[142:143]
    buffer_load_dwordx4 a[44:47], v2, s[32:35], s98 offen offset:1024 sc1
    v_pk_mul_f32 v[192:193], v[192:193], v[144:145]
    v_pk_mul_f32 v[194:195], v[194:195], v[146:147]
    v_exp_f32 v188, v188
    v_exp_f32 v189, v189
    v_exp_f32 v190, v190
    v_exp_f32 v191, v191
    v_exp_f32 v192, v192
    v_exp_f32 v193, v193
    buffer_load_dwordx4 a[48:51], v2, s[32:35], s98 offen offset:2048 sc1
    v_exp_f32 v194, v194
    v_exp_f32 v195, v195
    v_pk_mul_f32 v[140:141], v[140:141], v[148:149]
    v_pk_mul_f32 v[142:143], v[142:143], v[150:151]
    v_pk_mul_f32 v[144:145], v[144:145], v[152:153]
    v_pk_mul_f32 v[146:147], v[146:147], v[154:155]
    v_pk_fma_f32 v[188:189], v[188:189], v[212:213], v[212:213] op_sel:[0,1,1] op_sel_hi:[1,1,1]
    v_pk_fma_f32 v[190:191], v[190:191], v[212:213], v[212:213] op_sel:[0,1,1] op_sel_hi:[1,1,1]
    buffer_load_dwordx4 a[52:55], v2, s[32:35], s98 offen offset:3072 sc1
    v_pk_fma_f32 v[192:193], v[192:193], v[212:213], v[212:213] op_sel:[0,1,1] op_sel_hi:[1,1,1]
    v_pk_fma_f32 v[194:195], v[194:195], v[212:213], v[212:213] op_sel:[0,1,1] op_sel_hi:[1,1,1]
    v_rcp_f32 v188, v188
    v_rcp_f32 v189, v189
    v_rcp_f32 v190, v190
    v_rcp_f32 v191, v191
    v_rcp_f32 v192, v192
    v_rcp_f32 v193, v193
    v_rcp_f32 v194, v194
    v_rcp_f32 v195, v195
    v_pk_mul_f32 v[140:141], v[140:141], v[188:189]
    v_pk_mul_f32 v[142:143], v[142:143], v[190:191]
    v_pk_mul_f32 v[144:145], v[144:145], v[192:193]
    v_pk_mul_f32 v[146:147], v[146:147], v[194:195]
    v_cvt_pk_bf16_f32 v218, v140, v141
    v_cvt_pk_bf16_f32 v219, v142, v143
    v_cvt_pk_bf16_f32 v220, v144, v145
    v_cvt_pk_bf16_f32 v221, v146, v147
    s_add_u32 s71, s92, 0xc5000
    s_cmp_lg_u32 s61, 0
    s_cbranch_scc1 L_var31_wt
    buffer_store_dwordx4 v[218:221], v2, s[32:35], s71 offen
L_var31_end:
L_c_k41:
    v_lshrrev_b32 v148, 4, v1
    v_bfe_u32 v149, v1, 2, 2
    v_and_b32 v150, 3, v1
    v_and_b32 v151, 1, v148
    v_lshlrev_b32 v151, 1, v151
    v_lshrrev_b32 v153, 1, v150
    v_add_u32 v151, v151, v153
    v_and_b32 v153, 2, v149
    v_lshlrev_b32 v153, 1, v153
    v_xor_b32 v151, v151, v153
    v_lshlrev_b32 v151, 4, v151
    v_and_b32 v150, 1, v150
    v_lshl_add_u32 v151, v150, 3, v151
    v_lshrrev_b32 v148, 1, v148
    v_lshl_add_u32 v149, v148, 2, v149
    v_lshl_add_u32 v152, v149, 7, v151
    v_xor_b32 v153, 64, v152
    s_mul_i32 s69, s76, 2048
    s_lshl_b32 s71, s76, 6
    v_xor_b32 v152, s71, v152
    v_add_u32 v152, s69, v152
    v_xor_b32 v153, s71, v153
    v_add_u32 v153, s69, v153
    s_lshl_b32 s88, s56, 12
    s_add_u32 s88, s88, 135168
    v_add_u32 v148, s88, v2
    s_xor_b32 s88, s56, 2
    s_lshl_b32 s88, s88, 12
    s_add_u32 s88, s88, 135168
    v_add_u32 v149, s88, v2
    v_and_b32 v151, 31, v1
    v_mul_u32_u24 v150, 896, v151
    v_lshrrev_b32 v151, 5, v1
    v_lshl_add_u32 v150, v151, 4, v150
    s_lshl_b32 s88, s57, 2
    s_add_u32 s88, s88, s75
    s_mul_i32 s88, s88, 28672
    s_lshl_b32 s72, s60, 7
    s_add_u32 s88, s88, s72
    s_lshl_b32 s72, s76, 6
    s_add_u32 s88, s88, s72
    s_waitcnt vmcnt(0)
    s_add_u32 s91, s93, 512
    v_mov_b32 v7, 2
    s_mov_b64 exec, 1
    s_cmp_lg_u32 s61, 0
    s_cbranch_scc1 L_var32_wt
    buffer_store_dword v7, off, s[32:35], s91
L_var32_end:
    s_mov_b64 exec, -1
    s_add_u32 s91, s93, 768
    v_mov_b32 v7, 2
    s_mov_b64 exec, 1
    s_cmp_lg_u32 s61, 0
    s_cbranch_scc1 L_var33_wt
    buffer_store_dword v7, off, s[32:35], s91
L_var33_end:
    s_mov_b64 exec, -1
    s_barrier
    v_add_u32 v152, 114688, v152
    ds_read_b64_tr_b16 v[124:125], v152 offset:0
    ds_read_b64_tr_b16 v[126:127], v152 offset:1024
    v_add_u32 v153, 114688, v153
    ds_read_b64_tr_b16 v[128:129], v153 offset:0
    ds_read_b64_tr_b16 v[130:131], v153 offset:1024
    ds_read_b64_tr_b16 v[132:133], v152 offset:4096
    ds_read_b64_tr_b16 v[134:135], v152 offset:5120
    ds_read_b64_tr_b16 v[136:137], v153 offset:4096
    ds_read_b64_tr_b16 v[138:139], v153 offset:5120
    s_waitcnt lgkmcnt(4)
    v_mfma_f32_32x32x16_bf16 v[92:107], v[124:127], v[28:31], 0
    ds_read_b64_tr_b16 v[140:141], v152 offset:8192
    ds_read_b64_tr_b16 v[142:143], v152 offset:9216
    s_add_u32 m0, s62, 110592
    s_add_u32 s79, s68, 200704
    buffer_load_dwordx4 v3, s[24:27], s79 offen lds
    v_mfma_f32_32x32x16_bf16 v[108:123], v[128:131], v[28:31], 0
    ds_read_b64_tr_b16 v[144:145], v153 offset:8192
    ds_read_b64_tr_b16 v[146:147], v153 offset:9216
    s_waitcnt lgkmcnt(4)
    v_mfma_f32_32x32x16_bf16 v[92:107], v[132:135], v[32:35], v[92:107]
    ds_read_b64_tr_b16 v[124:125], v152 offset:12288
    ds_read_b64_tr_b16 v[126:127], v152 offset:13312
    v_mfma_f32_32x32x16_bf16 v[108:123], v[136:139], v[32:35], v[108:123]
    ds_read_b64_tr_b16 v[128:129], v153 offset:12288
    ds_read_b64_tr_b16 v[130:131], v153 offset:13312
    s_waitcnt lgkmcnt(4)
    v_mfma_f32_32x32x16_bf16 v[92:107], v[140:143], v[36:39], v[92:107]
    ds_read_b64_tr_b16 v[132:133], v152 offset:16384
    ds_read_b64_tr_b16 v[134:135], v152 offset:17408
    v_mfma_f32_32x32x16_bf16 v[108:123], v[144:147], v[36:39], v[108:123]
    ds_read_b64_tr_b16 v[136:137], v153 offset:16384
    ds_read_b64_tr_b16 v[138:139], v153 offset:17408
    s_waitcnt lgkmcnt(4)
    v_mfma_f32_32x32x16_bf16 v[92:107], v[124:127], v[40:43], v[92:107]
    ds_read_b64_tr_b16 v[140:141], v152 offset:20480
    ds_read_b64_tr_b16 v[142:143], v152 offset:21504
    v_mfma_f32_32x32x16_bf16 v[108:123], v[128:131], v[40:43], v[108:123]
    ds_read_b64_tr_b16 v[144:145], v153 offset:20480
    ds_read_b64_tr_b16 v[146:147], v153 offset:21504
    s_barrier
    s_waitcnt lgkmcnt(4)
    v_mfma_f32_32x32x16_bf16 v[92:107], v[132:135], v[44:47], v[92:107]
    ds_read_b64_tr_b16 v[124:125], v152 offset:24576
    ds_read_b64_tr_b16 v[126:127], v152 offset:25600
    buffer_load_dword v227, v226, s[32:35], s95 offen sc1
    v_mfma_f32_32x32x16_bf16 v[108:123], v[136:139], v[44:47], v[108:123]
    ds_read_b64_tr_b16 v[128:129], v153 offset:24576
    ds_read_b64_tr_b16 v[130:131], v153 offset:25600
    s_add_u32 m0, s62, 114688
    s_add_u32 s79, s68, 215040
    buffer_load_dwordx4 v3, s[24:27], s79 offen lds
    s_waitcnt lgkmcnt(4)
    v_mfma_f32_32x32x16_bf16 v[92:107], v[140:143], v[48:51], v[92:107]
    ds_read_b64_tr_b16 v[132:133], v152 offset:28672
    ds_read_b64_tr_b16 v[134:135], v152 offset:29696
    v_mfma_f32_32x32x16_bf16 v[108:123], v[144:147], v[48:51], v[108:123]
    ds_read_b64_tr_b16 v[136:137], v153 offset:28672
    ds_read_b64_tr_b16 v[138:139], v153 offset:29696
    s_add_u32 m0, s62, 118784
    s_add_u32 s79, s68, 344064
    buffer_load_dwordx4 v3, s[24:27], s79 offen lds
    s_waitcnt lgkmcnt(4)
    v_mfma_f32_32x32x16_bf16 v[92:107], v[124:127], v[52:55], v[92:107]
    ds_read_b64_tr_b16 v[140:141], v152 offset:32768
    ds_read_b64_tr_b16 v[142:143], v152 offset:33792
    s_add_u32 m0, s62, 122880
    s_add_u32 s79, s68, 358400
    buffer_load_dwordx4 v3, s[24:27], s79 offen lds
    v_mfma_f32_32x32x16_bf16 v[108:123], v[128:131], v[52:55], v[108:123]
    ds_read_b64_tr_b16 v[144:145], v153 offset:32768
    ds_read_b64_tr_b16 v[146:147], v153 offset:33792
    s_waitcnt lgkmcnt(4)
    v_mfma_f32_32x32x16_bf16 v[92:107], v[132:135], v[56:59], v[92:107]
    ds_read_b64_tr_b16 v[124:125], v152 offset:36864
    ds_read_b64_tr_b16 v[126:127], v152 offset:37888
    s_add_u32 m0, s62, 126976
    s_add_u32 s79, s68, 372736
    buffer_load_dwordx4 v3, s[24:27], s79 offen lds
    v_mfma_f32_32x32x16_bf16 v[108:123], v[136:139], v[56:59], v[108:123]
    ds_read_b64_tr_b16 v[128:129], v153 offset:36864
    ds_read_b64_tr_b16 v[130:131], v153 offset:37888
    s_barrier
    s_waitcnt vmcnt(4)
    s_mov_b32 s73, 0
L_peek_500:
    v_cmp_le_u32 s[44:45], 2, v227
    s_add_u32 s73, s73, 1
    s_cmp_eq_u64 s[44:45], -1
    s_cbranch_scc1 L_peek_500_ok
    s_cmp_ge_u32 s73, 262144
    s_cbranch_scc1 L_peek_500_ok
    buffer_load_dword v227, v226, s[32:35], s95 offen sc1
    s_waitcnt vmcnt(0)
    s_branch L_peek_500
L_peek_500_ok:
    s_waitcnt lgkmcnt(4)
    v_mfma_f32_32x32x16_bf16 v[92:107], v[140:143], v[60:63], v[92:107]
    ds_read_b64_tr_b16 v[132:133], v152 offset:40960
    ds_read_b64_tr_b16 v[134:135], v152 offset:41984
    s_add_u32 s98, s99, 0x7c000
    buffer_load_dwordx4 a[56:59], v2, s[32:35], s98 offen offset:0 sc1
    v_mfma_f32_32x32x16_bf16 v[108:123], v[144:147], v[60:63], v[108:123]
    ds_read_b64_tr_b16 v[136:137], v153 offset:40960
    ds_read_b64_tr_b16 v[138:139], v153 offset:41984
    s_add_u32 m0, s62, 131072
    s_add_u32 s79, s68, 387072
    buffer_load_dwordx4 v3, s[24:27], s79 offen lds
    s_waitcnt lgkmcnt(4)
    v_mfma_f32_32x32x16_bf16 v[92:107], v[124:127], v[64:67], v[92:107]
    v_add_u32 v152, 4294852608, v152
    ds_read_b64_tr_b16 v[140:141], v152 offset:0
    ds_read_b64_tr_b16 v[142:143], v152 offset:1024
    buffer_load_dwordx4 a[60:63], v2, s[32:35], s98 offen offset:1024 sc1
    v_mfma_f32_32x32x16_bf16 v[108:123], v[128:131], v[64:67], v[108:123]
    v_add_u32 v153, 4294852608, v153
    ds_read_b64_tr_b16 v[144:145], v153 offset:0
    ds_read_b64_tr_b16 v[146:147], v153 offset:1024
    s_waitcnt lgkmcnt(4)
    v_mfma_f32_32x32x16_bf16 v[92:107], v[132:135], v[68:71], v[92:107]
    ds_read_b64_tr_b16 v[124:125], v152 offset:4096
    ds_read_b64_tr_b16 v[126:127], v152 offset:5120
    s_add_u32 m0, s62, 135168
    s_add_u32 s79, s68, 401408
    buffer_load_dwordx4 v3, s[24:27], s79 offen lds
    v_mfma_f32_32x32x16_bf16 v[108:123], v[136:139], v[68:71], v[108:123]
    ds_read_b64_tr_b16 v[128:129], v153 offset:4096
    ds_read_b64_tr_b16 v[130:131], v153 offset:5120
    buffer_load_dwordx4 a[64:67], v2, s[32:35], s98 offen offset:2048 sc1
    s_waitcnt lgkmcnt(4)
    v_mfma_f32_32x32x16_bf16 v[92:107], v[140:143], v[72:75], v[92:107]
    ds_read_b64_tr_b16 v[132:133], v152 offset:8192
    ds_read_b64_tr_b16 v[134:135], v152 offset:9216
    buffer_load_dwordx4 a[68:71], v2, s[32:35], s98 offen offset:3072 sc1
    v_mfma_f32_32x32x16_bf16 v[108:123], v[144:147], v[72:75], v[108:123]
    ds_read_b64_tr_b16 v[136:137], v153 offset:8192
    ds_read_b64_tr_b16 v[138:139], v153 offset:9216
    s_barrier
    s_waitcnt lgkmcnt(4)
    v_mfma_f32_32x32x16_bf16 v[92:107], v[124:127], v[76:79], v[92:107]
    ds_read_b64_tr_b16 v[140:141], v152 offset:12288
    ds_read_b64_tr_b16 v[142:143], v152 offset:13312
    s_add_u32 s98, s99, 0x7d000
    buffer_load_dwordx4 a[72:75], v2, s[32:35], s98 offen offset:0 sc1
    v_mfma_f32_32x32x16_bf16 v[108:123], v[128:131], v[76:79], v[108:123]
    ds_read_b64_tr_b16 v[144:145], v153 offset:12288
    ds_read_b64_tr_b16 v[146:147], v153 offset:13312
    s_add_u32 m0, s62, 139264
    s_add_u32 s79, s68, 415744
    buffer_load_dwordx4 v3, s[24:27], s79 offen lds
    s_waitcnt lgkmcnt(4)
    v_mfma_f32_32x32x16_bf16 v[92:107], v[132:135], v[80:83], v[92:107]
    ds_read_b64_tr_b16 v[124:125], v152 offset:16384
    ds_read_b64_tr_b16 v[126:127], v152 offset:17408
    buffer_load_dwordx4 a[76:79], v2, s[32:35], s98 offen offset:1024 sc1
    v_mfma_f32_32x32x16_bf16 v[108:123], v[136:139], v[80:83], v[108:123]
    ds_read_b64_tr_b16 v[128:129], v153 offset:16384
    ds_read_b64_tr_b16 v[130:131], v153 offset:17408
    s_waitcnt lgkmcnt(4)
    v_mfma_f32_32x32x16_bf16 v[92:107], v[140:143], v[84:87], v[92:107]
    ds_read_b64_tr_b16 v[132:133], v152 offset:20480
    ds_read_b64_tr_b16 v[134:135], v152 offset:21504
    s_add_u32 m0, s62, 143360
    s_add_u32 s79, s68, 430080
    buffer_load_dwordx4 v3, s[24:27], s79 offen lds
    v_mfma_f32_32x32x16_bf16 v[108:123], v[144:147], v[84:87], v[108:123]
    ds_read_b64_tr_b16 v[136:137], v153 offset:20480
    ds_read_b64_tr_b16 v[138:139], v153 offset:21504
    buffer_load_dwordx4 a[80:83], v2, s[32:35], s98 offen offset:2048 sc1
    s_waitcnt lgkmcnt(4)
    v_mfma_f32_32x32x16_bf16 v[92:107], v[124:127], v[88:91], v[92:107]
    ds_read_b64_tr_b16 v[140:141], v152 offset:24576
    ds_read_b64_tr_b16 v[142:143], v152 offset:25600
    buffer_load_dwordx4 a[84:87], v2, s[32:35], s98 offen offset:3072 sc1
    v_mfma_f32_32x32x16_bf16 v[108:123], v[128:131], v[88:91], v[108:123]
    ds_read_b64_tr_b16 v[144:145], v153 offset:24576
    ds_read_b64_tr_b16 v[146:147], v153 offset:25600
    s_barrier
    s_waitcnt lgkmcnt(4)
    v_mfma_f32_32x32x16_bf16 v[92:107], v[132:135], a[24:27], v[92:107]
    ds_read_b64_tr_b16 v[124:125], v152 offset:28672
    ds_read_b64_tr_b16 v[126:127], v152 offset:29696
    s_add_u32 s98, s97, 0x72000
    buffer_load_dwordx4 a[88:91], v2, s[32:35], s98 offen offset:0 sc1
    v_mfma_f32_32x32x16_bf16 v[108:123], v[136:139], a[24:27], v[108:123]
    ds_read_b64_tr_b16 v[128:129], v153 offset:28672
    ds_read_b64_tr_b16 v[130:131], v153 offset:29696
    s_add_u32 m0, s62, 147456
    s_add_u32 s79, s68, 444416
    buffer_load_dwordx4 v3, s[24:27], s79 offen lds
    s_waitcnt lgkmcnt(4)
    v_mfma_f32_32x32x16_bf16 v[92:107], v[140:143], a[28:31], v[92:107]
    ds_read_b64_tr_b16 v[132:133], v152 offset:32768
    ds_read_b64_tr_b16 v[134:135], v152 offset:33792
    v_mfma_f32_32x32x16_bf16 v[108:123], v[144:147], a[28:31], v[108:123]
    ds_read_b64_tr_b16 v[136:137], v153 offset:32768
    ds_read_b64_tr_b16 v[138:139], v153 offset:33792
    buffer_load_dwordx4 a[92:95], v2, s[32:35], s98 offen offset:1024 sc1
    s_waitcnt lgkmcnt(4)
    v_mfma_f32_32x32x16_bf16 v[92:107], v[124:127], a[32:35], v[92:107]
    ds_read_b64_tr_b16 v[140:141], v152 offset:36864
    ds_read_b64_tr_b16 v[142:143], v152 offset:37888
    s_add_u32 m0, s62, 151552
    s_add_u32 s79, s68, 573440
    buffer_load_dwordx4 v3, s[24:27], s79 offen lds
    v_mfma_f32_32x32x16_bf16 v[108:123], v[128:131], a[32:35], v[108:123]
    ds_read_b64_tr_b16 v[144:145], v153 offset:36864
    ds_read_b64_tr_b16 v[146:147], v153 offset:37888
    s_waitcnt lgkmcnt(4)
    v_mfma_f32_32x32x16_bf16 v[92:107], v[132:135], a[36:39], v[92:107]
    ds_read_b64_tr_b16 v[124:125], v152 offset:40960
    ds_read_b64_tr_b16 v[126:127], v152 offset:41984
    buffer_load_dwordx4 a[96:99], v2, s[32:35], s98 offen offset:2048 sc1
    v_mfma_f32_32x32x16_bf16 v[108:123], v[136:139], a[36:39], v[108:123]
    ds_read_b64_tr_b16 v[128:129], v153 offset:40960
    ds_read_b64_tr_b16 v[130:131], v153 offset:41984
    s_barrier
    s_waitcnt lgkmcnt(4)
    v_mfma_f32_32x32x16_bf16 v[92:107], v[140:143], a[40:43], v[92:107]
    ds_read_b64_tr_b16 v[132:133], v152 offset:45056
    ds_read_b64_tr_b16 v[134:135], v152 offset:46080
    buffer_load_dwordx4 a[100:103], v2, s[32:35], s98 offen offset:3072 sc1
    v_mfma_f32_32x32x16_bf16 v[108:123], v[144:147], a[40:43], v[108:123]
    ds_read_b64_tr_b16 v[136:137], v153 offset:45056
    ds_read_b64_tr_b16 v[138:139], v153 offset:46080
    s_add_u32 m0, s62, 155648
    s_add_u32 s79, s68, 587776
    buffer_load_dwordx4 v3, s[24:27], s79 offen lds
    s_waitcnt lgkmcnt(4)
    v_mfma_f32_32x32x16_bf16 v[92:107], v[124:127], a[44:47], v[92:107]
    ds_read_b64_tr_b16 v[140:141], v152 offset:49152
    ds_read_b64_tr_b16 v[142:143], v152 offset:50176
    v_mfma_f32_32x32x16_bf16 v[108:123], v[128:131], a[44:47], v[108:123]
    ds_read_b64_tr_b16 v[144:145], v153 offset:49152
    ds_read_b64_tr_b16 v[146:147], v153 offset:50176
    s_add_u32 s98, s97, 0x73000
    buffer_load_dwordx4 a[104:107], v2, s[32:35], s98 offen offset:0 sc1
    s_waitcnt lgkmcnt(4)
    v_mfma_f32_32x32x16_bf16 v[92:107], v[132:135], a[48:51], v[92:107]
    ds_read_b64_tr_b16 v[124:125], v152 offset:53248
    ds_read_b64_tr_b16 v[126:127], v152 offset:54272
    s_add_u32 m0, s62, 0
    s_add_u32 s79, s68, 602112
    buffer_load_dwordx4 v3, s[24:27], s79 offen lds
    v_mfma_f32_32x32x16_bf16 v[108:123], v[136:139], a[48:51], v[108:123]
    ds_read_b64_tr_b16 v[128:129], v153 offset:53248
    ds_read_b64_tr_b16 v[130:131], v153 offset:54272
    s_waitcnt lgkmcnt(4)
    v_mfma_f32_32x32x16_bf16 v[92:107], v[140:143], a[52:55], v[92:107]
    ds_read_b64_tr_b16 v[132:133], v152 offset:57344
    ds_read_b64_tr_b16 v[134:135], v152 offset:58368
    buffer_load_dwordx4 a[108:111], v2, s[32:35], s98 offen offset:1024 sc1
    v_mfma_f32_32x32x16_bf16 v[108:123], v[144:147], a[52:55], v[108:123]
    ds_read_b64_tr_b16 v[136:137], v153 offset:57344
    ds_read_b64_tr_b16 v[138:139], v153 offset:58368
    s_barrier
    s_waitcnt vmcnt(21) lgkmcnt(4)
    v_mfma_f32_32x32x16_bf16 v[92:107], v[124:127], a[56:59], v[92:107]
    ds_read_b64_tr_b16 v[140:141], v152 offset:61440
    ds_read_b64_tr_b16 v[142:143], v152 offset:62464
    buffer_load_dwordx4 a[112:115], v2, s[32:35], s98 offen offset:2048 sc1
    v_mfma_f32_32x32x16_bf16 v[108:123], v[128:131], a[56:59], v[108:123]
    ds_read_b64_tr_b16 v[144:145], v153 offset:61440
    ds_read_b64_tr_b16 v[146:147], v153 offset:62464
    s_add_u32 m0, s62, 4096
    s_add_u32 s79, s68, 616448
    buffer_load_dwordx4 v3, s[24:27], s79 offen lds
    s_waitcnt vmcnt(21) lgkmcnt(4)
    v_mfma_f32_32x32x16_bf16 v[92:107], v[132:135], a[60:63], v[92:107]
    v_add_u32 v152, 65536, v152
    ds_read_b64_tr_b16 v[124:125], v152 offset:0
    ds_read_b64_tr_b16 v[126:127], v152 offset:1024
    v_mfma_f32_32x32x16_bf16 v[108:123], v[136:139], a[60:63], v[108:123]
    v_add_u32 v153, 65536, v153
    ds_read_b64_tr_b16 v[128:129], v153 offset:0
    ds_read_b64_tr_b16 v[130:131], v153 offset:1024
    buffer_load_dwordx4 a[116:119], v2, s[32:35], s98 offen offset:3072 sc1
    s_waitcnt vmcnt(20) lgkmcnt(4)
    v_mfma_f32_32x32x16_bf16 v[92:107], v[140:143], a[64:67], v[92:107]
    ds_read_b64_tr_b16 v[132:133], v152 offset:4096
    ds_read_b64_tr_b16 v[134:135], v152 offset:5120
    s_add_u32 m0, s62, 8192
    s_add_u32 s79, s68, 630784
    buffer_load_dwordx4 v3, s[24:27], s79 offen lds
    v_mfma_f32_32x32x16_bf16 v[108:123], v[144:147], a[64:67], v[108:123]
    ds_read_b64_tr_b16 v[136:137], v153 offset:4096
    ds_read_b64_tr_b16 v[138:139], v153 offset:5120
    s_waitcnt vmcnt(20) lgkmcnt(4)
    v_mfma_f32_32x32x16_bf16 v[92:107], v[124:127], a[68:71], v[92:107]
    ds_read_b64_tr_b16 v[140:141], v152 offset:8192
    ds_read_b64_tr_b16 v[142:143], v152 offset:9216
    s_add_u32 s98, s97, 0x76000
    buffer_load_dwordx4 a[120:123], v2, s[32:35], s98 offen offset:0 sc1
    v_mfma_f32_32x32x16_bf16 v[108:123], v[128:131], a[68:71], v[108:123]
    ds_read_b64_tr_b16 v[144:145], v153 offset:8192
    ds_read_b64_tr_b16 v[146:147], v153 offset:9216
    s_barrier
    s_waitcnt vmcnt(20) lgkmcnt(4)
    v_mfma_f32_32x32x16_bf16 v[92:107], v[132:135], a[72:75], v[92:107]
    ds_read_b64_tr_b16 v[124:125], v152 offset:12288
    ds_read_b64_tr_b16 v[126:127], v152 offset:13312
    buffer_load_dwordx4 a[124:127], v2, s[32:35], s98 offen offset:1024 sc1
    v_mfma_f32_32x32x16_bf16 v[108:123], v[136:139], a[72:75], v[108:123]
    ds_read_b64_tr_b16 v[128:129], v153 offset:12288
    ds_read_b64_tr_b16 v[130:131], v153 offset:13312
    s_add_u32 m0, s62, 12288
    s_add_u32 s79, s68, 645120
    buffer_load_dwordx4 v3, s[24:27], s79 offen lds
    s_waitcnt vmcnt(20) lgkmcnt(4)
    v_mfma_f32_32x32x16_bf16 v[92:107], v[140:143], a[76:79], v[92:107]
    ds_read_b64_tr_b16 v[132:133], v152 offset:16384
    ds_read_b64_tr_b16 v[134:135], v152 offset:17408
    v_mfma_f32_32x32x16_bf16 v[108:123], v[144:147], a[76:79], v[108:123]
    ds_read_b64_tr_b16 v[136:137], v153 offset:16384
    ds_read_b64_tr_b16 v[138:139], v153 offset:17408
    buffer_load_dwordx4 a[128:131], v2, s[32:35], s98 offen offset:2048 sc1
    s_waitcnt vmcnt(19) lgkmcnt(4)
    v_mfma_f32_32x32x16_bf16 v[92:107], v[124:127], a[80:83], v[92:107]
    ds_read_b64_tr_b16 v[140:141], v152 offset:20480
    ds_read_b64_tr_b16 v[142:143], v152 offset:21504
    s_add_u32 m0, s62, 16384
    s_add_u32 s79, s68, 659456
    buffer_load_dwordx4 v3, s[24:27], s79 offen lds
    v_mfma_f32_32x32x16_bf16 v[108:123], v[128:131], a[80:83], v[108:123]
    ds_read_b64_tr_b16 v[144:145], v153 offset:20480
    ds_read_b64_tr_b16 v[146:147], v153 offset:21504
    s_waitcnt vmcnt(19) lgkmcnt(4)
    v_mfma_f32_32x32x16_bf16 v[92:107], v[132:135], a[84:87], v[92:107]
    ds_read_b64_tr_b16 v[124:125], v152 offset:24576
    ds_read_b64_tr_b16 v[126:127], v152 offset:25600
    buffer_load_dwordx4 a[132:135], v2, s[32:35], s98 offen offset:3072 sc1
    v_mfma_f32_32x32x16_bf16 v[108:123], v[136:139], a[84:87], v[108:123]
    ds_read_b64_tr_b16 v[128:129], v153 offset:24576
    ds_read_b64_tr_b16 v[130:131], v153 offset:25600
    s_barrier
    s_waitcnt vmcnt(19) lgkmcnt(4)
    v_mfma_f32_32x32x16_bf16 v[92:107], v[140:143], a[88:91], v[92:107]
    ds_read_b64_tr_b16 v[132:133], v152 offset:28672
    ds_read_b64_tr_b16 v[134:135], v152 offset:29696
    s_add_u32 s98, s97, 0x77000
    buffer_load_dwordx4 a[136:139], v2, s[32:35], s98 offen offset:0 sc1
    v_mfma_f32_32x32x16_bf16 v[108:123], v[144:147], a[88:91], v[108:123]
    ds_read_b64_tr_b16 v[136:137], v153 offset:28672
    ds_read_b64_tr_b16 v[138:139], v153 offset:29696
    s_waitcnt vmcnt(18) lgkmcnt(4)
    v_mfma_f32_32x32x16_bf16 v[92:107], v[124:127], a[92:95], v[92:107]
    ds_read_b64_tr_b16 v[140:141], v152 offset:32768
    ds_read_b64_tr_b16 v[142:143], v152 offset:33792
    s_add_u32 m0, s62, 20480
    s_add_u32 s79, s68, 673792
    buffer_load_dwordx4 v3, s[24:27], s79 offen lds
    v_mfma_f32_32x32x16_bf16 v[108:123], v[128:131], a[92:95], v[108:123]
    ds_read_b64_tr_b16 v[144:145], v153 offset:32768
    ds_read_b64_tr_b16 v[146:147], v153 offset:33792
    s_waitcnt vmcnt(17) lgkmcnt(4)
    v_mfma_f32_32x32x16_bf16 v[92:107], v[132:135], a[96:99], v[92:107]
    ds_read_b64_tr_b16 v[124:125], v152 offset:36864
    ds_read_b64_tr_b16 v[126:127], v152 offset:37888
    buffer_load_dwordx4 a[140:143], v2, s[32:35], s98 offen offset:1024 sc1
    v_mfma_f32_32x32x16_bf16 v[108:123], v[136:139], a[96:99], v[108:123]
    ds_read_b64_tr_b16 v[128:129], v153 offset:36864
    ds_read_b64_tr_b16 v[130:131], v153 offset:37888
    s_waitcnt vmcnt(17) lgkmcnt(4)
    v_mfma_f32_32x32x16_bf16 v[92:107], v[140:143], a[100:103], v[92:107]
    ds_read_b64_tr_b16 v[132:133], v152 offset:40960
    ds_read_b64_tr_b16 v[134:135], v152 offset:41984
    buffer_load_dwordx4 a[144:147], v2, s[32:35], s98 offen offset:2048 sc1
    v_mfma_f32_32x32x16_bf16 v[108:123], v[144:147], a[100:103], v[108:123]
    ds_read_b64_tr_b16 v[136:137], v153 offset:40960
    ds_read_b64_tr_b16 v[138:139], v153 offset:41984
    s_barrier
    s_waitcnt vmcnt(16) lgkmcnt(4)
    v_mfma_f32_32x32x16_bf16 v[92:107], v[124:127], a[104:107], v[92:107]
    ds_read_b64_tr_b16 v[140:141], v152 offset:45056
    ds_read_b64_tr_b16 v[142:143], v152 offset:46080
    buffer_load_dwordx4 a[148:151], v2, s[32:35], s98 offen offset:3072 sc1
    v_mfma_f32_32x32x16_bf16 v[108:123], v[128:131], a[104:107], v[108:123]
    ds_read_b64_tr_b16 v[144:145], v153 offset:45056
    ds_read_b64_tr_b16 v[146:147], v153 offset:46080
    s_waitcnt vmcnt(15) lgkmcnt(4)
    v_mfma_f32_32x32x16_bf16 v[92:107], v[132:135], a[108:111], v[92:107]
    ds_read_b64_tr_b16 v[124:125], v152 offset:49152
    ds_read_b64_tr_b16 v[126:127], v152 offset:50176
    s_add_u32 s98, s97, 0x7a000
    buffer_load_dwordx4 a[152:155], v2, s[32:35], s98 offen offset:0 sc1
    v_mfma_f32_32x32x16_bf16 v[108:123], v[136:139], a[108:111], v[108:123]
    ds_read_b64_tr_b16 v[128:129], v153 offset:49152
    ds_read_b64_tr_b16 v[130:131], v153 offset:50176
    s_waitcnt vmcnt(15) lgkmcnt(4)
    v_mfma_f32_32x32x16_bf16 v[92:107], v[140:143], a[112:115], v[92:107]
    ds_read_b64_tr_b16 v[132:133], v152 offset:53248
    ds_read_b64_tr_b16 v[134:135], v152 offset:54272
    v_mfma_f32_32x32x16_bf16 v[108:123], v[144:147], a[112:115], v[108:123]
    ds_read_b64_tr_b16 v[136:137], v153 offset:53248
    ds_read_b64_tr_b16 v[138:139], v153 offset:54272
    buffer_load_dwordx4 a[156:159], v2, s[32:35], s98 offen offset:1024 sc1
    s_waitcnt vmcnt(14) lgkmcnt(4)
    v_mfma_f32_32x32x16_bf16 v[92:107], v[124:127], a[116:119], v[92:107]
    ds_read_b64_tr_b16 v[140:141], v152 offset:57344
    ds_read_b64_tr_b16 v[142:143], v152 offset:58368
    v_mfma_f32_32x32x16_bf16 v[108:123], v[128:131], a[116:119], v[108:123]
    ds_read_b64_tr_b16 v[144:145], v153 offset:57344
    ds_read_b64_tr_b16 v[146:147], v153 offset:58368
    s_barrier
    s_waitcnt vmcnt(12) lgkmcnt(4)
    v_mfma_f32_32x32x16_bf16 v[92:107], v[132:135], a[120:123], v[92:107]
    ds_read_b64_tr_b16 v[124:125], v152 offset:61440
    ds_read_b64_tr_b16 v[126:127], v152 offset:62464
    buffer_load_dwordx4 a[160:163], v2, s[32:35], s98 offen offset:2048 sc1
    v_mfma_f32_32x32x16_bf16 v[108:123], v[136:139], a[120:123], v[108:123]
    ds_read_b64_tr_b16 v[128:129], v153 offset:61440
    ds_read_b64_tr_b16 v[130:131], v153 offset:62464
    s_waitcnt vmcnt(12) lgkmcnt(4)
    v_mfma_f32_32x32x16_bf16 v[92:107], v[140:143], a[124:127], v[92:107]
    v_add_u32 v152, 65536, v152
    ds_read_b64_tr_b16 v[132:133], v152 offset:0
    ds_read_b64_tr_b16 v[134:135], v152 offset:1024
    buffer_load_dwordx4 a[164:167], v2, s[32:35], s98 offen offset:3072 sc1
    v_mfma_f32_32x32x16_bf16 v[108:123], v[144:147], a[124:127], v[108:123]
    v_add_u32 v153, 65536, v153
    ds_read_b64_tr_b16 v[136:137], v153 offset:0
    ds_read_b64_tr_b16 v[138:139], v153 offset:1024
    s_waitcnt vmcnt(11) lgkmcnt(4)
    v_mfma_f32_32x32x16_bf16 v[92:107], v[124:127], a[128:131], v[92:107]
    ds_read_b64_tr_b16 v[140:141], v152 offset:4096
    ds_read_b64_tr_b16 v[142:143], v152 offset:5120
    v_mfma_f32_32x32x16_bf16 v[108:123], v[128:131], a[128:131], v[108:123]
    ds_read_b64_tr_b16 v[144:145], v153 offset:4096
    ds_read_b64_tr_b16 v[146:147], v153 offset:5120
    s_add_u32 s98, s97, 0x7b000
    buffer_load_dwordx4 a[168:171], v2, s[32:35], s98 offen offset:0 sc1
    s_waitcnt vmcnt(10) lgkmcnt(4)
    v_mfma_f32_32x32x16_bf16 v[92:107], v[132:135], a[132:135], v[92:107]
    ds_read_b64_tr_b16 v[124:125], v152 offset:8192
    ds_read_b64_tr_b16 v[126:127], v152 offset:9216
    v_mfma_f32_32x32x16_bf16 v[108:123], v[136:139], a[132:135], v[108:123]
    ds_read_b64_tr_b16 v[128:129], v153 offset:8192
    ds_read_b64_tr_b16 v[130:131], v153 offset:9216
    s_barrier
    s_waitcnt vmcnt(9) lgkmcnt(4)
    v_mfma_f32_32x32x16_bf16 v[92:107], v[140:143], a[136:139], v[92:107]
    ds_read_b64_tr_b16 v[132:133], v152 offset:12288
    ds_read_b64_tr_b16 v[134:135], v152 offset:13312
    buffer_load_dwordx4 a[172:175], v2, s[32:35], s98 offen offset:1024 sc1
    v_mfma_f32_32x32x16_bf16 v[108:123], v[144:147], a[136:139], v[108:123]
    ds_read_b64_tr_b16 v[136:137], v153 offset:12288
    ds_read_b64_tr_b16 v[138:139], v153 offset:13312
    s_waitcnt vmcnt(8) lgkmcnt(4)
    v_mfma_f32_32x32x16_bf16 v[92:107], v[124:127], a[140:143], v[92:107]
    ds_read_b64_tr_b16 v[140:141], v152 offset:16384
    ds_read_b64_tr_b16 v[142:143], v152 offset:17408
    buffer_load_dwordx4 a[176:179], v2, s[32:35], s98 offen offset:2048 sc1
    v_mfma_f32_32x32x16_bf16 v[108:123], v[128:131], a[140:143], v[108:123]
    ds_read_b64_tr_b16 v[144:145], v153 offset:16384
    ds_read_b64_tr_b16 v[146:147], v153 offset:17408
    s_waitcnt vmcnt(8) lgkmcnt(4)
    v_mfma_f32_32x32x16_bf16 v[92:107], v[132:135], a[144:147], v[92:107]
    ds_read_b64_tr_b16 v[124:125], v152 offset:20480
    ds_read_b64_tr_b16 v[126:127], v152 offset:21504
    v_mfma_f32_32x32x16_bf16 v[108:123], v[136:139], a[144:147], v[108:123]
    ds_read_b64_tr_b16 v[128:129], v153 offset:20480
    ds_read_b64_tr_b16 v[130:131], v153 offset:21504
    buffer_load_dwordx4 a[180:183], v2, s[32:35], s98 offen offset:3072 sc1
    s_waitcnt vmcnt(8) lgkmcnt(4)
    v_mfma_f32_32x32x16_bf16 v[92:107], v[140:143], a[148:151], v[92:107]
    ds_read_b64_tr_b16 v[132:133], v152 offset:24576
    ds_read_b64_tr_b16 v[134:135], v152 offset:25600
    v_mfma_f32_32x32x16_bf16 v[108:123], v[144:147], a[148:151], v[108:123]
    ds_read_b64_tr_b16 v[136:137], v153 offset:24576
    ds_read_b64_tr_b16 v[138:139], v153 offset:25600
    s_barrier
    s_waitcnt vmcnt(7) lgkmcnt(4)
    v_mfma_f32_32x32x16_bf16 v[92:107], v[124:127], a[152:155], v[92:107]
    v_add_u32 v152, 4294836224, v152
    ds_read_b64_tr_b16 v[140:141], v152 offset:0
    ds_read_b64_tr_b16 v[142:143], v152 offset:1024
    v_mfma_f32_32x32x16_bf16 v[108:123], v[128:131], a[152:155], v[108:123]
    v_add_u32 v153, 4294836224, v153
    ds_read_b64_tr_b16 v[144:145], v153 offset:0
    ds_read_b64_tr_b16 v[146:147], v153 offset:1024
    s_waitcnt vmcnt(6) lgkmcnt(4)
    v_mfma_f32_32x32x16_bf16 v[92:107], v[132:135], a[156:159], v[92:107]
    ds_read_b64_tr_b16 v[124:125], v152 offset:4096
    ds_read_b64_tr_b16 v[126:127], v152 offset:5120
    v_mfma_f32_32x32x16_bf16 v[108:123], v[136:139], a[156:159], v[108:123]
    ds_read_b64_tr_b16 v[128:129], v153 offset:4096
    ds_read_b64_tr_b16 v[130:131], v153 offset:5120
    s_waitcnt vmcnt(5) lgkmcnt(4)
    v_mfma_f32_32x32x16_bf16 v[92:107], v[140:143], a[160:163], v[92:107]
    ds_read_b64_tr_b16 v[132:133], v152 offset:8192
    ds_read_b64_tr_b16 v[134:135], v152 offset:9216
    v_mfma_f32_32x32x16_bf16 v[108:123], v[144:147], a[160:163], v[108:123]
    ds_read_b64_tr_b16 v[136:137], v153 offset:8192
    ds_read_b64_tr_b16 v[138:139], v153 offset:9216
    s_waitcnt vmcnt(4) lgkmcnt(4)
    v_mfma_f32_32x32x16_bf16 v[92:107], v[124:127], a[164:167], v[92:107]
    ds_read_b64_tr_b16 v[140:141], v152 offset:12288
    ds_read_b64_tr_b16 v[142:143], v152 offset:13312
    v_mfma_f32_32x32x16_bf16 v[108:123], v[128:131], a[164:167], v[108:123]
    ds_read_b64_tr_b16 v[144:145], v153 offset:12288
    ds_read_b64_tr_b16 v[146:147], v153 offset:13312
    s_barrier
    s_waitcnt vmcnt(3) lgkmcnt(4)
    v_mfma_f32_32x32x16_bf16 v[92:107], v[132:135], a[168:171], v[92:107]
    ds_read_b64_tr_b16 v[124:125], v152 offset:16384
    ds_read_b64_tr_b16 v[126:127], v152 offset:17408
    v_mfma_f32_32x32x16_bf16 v[108:123], v[136:139], a[168:171], v[108:123]
    ds_read_b64_tr_b16 v[128:129], v153 offset:16384
    ds_read_b64_tr_b16 v[130:131], v153 offset:17408
    s_waitcnt vmcnt(2) lgkmcnt(4)
    v_mfma_f32_32x32x16_bf16 v[92:107], v[140:143], a[172:175], v[92:107]
    ds_read_b64_tr_b16 v[132:133], v152 offset:20480
    ds_read_b64_tr_b16 v[134:135], v152 offset:21504
    v_mfma_f32_32x32x16_bf16 v[108:123], v[144:147], a[172:175], v[108:123]
    ds_read_b64_tr_b16 v[136:137], v153 offset:20480
    ds_read_b64_tr_b16 v[138:139], v153 offset:21504
    s_waitcnt vmcnt(1) lgkmcnt(4)
    v_mfma_f32_32x32x16_bf16 v[92:107], v[124:127], a[176:179], v[92:107]
    v_mfma_f32_32x32x16_bf16 v[108:123], v[128:131], a[176:179], v[108:123]
    s_waitcnt vmcnt(0) lgkmcnt(0)
    v_mfma_f32_32x32x16_bf16 v[92:107], v[132:135], a[180:183], v[92:107]
    v_mfma_f32_32x32x16_bf16 v[108:123], v[136:139], a[180:183], v[108:123]
    s_nop 11
    ds_write_b128 v148, v[108:111] offset:0
    ds_write_b128 v148, v[112:115] offset:1024
    ds_write_b128 v148, v[116:119] offset:2048
    ds_write_b128 v148, v[120:123] offset:3072
    v_pk_add_f32 v[8:9], v[8:9], v[92:93]
    v_pk_add_f32 v[10:11], v[10:11], v[94:95]
    v_pk_add_f32 v[12:13], v[12:13], v[96:97]
    v_pk_add_f32 v[14:15], v[14:15], v[98:99]
    v_pk_add_f32 v[16:17], v[16:17], v[100:101]
    v_pk_add_f32 v[18:19], v[18:19], v[102:103]
    v_pk_add_f32 v[20:21], v[20:21], v[104:105]
    v_pk_add_f32 v[22:23], v[22:23], v[106:107]
    s_waitcnt lgkmcnt(0)
    s_barrier
    ds_read_b128 v[108:111], v149 offset:0
    ds_read_b128 v[112:115], v149 offset:1024
    ds_read_b128 v[116:119], v149 offset:2048
    ds_read_b128 v[120:123], v149 offset:3072
    s_waitcnt lgkmcnt(3)
    v_pk_add_f32 v[8:9], v[8:9], v[108:109]
    v_pk_add_f32 v[10:11], v[10:11], v[110:111]
    v_cvt_pk_bf16_f32 v92, v8, v9
    v_cvt_pk_bf16_f32 v93, v10, v11
    s_waitcnt lgkmcnt(2)
    v_pk_add_f32 v[12:13], v[12:13], v[112:113]
    v_pk_add_f32 v[14:15], v[14:15], v[114:115]
    v_cvt_pk_bf16_f32 v94, v12, v13
    v_cvt_pk_bf16_f32 v95, v14, v15
    s_waitcnt lgkmcnt(1)
    v_pk_add_f32 v[16:17], v[16:17], v[116:117]
    v_pk_add_f32 v[18:19], v[18:19], v[118:119]
    v_cvt_pk_bf16_f32 v96, v16, v17
    v_cvt_pk_bf16_f32 v97, v18, v19
    s_waitcnt lgkmcnt(0)
    v_pk_add_f32 v[20:21], v[20:21], v[120:121]
    v_pk_add_f32 v[22:23], v[22:23], v[122:123]
    v_cvt_pk_bf16_f32 v98, v20, v21
    v_cvt_pk_bf16_f32 v99, v22, v23
    v_permlane32_swap_b32 v92, v94
    v_permlane32_swap_b32 v93, v95
    v_permlane32_swap_b32 v96, v98
    v_permlane32_swap_b32 v97, v99
    buffer_store_dwordx4 v[92:95], v150, s[28:31], s88 offen offset:0
    buffer_store_dwordx4 v[96:99], v150, s[28:31], s88 offen offset:32
    s_branch L_bump
L_idle1:
    s_waitcnt vmcnt(0)
    v_mov_b32 v7, 2
    s_mov_b64 exec, 1
    s_cmp_lg_u32 s61, 0
    s_cbranch_scc1 L_var34_wt
    buffer_store_dword v7, off, s[32:35], s90
L_var34_end:
    s_mov_b64 exec, -1
    s_waitcnt vmcnt(0)
    s_endpgm
L_bump:
    s_cmp_lg_u32 s2, 0
    s_cbranch_scc1 L_end
    v_mov_b32 v2, s36
    v_mov_b32 v3, s37
    s_mov_b32 s69, 0x2002000
    s_mov_b64 exec, 1
    buffer_store_dwordx2 v[2:3], off, s[32:35], s69
L_end:
    s_endpgm
L_var1_wt:
    buffer_store_dwordx4 v[172:175], v2, s[32:35], s70 offen offset:0 sc1
    buffer_store_dwordx4 v[176:179], v2, s[32:35], s70 offen offset:1024 sc1
    s_branch L_var1_end
L_var2_wt:
    buffer_store_dword v7, off, s[32:35], s90 sc1
    s_branch L_var2_end
L_var3_wt:
    buffer_store_dwordx4 v[110:113], v2, s[32:35], s88 offen offset:0 sc1
    s_branch L_var3_end
L_var4_wt:
    buffer_store_dwordx4 v[114:117], v2, s[32:35], s88 offen offset:1024 sc1
    s_branch L_var4_end
L_var5_wt:
    buffer_store_dwordx2 v[118:119], v30, s[32:35], s89 offen sc1
    s_branch L_var5_end
L_var6_wt:
    buffer_store_dword v7, off, s[32:35], s91 sc1
    s_branch L_var6_end
L_var7_wt:
    buffer_store_dword v7, off, s[32:35], s89 sc1
    s_branch L_var7_end
L_var8_wt:
    buffer_store_dword v7, off, s[32:35], s91 sc1
    s_branch L_var8_end
L_var9_wt:
    buffer_store_dword v7, off, s[32:35], s91 sc1
    s_branch L_var9_end
L_var10_wt:
    buffer_store_dword v7, off, s[32:35], s91 sc1
    s_branch L_var10_end
L_var11_wt:
    buffer_store_dwordx4 v[28:31], v2, s[32:35], s88 offen offset:0 sc1
    s_branch L_var11_end
L_var12_wt:
    buffer_store_dwordx4 v[32:35], v2, s[32:35], s88 offen offset:1024 sc1
    s_branch L_var12_end
L_var13_wt:
    buffer_store_dwordx2 v[36:37], v216, s[32:35], s90 offen sc1
    s_branch L_var13_end
L_var14_wt:
    buffer_store_dword v7, off, s[32:35], s92 sc1
    s_branch L_var14_end
L_var15_wt:
    buffer_store_dword v7, off, s[32:35], s90 sc1
    s_branch L_var15_end
L_var16_wt:
    buffer_store_dwordx4 v[172:175], v2, s[32:35], s70 offen offset:0 sc1
    buffer_store_dwordx4 v[176:179], v2, s[32:35], s70 offen offset:1024 sc1
    s_branch L_var16_end
L_var17_wt:
    buffer_store_dword v7, off, s[32:35], s90 sc1
    s_branch L_var17_end
L_var18_wt:
    buffer_store_dwordx4 v[92:95], v2, s[32:35], s88 offen offset:0 sc1
    s_branch L_var18_end
L_var19_wt:
    buffer_store_dwordx4 v[96:99], v2, s[32:35], s88 offen offset:1024 sc1
    s_branch L_var19_end
L_var20_wt:
    buffer_store_dwordx2 v[100:101], v150, s[32:35], s89 offen sc1
    s_branch L_var20_end
L_var21_wt:
    buffer_store_dword v7, off, s[32:35], s91 sc1
    s_branch L_var21_end
L_var22_wt:
    buffer_store_dwordx4 v[214:217], v2, s[32:35], s71 offen sc1
    s_branch L_var22_end
L_var23_wt:
    buffer_store_dwordx4 v[218:221], v2, s[32:35], s71 offen sc1
    s_branch L_var23_end
L_var24_wt:
    buffer_store_dwordx4 v[214:217], v2, s[32:35], s71 offen sc1
    s_branch L_var24_end
L_var25_wt:
    buffer_store_dwordx4 v[218:221], v2, s[32:35], s71 offen sc1
    s_branch L_var25_end
L_var26_wt:
    buffer_store_dword v7, off, s[32:35], s89 sc1
    s_branch L_var26_end
L_var27_wt:
    buffer_store_dword v7, off, s[32:35], s91 sc1
    s_branch L_var27_end
L_var28_wt:
    buffer_store_dwordx4 v[214:217], v2, s[32:35], s71 offen sc1
    s_branch L_var28_end
L_var29_wt:
    buffer_store_dwordx4 v[218:221], v2, s[32:35], s71 offen sc1
    s_branch L_var29_end
L_var30_wt:
    buffer_store_dwordx4 v[214:217], v2, s[32:35], s71 offen sc1
    s_branch L_var30_end
L_var31_wt:
    buffer_store_dwordx4 v[218:221], v2, s[32:35], s71 offen sc1
    s_branch L_var31_end
L_var32_wt:
    buffer_store_dword v7, off, s[32:35], s91 sc1
    s_branch L_var32_end
L_var33_wt:
    buffer_store_dword v7, off, s[32:35], s91 sc1
    s_branch L_var33_end
L_var34_wt:
    buffer_store_dword v7, off, s[32:35], s90 sc1
    s_branch L_var34_end
L_codeend:
.section .rodata,"a"
.p2align 6
.amdhsa_kernel interleave_layers__linear_kernel_hedgehog__glu_gated_geglu__prompt_kernel
  .amdhsa_next_free_vgpr 512
  .amdhsa_next_free_sgpr 102
  .amdhsa_accum_offset 256
  .amdhsa_group_segment_fixed_size 0
  .amdhsa_kernarg_size 88
  .amdhsa_user_sgpr_count 2
  .amdhsa_user_sgpr_kernarg_segment_ptr 1
  .amdhsa_system_sgpr_workgroup_id_x 1
.end_amdhsa_kernel
```
